```python
import torch

def _softmax(x, axis=-1):
    return torch.softmax(x, dim=axis)
def _gelu(x):
    return torch.nn.functional.gelu(x, approximate="tanh")
def _silu(x):
    return torch.nn.functional.silu(x)
def _sigmoid(x):
    return torch.sigmoid(x)
def _layernorm(x, axis=-1, eps=1e-5):
    m = x.mean(dim=axis, keepdim=True)
    v = x.var(dim=axis, keepdim=True, unbiased=False)
    return (x - m) / torch.sqrt(v + eps)
def _scatter_add(tgt, idx, src, axis=0):
    return tgt.clone().index_add_(axis, idx, src)
def _segment_sum(src, seg, n):
    out = torch.zeros((n,) + src.shape[1:], dtype=src.dtype)
    return out.index_add_(0, seg, src)
def _pad(x, pw):
    flat = tuple(v for pair in reversed(pw) for v in pair)
    return torch.nn.functional.pad(x, flat)

kernel_name = 'sequential_preLN__spectral_gfnet__glu_gated_bilinear__prompt'

def setup_inputs():

    _w = (lambda a: (lambda t: t.to(torch.bfloat16) if t.is_floating_point() else t)(torch.as_tensor(a)))
    def _A_setup():
        B, S, D = 1, 2048, 1024
        Df = D // 2 + 1
        return {
            "x": _w((lambda *s: torch.randn(*s, dtype=torch.bfloat16) * 0.05)(B, S, D)),
            "w_r": _w((lambda *s: torch.randn(*s, dtype=torch.bfloat16) * 0.4)(S, Df) * 0.02),
            "w_i": _w((lambda *s: torch.randn(*s, dtype=torch.bfloat16) * 0.4)(S, Df) * 0.02),
        }
    _A_in = _A_setup()

    def _B_setup():
        B, S, D, F = 1, 2048, 1024, 3584
        return {
            "x": _w((lambda *s: torch.randn(*s, dtype=torch.bfloat16) * 0.05)(B, S, D)),
            "w_gate": _w((lambda *s: torch.randn(*s, dtype=torch.bfloat16) * 0.2)(D, F) * (D ** -0.5)),
            "w_up": _w((lambda *s: torch.randn(*s, dtype=torch.bfloat16) * 0.2)(D, F) * (D ** -0.5)),
            "w_down": _w((lambda *s: torch.randn(*s, dtype=torch.bfloat16) * 0.2)(F, D) * (F ** -0.5)),
        }
    _B_in = _B_setup()

    return {
        "A_x": _A_in["x"],
        "A_w_r": _A_in["w_r"],
        "A_w_i": _A_in["w_i"],
        "B_x": _B_in["x"],
        "B_w_gate": _B_in["w_gate"],
        "B_w_up": _B_in["w_up"],
        "B_w_down": _B_in["w_down"],
    }

def reference(A_x, A_w_r, A_w_i, B_x, B_w_gate, B_w_up, B_w_down):
    def _A_ref(x, w_r, w_i):
        B, S, D = x.shape
        X = (lambda x, axes=(-2,-1): torch.fft.rfft2(x.float(), dim=axes))(x, axes=(-2, -1))
        W = w_r + 1j * w_i
        X = X * W
        y = (lambda x, s, axes=(-2,-1): torch.fft.irfft2(x, s=s, dim=axes).to(torch.bfloat16))(X, (S, D), axes=(-2, -1))
        return y

    def _B_ref(x, w_gate, w_up, w_down):
        g = torch.einsum("bsd,df->bsf", x, w_gate)
        u = torch.einsum("bsd,df->bsf", x, w_up)
        h = g * u
        return torch.einsum("bsf,fd->bsd", h, w_down)

    x = A_x
    h = x + _A_ref(_layernorm(x, axis=-1), A_w_r, A_w_i)
    h2 = h + _B_ref(_layernorm(h, axis=-1), B_w_gate, B_w_up, B_w_down)
    return h2
```

```asm
; @launch kernel=fft1_kernel grid=(512,1,1) block=(256,1,1) lds=16896
; @launch kernel=main_kernel grid=(256,1,1) block=(256,1,1) lds=163840
.amdgcn_target "amdgcn-amd-amdhsa--gfx950"
.text
.globl fft1_kernel
.p2align 8
.type fft1_kernel,@function
fft1_kernel:
  s_cmp_ge_u32 s2, 512
  s_cbranch_scc1 L_f1_end
  s_load_dwordx4 s[4:7], s[0:1], 0
  s_load_dwordx2 s[8:9], s[0:1], 16
  s_load_dwordx2 s[10:11], s[0:1], 72
  s_getpc_b64 s[70:71]
L_pc_fft1_kernel:
  v_lshlrev_b32 v222, 6, v0
  v_min_u32 v222, L_f1_end-L_pc_fft1_kernel, v222
  v_mov_b32 v223, 0
  v_lshl_add_u64 v[222:223], v[222:223], 0, s[70:71]
  global_load_dword v222, v[222:223], off
L_f1_nopf:
  v_lshrrev_b32 v2, 6, v0
  v_mov_b32 v1, v0
  v_and_b32 v0, 63, v0
  v_readfirstlane_b32 s13, v2
  s_and_b32 s12, s2, 255
  s_lshr_b32 s14, s12, 5
  s_and_b32 s15, s12, 31
  s_lshl_b32 s16, s14, 7
  s_add_u32 s16, s16, s15
  s_bfe_u32 s18, s12, 0x20002
  s_lshl_b32 s19, s12, 7
  s_mul_i32 s38, s13, 1048576
  s_add_u32 s56, s38, s19
  s_add_u32 s57, s56, 262144
  s_add_u32 s58, s57, 262144
  s_add_u32 s59, s58, 262144
  s_mov_b32 s34, 6291456
  s_mov_b32 s35, 0x20000
  s_cmp_ge_u32 s2, 256
  s_cbranch_scc1 L_f1_filter
  s_lshl_b32 s17, s13, 5
  s_add_u32 s16, s16, s17
  s_lshl_b32 s16, s16, 11
  s_add_u32 s17, s16, 2097152
  v_lshlrev_b32 v2, 4, v0
  s_mov_b32 s22, 4194304
  s_mov_b32 s23, 0x20000
  s_waitcnt lgkmcnt(0)
  s_mov_b32 s20, s4
  s_and_b32 s21, s5, 0xffff
  buffer_load_dwordx4 v[4:7], v2, s[20:23], s16 offen
  buffer_load_dwordx4 v[8:11], v2, s[20:23], s16 offen offset:1024
  buffer_load_dwordx4 v[12:15], v2, s[20:23], s17 offen
  buffer_load_dwordx4 v[16:19], v2, s[20:23], s17 offen offset:1024
  s_add_u32 s32, s10, 0
  s_addc_u32 s33, s11, 0
  s_and_b32 s33, s33, 0xffff
  v_and_b32 v56, 31, v0
  v_cvt_f32_u32 v56, v56
  v_lshrrev_b32 v57, 5, v0
  v_cvt_f32_u32 v57, v57
  v_mul_f32 v57, 4.0, v57
  v_mul_f32 v58, 0x3d000000, v56
  v_mul_f32 v59, v57, v58
  v_mov_b32 v152, v59
  v_cos_f32 v153, v152
  v_sin_f32 v154, v152
  v_fmamk_f32 v155, v58, 0x40000000, v59
  v_cos_f32 v156, v155
  v_sin_f32 v157, v155
  v_cvt_pk_f16_f32 v64, v153, v154
  v_cvt_pk_f16_f32 v80, -v154, v153
  v_fmamk_f32 v152, v58, 0x3f800000, v59
  v_cos_f32 v153, v152
  v_sin_f32 v154, v152
  v_cvt_pk_f16_f32 v65, v156, v157
  v_cvt_pk_f16_f32 v81, -v157, v156
  v_fmamk_f32 v155, v58, 0x40400000, v59
  v_cos_f32 v156, v155
  v_sin_f32 v157, v155
  v_cvt_pk_f16_f32 v66, v153, v154
  v_cvt_pk_f16_f32 v82, -v154, v153
  v_fmamk_f32 v152, v58, 0x41000000, v59
  v_cos_f32 v153, v152
  v_sin_f32 v154, v152
  v_cvt_pk_f16_f32 v67, v156, v157
  v_cvt_pk_f16_f32 v83, -v157, v156
  v_fmamk_f32 v155, v58, 0x41200000, v59
  v_cos_f32 v156, v155
  v_sin_f32 v157, v155
  v_cvt_pk_f16_f32 v68, v153, v154
  v_cvt_pk_f16_f32 v84, -v154, v153
  v_fmamk_f32 v152, v58, 0x41100000, v59
  v_cos_f32 v153, v152
  v_sin_f32 v154, v152
  v_cvt_pk_f16_f32 v69, v156, v157
  v_cvt_pk_f16_f32 v85, -v157, v156
  v_fmamk_f32 v155, v58, 0x41300000, v59
  v_cos_f32 v156, v155
  v_sin_f32 v157, v155
  v_cvt_pk_f16_f32 v70, v153, v154
  v_cvt_pk_f16_f32 v86, -v154, v153
  v_fmamk_f32 v152, v58, 0x41800000, v59
  v_cos_f32 v153, v152
  v_sin_f32 v154, v152
  v_cvt_pk_f16_f32 v71, v156, v157
  v_cvt_pk_f16_f32 v87, -v157, v156
  v_fmamk_f32 v155, v58, 0x41900000, v59
  v_cos_f32 v156, v155
  v_sin_f32 v157, v155
  v_cvt_pk_f16_f32 v72, v153, v154
  v_cvt_pk_f16_f32 v88, -v154, v153
  v_fmamk_f32 v152, v58, 0x41880000, v59
  v_cos_f32 v153, v152
  v_sin_f32 v154, v152
  v_cvt_pk_f16_f32 v73, v156, v157
  v_cvt_pk_f16_f32 v89, -v157, v156
  v_fmamk_f32 v155, v58, 0x41980000, v59
  v_cos_f32 v156, v155
  v_sin_f32 v157, v155
  v_cvt_pk_f16_f32 v74, v153, v154
  v_cvt_pk_f16_f32 v90, -v154, v153
  v_fmamk_f32 v152, v58, 0x41c00000, v59
  v_cos_f32 v153, v152
  v_sin_f32 v154, v152
  v_cvt_pk_f16_f32 v75, v156, v157
  v_cvt_pk_f16_f32 v91, -v157, v156
  v_fmamk_f32 v155, v58, 0x41d00000, v59
  v_cos_f32 v156, v155
  v_sin_f32 v157, v155
  v_cvt_pk_f16_f32 v76, v153, v154
  v_cvt_pk_f16_f32 v92, -v154, v153
  v_fmamk_f32 v152, v58, 0x41c80000, v59
  v_cos_f32 v153, v152
  v_sin_f32 v154, v152
  v_cvt_pk_f16_f32 v77, v156, v157
  v_cvt_pk_f16_f32 v93, -v157, v156
  v_fmamk_f32 v155, v58, 0x41d80000, v59
  v_cos_f32 v156, v155
  v_sin_f32 v157, v155
  v_cvt_pk_f16_f32 v78, v153, v154
  v_cvt_pk_f16_f32 v94, -v154, v153
  s_nop 0
  v_cvt_pk_f16_f32 v79, v156, v157
  v_cvt_pk_f16_f32 v95, -v157, v156
  v_mov_b32 v152, v59
  v_cos_f32 v153, v152
  v_sin_f32 v154, v152
  v_fmamk_f32 v155, v58, 0x3f800000, v59
  v_cos_f32 v156, v155
  v_sin_f32 v157, v155
  s_nop 0
  v_cvt_pk_f16_f32 v128, v153, v156
  v_cvt_pk_f16_f32 v136, v154, v157
  v_cvt_pk_f16_f32 v144, -v154, -v157
  v_fmamk_f32 v152, v58, 0x40000000, v59
  v_cos_f32 v153, v152
  v_sin_f32 v154, v152
  v_fmamk_f32 v155, v58, 0x40400000, v59
  v_cos_f32 v156, v155
  v_sin_f32 v157, v155
  s_nop 0
  v_cvt_pk_f16_f32 v129, v153, v156
  v_cvt_pk_f16_f32 v137, v154, v157
  v_cvt_pk_f16_f32 v145, -v154, -v157
  v_fmamk_f32 v152, v58, 0x41000000, v59
  v_cos_f32 v153, v152
  v_sin_f32 v154, v152
  v_fmamk_f32 v155, v58, 0x41100000, v59
  v_cos_f32 v156, v155
  v_sin_f32 v157, v155
  s_nop 0
  v_cvt_pk_f16_f32 v130, v153, v156
  v_cvt_pk_f16_f32 v138, v154, v157
  v_cvt_pk_f16_f32 v146, -v154, -v157
  v_fmamk_f32 v152, v58, 0x41200000, v59
  v_cos_f32 v153, v152
  v_sin_f32 v154, v152
  v_fmamk_f32 v155, v58, 0x41300000, v59
  v_cos_f32 v156, v155
  v_sin_f32 v157, v155
  s_nop 0
  v_cvt_pk_f16_f32 v131, v153, v156
  v_cvt_pk_f16_f32 v139, v154, v157
  v_cvt_pk_f16_f32 v147, -v154, -v157
  v_fmamk_f32 v152, v58, 0x41800000, v59
  v_cos_f32 v153, v152
  v_sin_f32 v154, v152
  v_fmamk_f32 v155, v58, 0x41880000, v59
  v_cos_f32 v156, v155
  v_sin_f32 v157, v155
  s_nop 0
  v_cvt_pk_f16_f32 v132, v153, v156
  v_cvt_pk_f16_f32 v140, v154, v157
  v_cvt_pk_f16_f32 v148, -v154, -v157
  v_fmamk_f32 v152, v58, 0x41900000, v59
  v_cos_f32 v153, v152
  v_sin_f32 v154, v152
  v_fmamk_f32 v155, v58, 0x41980000, v59
  v_cos_f32 v156, v155
  v_sin_f32 v157, v155
  s_nop 0
  v_cvt_pk_f16_f32 v133, v153, v156
  v_cvt_pk_f16_f32 v141, v154, v157
  v_cvt_pk_f16_f32 v149, -v154, -v157
  v_fmamk_f32 v152, v58, 0x41c00000, v59
  v_cos_f32 v153, v152
  v_sin_f32 v154, v152
  v_fmamk_f32 v155, v58, 0x41c80000, v59
  v_cos_f32 v156, v155
  v_sin_f32 v157, v155
  s_nop 0
  v_cvt_pk_f16_f32 v134, v153, v156
  v_cvt_pk_f16_f32 v142, v154, v157
  v_cvt_pk_f16_f32 v150, -v154, -v157
  v_fmamk_f32 v152, v58, 0x41d00000, v59
  v_cos_f32 v153, v152
  v_sin_f32 v154, v152
  v_fmamk_f32 v155, v58, 0x41d80000, v59
  v_cos_f32 v156, v155
  v_sin_f32 v157, v155
  s_nop 0
  v_cvt_pk_f16_f32 v135, v153, v156
  v_cvt_pk_f16_f32 v143, v154, v157
  v_cvt_pk_f16_f32 v151, -v154, -v157
  v_mul_f32 v58, 0x3a800000, v56
  v_mul_f32 v59, v57, v58
  v_mov_b32 v152, v59
  v_cos_f32 v96, v152
  v_sin_f32 v112, v152
  v_fmamk_f32 v153, v58, 0x3f800000, v59
  v_cos_f32 v97, v153
  v_sin_f32 v113, v153
  v_fmamk_f32 v152, v58, 0x40000000, v59
  v_cos_f32 v98, v152
  v_sin_f32 v114, v152
  v_fmamk_f32 v153, v58, 0x40400000, v59
  v_cos_f32 v99, v153
  v_sin_f32 v115, v153
  v_fmamk_f32 v152, v58, 0x41000000, v59
  v_cos_f32 v100, v152
  v_sin_f32 v116, v152
  v_fmamk_f32 v153, v58, 0x41100000, v59
  v_cos_f32 v101, v153
  v_sin_f32 v117, v153
  v_fmamk_f32 v152, v58, 0x41200000, v59
  v_cos_f32 v102, v152
  v_sin_f32 v118, v152
  v_fmamk_f32 v153, v58, 0x41300000, v59
  v_cos_f32 v103, v153
  v_sin_f32 v119, v153
  v_fmamk_f32 v152, v58, 0x41800000, v59
  v_cos_f32 v104, v152
  v_sin_f32 v120, v152
  v_fmamk_f32 v153, v58, 0x41880000, v59
  v_cos_f32 v105, v153
  v_sin_f32 v121, v153
  v_fmamk_f32 v152, v58, 0x41900000, v59
  v_cos_f32 v106, v152
  v_sin_f32 v122, v152
  v_fmamk_f32 v153, v58, 0x41980000, v59
  v_cos_f32 v107, v153
  v_sin_f32 v123, v153
  v_fmamk_f32 v152, v58, 0x41c00000, v59
  v_cos_f32 v108, v152
  v_sin_f32 v124, v152
  v_fmamk_f32 v153, v58, 0x41c80000, v59
  v_cos_f32 v109, v153
  v_sin_f32 v125, v153
  v_fmamk_f32 v152, v58, 0x41d00000, v59
  v_cos_f32 v110, v152
  v_sin_f32 v126, v152
  v_fmamk_f32 v153, v58, 0x41d80000, v59
  v_cos_f32 v111, v153
  v_sin_f32 v127, v153
  s_lshl_b32 s38, s14, 7
  s_add_u32 s38, s38, s15
  v_and_b32 v2, 1, v0
  v_cvt_f32_u32 v2, v2
  v_mul_f32 v58, 0x3c800000, v2
  v_cvt_f32_u32 v59, s38
  v_mul_f32 v59, 0x3a000000, v59
  v_mul_f32 v59, v59, v2
  v_mov_b32 v152, v59
  v_cos_f32 v153, v152
  v_sin_f32 v154, v152
  v_fmamk_f32 v155, v58, 0x3f800000, v59
  v_cos_f32 v156, v155
  v_sin_f32 v157, v155
  v_cvt_pk_f16_f32 v224, v153, v153
  v_cvt_pk_f16_f32 v228, v154, -v154
  v_fmamk_f32 v152, v58, 0x40000000, v59
  v_cos_f32 v153, v152
  v_sin_f32 v154, v152
  v_cvt_pk_f16_f32 v225, v156, v156
  v_cvt_pk_f16_f32 v229, v157, -v157
  v_fmamk_f32 v155, v58, 0x40400000, v59
  v_cos_f32 v156, v155
  v_sin_f32 v157, v155
  v_cvt_pk_f16_f32 v226, v153, v153
  v_cvt_pk_f16_f32 v230, v154, -v154
  s_nop 0
  v_cvt_pk_f16_f32 v227, v156, v156
  v_cvt_pk_f16_f32 v231, v157, -v157
  s_lshl_b32 s38, s13, 12
  v_lshlrev_b32 v208, 5, v0
  v_add_u32 v208, s38, v208
  v_and_b32 v2, 31, v0
  v_lshlrev_b32 v2, 2, v2
  v_lshrrev_b32 v3, 5, v0
  v_lshl_add_u32 v2, v3, 9, v2
  v_add_u32 v209, s38, v2
  v_add_u32 v210, 128, v209
  v_and_b32 v2, 7, v0
  v_xor_b32 v2, s18, v2
  v_lshrrev_b32 v3, 3, v0
  v_mul_u32_u24 v3, 32768, v3
  v_lshl_add_u32 v211, v2, 4, v3
  s_lshl_b32 s38, s13, 7
  v_lshrrev_b32 v3, 1, v0
  v_add_u32 v3, s38, v3
  v_lshlrev_b32 v212, 2, v3
  v_add_u32 v213, 128, v212
  v_sub_u32 v214, 4096, v212
  v_subrev_u32 v215, 128, v214
  v_subrev_u32 v216, 256, v214
  v_subrev_u32 v217, 384, v214
  v_cmp_gt_u32 s[36:37], 2, v1
  v_mov_b32 v2, 2048
  s_nop 0
  v_cndmask_b32 v214, v214, v2, s[36:37]
  v_and_b32 v2, 1, v0
  v_cmp_eq_u32 vcc, 0, v2
  v_mov_b32 v2, 0x07060302
  v_mov_b32 v3, 0x05040100
  v_cndmask_b32 v218, v2, v3, vcc
  s_nop 0
  s_waitcnt vmcnt(0)
  v_lshlrev_b32 v20, 16, v4
  v_and_b32 v21, 0xffff0000, v4
  v_lshlrev_b32 v22, 16, v5
  v_and_b32 v23, 0xffff0000, v5
  v_lshlrev_b32 v24, 16, v6
  v_and_b32 v25, 0xffff0000, v6
  v_lshlrev_b32 v26, 16, v7
  v_and_b32 v27, 0xffff0000, v7
  v_lshlrev_b32 v28, 16, v8
  v_and_b32 v29, 0xffff0000, v8
  v_lshlrev_b32 v30, 16, v9
  v_and_b32 v31, 0xffff0000, v9
  v_lshlrev_b32 v32, 16, v10
  v_and_b32 v33, 0xffff0000, v10
  v_lshlrev_b32 v34, 16, v11
  v_and_b32 v35, 0xffff0000, v11
  v_lshlrev_b32 v36, 16, v12
  v_and_b32 v37, 0xffff0000, v12
  v_lshlrev_b32 v38, 16, v13
  v_and_b32 v39, 0xffff0000, v13
  v_lshlrev_b32 v40, 16, v14
  v_and_b32 v41, 0xffff0000, v14
  v_lshlrev_b32 v42, 16, v15
  v_and_b32 v43, 0xffff0000, v15
  v_lshlrev_b32 v44, 16, v16
  v_and_b32 v45, 0xffff0000, v16
  v_lshlrev_b32 v46, 16, v17
  v_and_b32 v47, 0xffff0000, v17
  v_lshlrev_b32 v48, 16, v18
  v_and_b32 v49, 0xffff0000, v18
  v_lshlrev_b32 v50, 16, v19
  v_and_b32 v51, 0xffff0000, v19
  v_pk_mul_f32 v[54:55], v[20:21], v[20:21]
  v_pk_mul_f32 v[58:59], v[36:37], v[36:37]
  v_pk_add_f32 v[52:53], v[20:21], v[22:23]
  v_pk_fma_f32 v[54:55], v[22:23], v[22:23], v[54:55]
  v_pk_add_f32 v[56:57], v[36:37], v[38:39]
  v_pk_fma_f32 v[58:59], v[38:39], v[38:39], v[58:59]
  v_pk_add_f32 v[52:53], v[52:53], v[24:25]
  v_pk_fma_f32 v[54:55], v[24:25], v[24:25], v[54:55]
  v_pk_add_f32 v[56:57], v[56:57], v[40:41]
  v_pk_fma_f32 v[58:59], v[40:41], v[40:41], v[58:59]
  v_pk_add_f32 v[52:53], v[52:53], v[26:27]
  v_pk_fma_f32 v[54:55], v[26:27], v[26:27], v[54:55]
  v_pk_add_f32 v[56:57], v[56:57], v[42:43]
  v_pk_fma_f32 v[58:59], v[42:43], v[42:43], v[58:59]
  v_pk_add_f32 v[52:53], v[52:53], v[28:29]
  v_pk_fma_f32 v[54:55], v[28:29], v[28:29], v[54:55]
  v_pk_add_f32 v[56:57], v[56:57], v[44:45]
  v_pk_fma_f32 v[58:59], v[44:45], v[44:45], v[58:59]
  v_pk_add_f32 v[52:53], v[52:53], v[30:31]
  v_pk_fma_f32 v[54:55], v[30:31], v[30:31], v[54:55]
  v_pk_add_f32 v[56:57], v[56:57], v[46:47]
  v_pk_fma_f32 v[58:59], v[46:47], v[46:47], v[58:59]
  v_pk_add_f32 v[52:53], v[52:53], v[32:33]
  v_pk_fma_f32 v[54:55], v[32:33], v[32:33], v[54:55]
  v_pk_add_f32 v[56:57], v[56:57], v[48:49]
  v_pk_fma_f32 v[58:59], v[48:49], v[48:49], v[58:59]
  v_pk_add_f32 v[52:53], v[52:53], v[34:35]
  v_pk_fma_f32 v[54:55], v[34:35], v[34:35], v[54:55]
  v_pk_add_f32 v[56:57], v[56:57], v[50:51]
  v_pk_fma_f32 v[58:59], v[50:51], v[50:51], v[58:59]
  v_add_f32 v52, v52, v53
  v_add_f32 v54, v54, v55
  v_add_f32 v56, v56, v57
  v_add_f32 v58, v58, v59
  v_add_f32_dpp v52, v52, v52 quad_perm:[1,0,3,2] row_mask:0xf bank_mask:0xf
  v_add_f32_dpp v54, v54, v54 quad_perm:[1,0,3,2] row_mask:0xf bank_mask:0xf
  v_add_f32_dpp v56, v56, v56 quad_perm:[1,0,3,2] row_mask:0xf bank_mask:0xf
  v_add_f32_dpp v58, v58, v58 quad_perm:[1,0,3,2] row_mask:0xf bank_mask:0xf
  v_add_f32_dpp v52, v52, v52 quad_perm:[2,3,0,1] row_mask:0xf bank_mask:0xf
  v_add_f32_dpp v54, v54, v54 quad_perm:[2,3,0,1] row_mask:0xf bank_mask:0xf
  v_add_f32_dpp v56, v56, v56 quad_perm:[2,3,0,1] row_mask:0xf bank_mask:0xf
  v_add_f32_dpp v58, v58, v58 quad_perm:[2,3,0,1] row_mask:0xf bank_mask:0xf
  v_add_f32_dpp v52, v52, v52 row_half_mirror row_mask:0xf bank_mask:0xf
  v_add_f32_dpp v54, v54, v54 row_half_mirror row_mask:0xf bank_mask:0xf
  v_add_f32_dpp v56, v56, v56 row_half_mirror row_mask:0xf bank_mask:0xf
  v_add_f32_dpp v58, v58, v58 row_half_mirror row_mask:0xf bank_mask:0xf
  v_add_f32_dpp v52, v52, v52 row_mirror row_mask:0xf bank_mask:0xf
  v_add_f32_dpp v54, v54, v54 row_mirror row_mask:0xf bank_mask:0xf
  v_add_f32_dpp v56, v56, v56 row_mirror row_mask:0xf bank_mask:0xf
  v_add_f32_dpp v58, v58, v58 row_mirror row_mask:0xf bank_mask:0xf
  v_mov_b32 v53, v52
  v_mov_b32 v55, v54
  v_mov_b32 v57, v56
  v_mov_b32 v59, v58
  v_permlane16_swap_b32 v52, v53
  v_permlane16_swap_b32 v54, v55
  v_permlane16_swap_b32 v56, v57
  v_permlane16_swap_b32 v58, v59
  v_add_f32 v52, v52, v53
  v_add_f32 v54, v54, v55
  v_add_f32 v56, v56, v57
  v_add_f32 v58, v58, v59
  v_mov_b32 v53, v52
  v_mov_b32 v55, v54
  v_mov_b32 v57, v56
  v_mov_b32 v59, v58
  v_permlane32_swap_b32 v52, v53
  v_permlane32_swap_b32 v54, v55
  v_permlane32_swap_b32 v56, v57
  v_permlane32_swap_b32 v58, v59
  v_add_f32 v52, v52, v53
  v_add_f32 v54, v54, v55
  v_add_f32 v56, v56, v57
  v_add_f32 v58, v58, v59
  v_mul_f32 v52, 0x3a800000, v52
  v_mul_f32 v56, 0x3a800000, v56
  v_mul_f32 v53, v52, v52
  v_mul_f32 v57, v56, v56
  v_mul_f32 v54, 0x3a800000, v54
  v_mul_f32 v58, 0x3a800000, v58
  v_sub_f32 v54, v54, v53
  v_sub_f32 v58, v58, v57
  v_max_f32 v54, 0, v54
  v_max_f32 v58, 0, v58
  v_cvt_pk_bf16_f32 v52, v52, v54
  v_cvt_pk_bf16_f32 v56, v56, v58
  v_and_b32 v54, 0xffff0000, v52
  v_and_b32 v58, 0xffff0000, v56
  v_add_f32 v54, 0x3727c5ac, v54
  v_add_f32 v58, 0x3727c5ac, v58
  v_cvt_pk_bf16_f32 v54, v54, v54
  v_cvt_pk_bf16_f32 v58, v58, v58
  v_and_b32 v54, 0xffff0000, v54
  v_and_b32 v58, 0xffff0000, v58
  v_sqrt_f32 v54, v54
  v_sqrt_f32 v58, v58
  v_lshlrev_b32 v52, 16, v52
  v_lshlrev_b32 v56, 16, v56
  v_cvt_pk_bf16_f32 v54, v54, v54
  v_cvt_pk_bf16_f32 v58, v58, v58
  v_and_b32 v54, 0xffff0000, v54
  v_and_b32 v58, 0xffff0000, v58
  v_rcp_f32 v60, v54
  v_rcp_f32 v62, v58
  v_mul_f32 v60, 0x3b000000, v60
  v_mul_f32 v62, 0x3b000000, v62
  v_mul_f32 v52, -v52, v60
  v_mul_f32 v56, -v56, v62
  v_pk_fma_f32 v[20:21], v[20:21], v[60:61], v[52:53] op_sel_hi:[1,0,0]
  v_pk_fma_f32 v[36:37], v[36:37], v[62:63], v[56:57] op_sel_hi:[1,0,0]
  v_pk_add_f32 v[152:153], v[20:21], v[36:37]
  v_pk_add_f32 v[154:155], v[20:21], v[36:37] neg_lo:[0,1] neg_hi:[0,1]
  v_cvt_pk_f16_f32 v192, v152, v154
  v_cvt_pk_f16_f32 v193, v153, v155
  v_pk_fma_f32 v[22:23], v[22:23], v[60:61], v[52:53] op_sel_hi:[1,0,0]
  v_pk_fma_f32 v[38:39], v[38:39], v[62:63], v[56:57] op_sel_hi:[1,0,0]
  v_pk_add_f32 v[156:157], v[22:23], v[38:39]
  v_pk_add_f32 v[158:159], v[22:23], v[38:39] neg_lo:[0,1] neg_hi:[0,1]
  v_cvt_pk_f16_f32 v194, v156, v158
  v_cvt_pk_f16_f32 v195, v157, v159
  ds_write_b128 v208, v[192:195] offset:0
  v_pk_fma_f32 v[24:25], v[24:25], v[60:61], v[52:53] op_sel_hi:[1,0,0]
  v_pk_fma_f32 v[40:41], v[40:41], v[62:63], v[56:57] op_sel_hi:[1,0,0]
  v_pk_add_f32 v[152:153], v[24:25], v[40:41]
  v_pk_add_f32 v[154:155], v[24:25], v[40:41] neg_lo:[0,1] neg_hi:[0,1]
  v_cvt_pk_f16_f32 v196, v152, v154
  v_cvt_pk_f16_f32 v197, v153, v155
  v_pk_fma_f32 v[26:27], v[26:27], v[60:61], v[52:53] op_sel_hi:[1,0,0]
  v_pk_fma_f32 v[42:43], v[42:43], v[62:63], v[56:57] op_sel_hi:[1,0,0]
  v_pk_add_f32 v[156:157], v[26:27], v[42:43]
  v_pk_add_f32 v[158:159], v[26:27], v[42:43] neg_lo:[0,1] neg_hi:[0,1]
  v_cvt_pk_f16_f32 v198, v156, v158
  v_cvt_pk_f16_f32 v199, v157, v159
  ds_write_b128 v208, v[196:199] offset:16
  v_pk_fma_f32 v[28:29], v[28:29], v[60:61], v[52:53] op_sel_hi:[1,0,0]
  v_pk_fma_f32 v[44:45], v[44:45], v[62:63], v[56:57] op_sel_hi:[1,0,0]
  v_pk_add_f32 v[152:153], v[28:29], v[44:45]
  v_pk_add_f32 v[154:155], v[28:29], v[44:45] neg_lo:[0,1] neg_hi:[0,1]
  v_cvt_pk_f16_f32 v200, v152, v154
  v_cvt_pk_f16_f32 v201, v153, v155
  v_pk_fma_f32 v[30:31], v[30:31], v[60:61], v[52:53] op_sel_hi:[1,0,0]
  v_pk_fma_f32 v[46:47], v[46:47], v[62:63], v[56:57] op_sel_hi:[1,0,0]
  v_pk_add_f32 v[156:157], v[30:31], v[46:47]
  v_pk_add_f32 v[158:159], v[30:31], v[46:47] neg_lo:[0,1] neg_hi:[0,1]
  v_cvt_pk_f16_f32 v202, v156, v158
  v_cvt_pk_f16_f32 v203, v157, v159
  ds_write_b128 v208, v[200:203] offset:2048
  v_pk_fma_f32 v[32:33], v[32:33], v[60:61], v[52:53] op_sel_hi:[1,0,0]
  v_pk_fma_f32 v[48:49], v[48:49], v[62:63], v[56:57] op_sel_hi:[1,0,0]
  v_pk_add_f32 v[152:153], v[32:33], v[48:49]
  v_pk_add_f32 v[154:155], v[32:33], v[48:49] neg_lo:[0,1] neg_hi:[0,1]
  v_cvt_pk_f16_f32 v204, v152, v154
  v_cvt_pk_f16_f32 v205, v153, v155
  v_pk_fma_f32 v[34:35], v[34:35], v[60:61], v[52:53] op_sel_hi:[1,0,0]
  v_pk_fma_f32 v[50:51], v[50:51], v[62:63], v[56:57] op_sel_hi:[1,0,0]
  v_pk_add_f32 v[156:157], v[34:35], v[50:51]
  v_pk_add_f32 v[158:159], v[34:35], v[50:51] neg_lo:[0,1] neg_hi:[0,1]
  v_cvt_pk_f16_f32 v206, v156, v158
  v_cvt_pk_f16_f32 v207, v157, v159
  ds_write_b128 v208, v[204:207] offset:2064
  ds_read2st64_b32 v[20:21], v209 offset0:0 offset1:1
  ds_read2st64_b32 v[22:23], v210 offset0:0 offset1:1
  ds_read2st64_b32 v[24:25], v209 offset0:4 offset1:5
  ds_read2st64_b32 v[26:27], v210 offset0:4 offset1:5
  ds_read2st64_b32 v[28:29], v209 offset0:8 offset1:9
  ds_read2st64_b32 v[30:31], v210 offset0:8 offset1:9
  ds_read2st64_b32 v[32:33], v209 offset0:12 offset1:13
  ds_read2st64_b32 v[34:35], v210 offset0:12 offset1:13
  s_waitcnt lgkmcnt(6)
  v_mfma_f32_32x32x16_f16 v[160:175], v[20:23], v[64:67], 0
  v_mfma_f32_32x32x16_f16 v[176:191], v[20:23], v[80:83], 0
  s_waitcnt lgkmcnt(4)
  v_mfma_f32_32x32x16_f16 v[160:175], v[24:27], v[68:71], v[160:175]
  v_mfma_f32_32x32x16_f16 v[176:191], v[24:27], v[84:87], v[176:191]
  s_waitcnt lgkmcnt(2)
  v_mfma_f32_32x32x16_f16 v[160:175], v[28:31], v[72:75], v[160:175]
  v_mfma_f32_32x32x16_f16 v[176:191], v[28:31], v[88:91], v[176:191]
  s_waitcnt lgkmcnt(0)
  v_mfma_f32_32x32x16_f16 v[160:175], v[32:35], v[76:79], v[160:175]
  v_mfma_f32_32x32x16_f16 v[176:191], v[32:35], v[92:95], v[176:191]
  s_nop 10
  v_pk_mul_f32 v[152:153], v[160:161], v[96:97]
  v_pk_mul_f32 v[154:155], v[176:177], v[96:97]
  v_pk_fma_f32 v[152:153], v[176:177], v[112:113], v[152:153]
  v_pk_fma_f32 v[154:155], v[160:161], v[112:113], v[154:155] neg_lo:[1,0,0] neg_hi:[1,0,0]
  v_cvt_pk_f16_f32 v192, v152, v153
  v_cvt_pk_f16_f32 v200, v154, v155
  v_pk_mul_f32 v[156:157], v[162:163], v[98:99]
  v_pk_mul_f32 v[158:159], v[178:179], v[98:99]
  v_pk_fma_f32 v[156:157], v[178:179], v[114:115], v[156:157]
  v_pk_fma_f32 v[158:159], v[162:163], v[114:115], v[158:159] neg_lo:[1,0,0] neg_hi:[1,0,0]
  v_cvt_pk_f16_f32 v193, v156, v157
  v_cvt_pk_f16_f32 v201, v158, v159
  v_pk_mul_f32 v[152:153], v[164:165], v[100:101]
  v_pk_mul_f32 v[154:155], v[180:181], v[100:101]
  v_pk_fma_f32 v[152:153], v[180:181], v[116:117], v[152:153]
  v_pk_fma_f32 v[154:155], v[164:165], v[116:117], v[154:155] neg_lo:[1,0,0] neg_hi:[1,0,0]
  v_cvt_pk_f16_f32 v194, v152, v153
  v_cvt_pk_f16_f32 v202, v154, v155
  v_pk_mul_f32 v[156:157], v[166:167], v[102:103]
  v_pk_mul_f32 v[158:159], v[182:183], v[102:103]
  v_pk_fma_f32 v[156:157], v[182:183], v[118:119], v[156:157]
  v_pk_fma_f32 v[158:159], v[166:167], v[118:119], v[158:159] neg_lo:[1,0,0] neg_hi:[1,0,0]
  v_cvt_pk_f16_f32 v195, v156, v157
  v_cvt_pk_f16_f32 v203, v158, v159
  v_pk_mul_f32 v[152:153], v[168:169], v[104:105]
  v_pk_mul_f32 v[154:155], v[184:185], v[104:105]
  v_pk_fma_f32 v[152:153], v[184:185], v[120:121], v[152:153]
  v_pk_fma_f32 v[154:155], v[168:169], v[120:121], v[154:155] neg_lo:[1,0,0] neg_hi:[1,0,0]
  v_cvt_pk_f16_f32 v196, v152, v153
  v_cvt_pk_f16_f32 v204, v154, v155
  v_pk_mul_f32 v[156:157], v[170:171], v[106:107]
  v_pk_mul_f32 v[158:159], v[186:187], v[106:107]
  v_pk_fma_f32 v[156:157], v[186:187], v[122:123], v[156:157]
  v_pk_fma_f32 v[158:159], v[170:171], v[122:123], v[158:159] neg_lo:[1,0,0] neg_hi:[1,0,0]
  v_cvt_pk_f16_f32 v197, v156, v157
  v_cvt_pk_f16_f32 v205, v158, v159
  v_pk_mul_f32 v[152:153], v[172:173], v[108:109]
  v_pk_mul_f32 v[154:155], v[188:189], v[108:109]
  v_pk_fma_f32 v[152:153], v[188:189], v[124:125], v[152:153]
  v_pk_fma_f32 v[154:155], v[172:173], v[124:125], v[154:155] neg_lo:[1,0,0] neg_hi:[1,0,0]
  v_cvt_pk_f16_f32 v198, v152, v153
  v_cvt_pk_f16_f32 v206, v154, v155
  v_pk_mul_f32 v[156:157], v[174:175], v[110:111]
  v_pk_mul_f32 v[158:159], v[190:191], v[110:111]
  v_pk_fma_f32 v[156:157], v[190:191], v[126:127], v[156:157]
  v_pk_fma_f32 v[158:159], v[174:175], v[126:127], v[158:159] neg_lo:[1,0,0] neg_hi:[1,0,0]
  v_cvt_pk_f16_f32 v199, v156, v157
  v_cvt_pk_f16_f32 v207, v158, v159
  v_mfma_f32_32x32x16_f16 v[160:175], v[128:131], v[192:195], 0
  v_mfma_f32_32x32x16_f16 v[176:191], v[128:131], v[200:203], 0
  v_mfma_f32_32x32x16_f16 v[160:175], v[132:135], v[196:199], v[160:175]
  v_mfma_f32_32x32x16_f16 v[176:191], v[132:135], v[204:207], v[176:191]
  v_mfma_f32_32x32x16_f16 v[160:175], v[136:139], v[200:203], v[160:175]
  v_mfma_f32_32x32x16_f16 v[176:191], v[144:147], v[192:195], v[176:191]
  v_mfma_f32_32x32x16_f16 v[160:175], v[140:143], v[204:207], v[160:175]
  v_mfma_f32_32x32x16_f16 v[176:191], v[148:151], v[196:199], v[176:191]
  s_nop 11
  v_cvt_pk_f16_f32 v192, v160, v176
  v_cvt_pk_f16_f32 v193, v161, v177
  v_cvt_pk_f16_f32 v194, v162, v178
  v_cvt_pk_f16_f32 v195, v163, v179
  ds_write2st64_b32 v209, v192, v194 offset0:0 offset1:1
  ds_write2st64_b32 v210, v193, v195 offset0:0 offset1:1
  v_cvt_pk_f16_f32 v196, v164, v180
  v_cvt_pk_f16_f32 v197, v165, v181
  v_cvt_pk_f16_f32 v198, v166, v182
  v_cvt_pk_f16_f32 v199, v167, v183
  ds_write2st64_b32 v209, v196, v198 offset0:4 offset1:5
  ds_write2st64_b32 v210, v197, v199 offset0:4 offset1:5
  v_cvt_pk_f16_f32 v200, v168, v184
  v_cvt_pk_f16_f32 v201, v169, v185
  v_cvt_pk_f16_f32 v202, v170, v186
  v_cvt_pk_f16_f32 v203, v171, v187
  ds_write2st64_b32 v209, v200, v202 offset0:8 offset1:9
  ds_write2st64_b32 v210, v201, v203 offset0:8 offset1:9
  v_cvt_pk_f16_f32 v204, v172, v188
  v_cvt_pk_f16_f32 v205, v173, v189
  v_cvt_pk_f16_f32 v206, v174, v190
  v_cvt_pk_f16_f32 v207, v175, v191
  ds_write2st64_b32 v209, v204, v206 offset0:12 offset1:13
  ds_write2st64_b32 v210, v205, v207 offset0:12 offset1:13
  s_waitcnt lgkmcnt(0)
  s_barrier
  ds_read2st64_b32 v[20:21], v212 offset0:0 offset1:16
  ds_read2st64_b32 v[24:25], v214 offset0:0 offset1:16
  ds_read2st64_b32 v[22:23], v212 offset0:32 offset1:48
  ds_read2st64_b32 v[26:27], v214 offset0:32 offset1:48
  ds_read2st64_b32 v[28:29], v213 offset0:0 offset1:16
  ds_read2st64_b32 v[32:33], v215 offset0:0 offset1:16
  ds_read2st64_b32 v[30:31], v213 offset0:32 offset1:48
  ds_read2st64_b32 v[34:35], v215 offset0:32 offset1:48
  ds_read2st64_b32 v[36:37], v212 offset0:1 offset1:17
  ds_read2st64_b32 v[40:41], v216 offset0:0 offset1:16
  ds_read2st64_b32 v[38:39], v212 offset0:33 offset1:49
  ds_read2st64_b32 v[42:43], v216 offset0:32 offset1:48
  s_waitcnt lgkmcnt(8)
  ds_read2st64_b32 v[44:45], v213 offset0:1 offset1:17
  ds_read2st64_b32 v[48:49], v217 offset0:0 offset1:16
  ds_read2st64_b32 v[46:47], v213 offset0:33 offset1:49
  ds_read2st64_b32 v[50:51], v217 offset0:32 offset1:48
  v_perm_b32 v80, v24, v20, v218
  v_pk_add_f16 v64, v20, v24 neg_hi:[0,1]
  v_pk_add_f16 v20, v20, v24 op_sel:[1,1] op_sel_hi:[0,0] neg_hi:[1,0]
  v_pk_add_f16 v80, v80, v80
  v_cndmask_b32 v64, v20, v64, vcc
  v_cndmask_b32 v64, v64, v80, s[36:37]
  v_pk_mul_f16 v20, v64, v224
  v_pk_fma_f16 v64, v64, v228, v20 op_sel:[1,0,0] op_sel_hi:[0,1,1]
  v_and_b32 v64, -2, v64
  v_perm_b32 v81, v25, v21, v218
  v_pk_add_f16 v65, v21, v25 neg_hi:[0,1]
  v_pk_add_f16 v21, v21, v25 op_sel:[1,1] op_sel_hi:[0,0] neg_hi:[1,0]
  v_pk_add_f16 v81, v81, v81
  v_cndmask_b32 v65, v21, v65, vcc
  v_cndmask_b32 v65, v65, v81, s[36:37]
  v_pk_mul_f16 v21, v65, v225
  v_pk_fma_f16 v65, v65, v229, v21 op_sel:[1,0,0] op_sel_hi:[0,1,1]
  v_and_b32 v65, -2, v65
  v_perm_b32 v82, v26, v22, v218
  v_pk_add_f16 v66, v22, v26 neg_hi:[0,1]
  v_pk_add_f16 v22, v22, v26 op_sel:[1,1] op_sel_hi:[0,0] neg_hi:[1,0]
  v_pk_add_f16 v82, v82, v82
  v_cndmask_b32 v66, v22, v66, vcc
  v_cndmask_b32 v66, v66, v82, s[36:37]
  v_pk_mul_f16 v22, v66, v226
  v_pk_fma_f16 v66, v66, v230, v22 op_sel:[1,0,0] op_sel_hi:[0,1,1]
  v_and_b32 v66, -2, v66
  v_perm_b32 v83, v27, v23, v218
  v_pk_add_f16 v67, v23, v27 neg_hi:[0,1]
  v_pk_add_f16 v23, v23, v27 op_sel:[1,1] op_sel_hi:[0,0] neg_hi:[1,0]
  v_pk_add_f16 v83, v83, v83
  v_cndmask_b32 v67, v23, v67, vcc
  v_cndmask_b32 v67, v67, v83, s[36:37]
  v_pk_mul_f16 v23, v67, v227
  v_pk_fma_f16 v67, v67, v231, v23 op_sel:[1,0,0] op_sel_hi:[0,1,1]
  v_and_b32 v67, -2, v67
  buffer_store_dwordx4 v[64:67], v211, s[32:35], s56 offen sc1
  s_waitcnt lgkmcnt(8)
  v_pk_add_f16 v68, v28, v32 neg_hi:[0,1]
  v_pk_add_f16 v28, v28, v32 op_sel:[1,1] op_sel_hi:[0,0] neg_hi:[1,0]
  v_cndmask_b32 v68, v28, v68, vcc
  v_pk_mul_f16 v28, v68, v224
  v_pk_fma_f16 v68, v68, v228, v28 op_sel:[1,0,0] op_sel_hi:[0,1,1]
  v_and_b32 v68, -2, v68
  v_pk_add_f16 v69, v29, v33 neg_hi:[0,1]
  v_pk_add_f16 v29, v29, v33 op_sel:[1,1] op_sel_hi:[0,0] neg_hi:[1,0]
  v_cndmask_b32 v69, v29, v69, vcc
  v_pk_mul_f16 v29, v69, v225
  v_pk_fma_f16 v69, v69, v229, v29 op_sel:[1,0,0] op_sel_hi:[0,1,1]
  v_and_b32 v69, -2, v69
  v_pk_add_f16 v70, v30, v34 neg_hi:[0,1]
  v_pk_add_f16 v30, v30, v34 op_sel:[1,1] op_sel_hi:[0,0] neg_hi:[1,0]
  v_cndmask_b32 v70, v30, v70, vcc
  v_pk_mul_f16 v30, v70, v226
  v_pk_fma_f16 v70, v70, v230, v30 op_sel:[1,0,0] op_sel_hi:[0,1,1]
  v_and_b32 v70, -2, v70
  v_pk_add_f16 v71, v31, v35 neg_hi:[0,1]
  v_pk_add_f16 v31, v31, v35 op_sel:[1,1] op_sel_hi:[0,0] neg_hi:[1,0]
  v_cndmask_b32 v71, v31, v71, vcc
  v_pk_mul_f16 v31, v71, v227
  v_pk_fma_f16 v71, v71, v231, v31 op_sel:[1,0,0] op_sel_hi:[0,1,1]
  v_and_b32 v71, -2, v71
  buffer_store_dwordx4 v[68:71], v211, s[32:35], s57 offen sc1
  s_waitcnt lgkmcnt(4)
  v_pk_add_f16 v72, v36, v40 neg_hi:[0,1]
  v_pk_add_f16 v36, v36, v40 op_sel:[1,1] op_sel_hi:[0,0] neg_hi:[1,0]
  v_cndmask_b32 v72, v36, v72, vcc
  v_pk_mul_f16 v36, v72, v224
  v_pk_fma_f16 v72, v72, v228, v36 op_sel:[1,0,0] op_sel_hi:[0,1,1]
  v_and_b32 v72, -2, v72
  v_pk_add_f16 v73, v37, v41 neg_hi:[0,1]
  v_pk_add_f16 v37, v37, v41 op_sel:[1,1] op_sel_hi:[0,0] neg_hi:[1,0]
  v_cndmask_b32 v73, v37, v73, vcc
  v_pk_mul_f16 v37, v73, v225
  v_pk_fma_f16 v73, v73, v229, v37 op_sel:[1,0,0] op_sel_hi:[0,1,1]
  v_and_b32 v73, -2, v73
  v_pk_add_f16 v74, v38, v42 neg_hi:[0,1]
  v_pk_add_f16 v38, v38, v42 op_sel:[1,1] op_sel_hi:[0,0] neg_hi:[1,0]
  v_cndmask_b32 v74, v38, v74, vcc
  v_pk_mul_f16 v38, v74, v226
  v_pk_fma_f16 v74, v74, v230, v38 op_sel:[1,0,0] op_sel_hi:[0,1,1]
  v_and_b32 v74, -2, v74
  v_pk_add_f16 v75, v39, v43 neg_hi:[0,1]
  v_pk_add_f16 v39, v39, v43 op_sel:[1,1] op_sel_hi:[0,0] neg_hi:[1,0]
  v_cndmask_b32 v75, v39, v75, vcc
  v_pk_mul_f16 v39, v75, v227
  v_pk_fma_f16 v75, v75, v231, v39 op_sel:[1,0,0] op_sel_hi:[0,1,1]
  v_and_b32 v75, -2, v75
  buffer_store_dwordx4 v[72:75], v211, s[32:35], s58 offen sc1
  s_waitcnt lgkmcnt(0)
  v_pk_add_f16 v76, v44, v48 neg_hi:[0,1]
  v_pk_add_f16 v44, v44, v48 op_sel:[1,1] op_sel_hi:[0,0] neg_hi:[1,0]
  v_cndmask_b32 v76, v44, v76, vcc
  v_pk_mul_f16 v44, v76, v224
  v_pk_fma_f16 v76, v76, v228, v44 op_sel:[1,0,0] op_sel_hi:[0,1,1]
  v_and_b32 v76, -2, v76
  v_pk_add_f16 v77, v45, v49 neg_hi:[0,1]
  v_pk_add_f16 v45, v45, v49 op_sel:[1,1] op_sel_hi:[0,0] neg_hi:[1,0]
  v_cndmask_b32 v77, v45, v77, vcc
  v_pk_mul_f16 v45, v77, v225
  v_pk_fma_f16 v77, v77, v229, v45 op_sel:[1,0,0] op_sel_hi:[0,1,1]
  v_and_b32 v77, -2, v77
  v_pk_add_f16 v78, v46, v50 neg_hi:[0,1]
  v_pk_add_f16 v46, v46, v50 op_sel:[1,1] op_sel_hi:[0,0] neg_hi:[1,0]
  v_cndmask_b32 v78, v46, v78, vcc
  v_pk_mul_f16 v46, v78, v226
  v_pk_fma_f16 v78, v78, v230, v46 op_sel:[1,0,0] op_sel_hi:[0,1,1]
  v_and_b32 v78, -2, v78
  v_pk_add_f16 v79, v47, v51 neg_hi:[0,1]
  v_pk_add_f16 v47, v47, v51 op_sel:[1,1] op_sel_hi:[0,0] neg_hi:[1,0]
  v_cndmask_b32 v79, v47, v79, vcc
  v_pk_mul_f16 v47, v79, v227
  v_pk_fma_f16 v79, v79, v231, v47 op_sel:[1,0,0] op_sel_hi:[0,1,1]
  v_and_b32 v79, -2, v79
  buffer_store_dwordx4 v[76:79], v211, s[32:35], s59 offen sc1
  s_endpgm
L_f1_filter:
  v_lshlrev_b32 v2, 2, v1
  s_mul_i32 s40, s16, 2052
  s_add_u32 s41, s40, 65664
  s_add_u32 s42, s41, 65664
  s_add_u32 s43, s42, 65664
  v_and_b32 v3, 3, v0
  v_mul_u32_u24 v4, 65664, v3
  v_lshrrev_b32 v5, 2, v0
  v_xor_b32 v5, s18, v5
  v_and_b32 v5, 1, v5
  v_mul_u32_u24 v6, 1026, v5
  v_add3_u32 v4, v4, v6, s40
  v_sub_u32 v6, 2101248, v4
  v_cmp_eq_u32 vcc, 0, v4
  s_nop 1
  v_cndmask_b32 v6, v6, v4, vcc
  v_cmp_gt_u32 vcc, 32, v1
  v_mov_b32 v7, 0x7fff0000
  s_nop 0
  v_cndmask_b32 v4, v7, v4, vcc
  v_cndmask_b32 v49, v7, v6, vcc
  s_waitcnt lgkmcnt(0)
  s_mov_b32 s24, s6
  s_and_b32 s25, s7, 0xffff
  s_mov_b32 s26, 2101248
  s_mov_b32 s27, 0x20000
  s_mov_b32 s28, s8
  s_and_b32 s29, s9, 0xffff
  s_mov_b32 s30, 2101248
  s_mov_b32 s31, 0x20000
  buffer_load_ushort v50, v4, s[24:27], 0 offen offset:0
  buffer_load_ushort v51, v49, s[24:27], 0 offen offset:0
  buffer_load_ushort v52, v4, s[24:27], 0 offen offset:1024
  buffer_load_ushort v53, v49, s[24:27], 0 offen offset:1024
  buffer_load_ushort v54, v4, s[28:31], 0 offen offset:0
  buffer_load_ushort v55, v49, s[28:31], 0 offen offset:0
  buffer_load_ushort v56, v4, s[28:31], 0 offen offset:1024
  buffer_load_ushort v57, v49, s[28:31], 0 offen offset:1024
  s_waitcnt vmcnt(0)
  buffer_load_dword v8, v2, s[24:27], s40 offen offset:0
  buffer_load_dword v9, v2, s[24:27], s41 offen offset:0
  buffer_load_dword v10, v2, s[24:27], s42 offen offset:0
  buffer_load_dword v11, v2, s[24:27], s43 offen offset:0
  buffer_load_dword v16, v2, s[28:31], s40 offen offset:0
  buffer_load_dword v17, v2, s[28:31], s41 offen offset:0
  buffer_load_dword v18, v2, s[28:31], s42 offen offset:0
  buffer_load_dword v19, v2, s[28:31], s43 offen offset:0
  buffer_load_dword v12, v2, s[24:27], s40 offen offset:1026
  buffer_load_dword v13, v2, s[24:27], s41 offen offset:1026
  buffer_load_dword v14, v2, s[24:27], s42 offen offset:1026
  buffer_load_dword v15, v2, s[24:27], s43 offen offset:1026
  buffer_load_dword v20, v2, s[28:31], s40 offen offset:1026
  buffer_load_dword v21, v2, s[28:31], s41 offen offset:1026
  buffer_load_dword v22, v2, s[28:31], s42 offen offset:1026
  buffer_load_dword v23, v2, s[28:31], s43 offen offset:1026
  s_getpc_b64 s[70:71]
L_pc_next:
  s_add_u32 s70, s70, main_kernel-L_pc_next
  s_addc_u32 s71, s71, 0
  v_lshlrev_b32 v70, 6, v1
  v_min_u32 v70, L_f2_end-main_kernel, v70
  v_mov_b32 v71, 0
  v_lshl_add_u64 v[70:71], v[70:71], 0, s[70:71]
  global_load_dword v70, v[70:71], off
  v_lshlrev_b32 v72, 6, v1
  v_add_u32 v72, 16384, v72
  v_min_u32 v72, L_f2_end-main_kernel, v72
  v_mov_b32 v73, 0
  v_lshl_add_u64 v[72:73], v[72:73], 0, s[70:71]
  global_load_dword v72, v[72:73], off
  v_lshlrev_b32 v74, 6, v1
  v_add_u32 v74, 32768, v74
  v_min_u32 v74, L_f2_end-main_kernel, v74
  v_mov_b32 v75, 0
  v_lshl_add_u64 v[74:75], v[74:75], 0, s[70:71]
  global_load_dword v74, v[74:75], off
  s_add_u32 s32, s10, 4194304
  s_addc_u32 s33, s11, 0
  s_and_b32 s33, s33, 0xffff
  s_lshl_b32 s38, s13, 12
  v_bfe_u32 v42, v0, 1, 2
  v_lshlrev_b32 v42, 4, v42
  v_lshl_add_u32 v42, v0, 6, v42
  v_add_u32 v42, s38, v42
  v_bfe_u32 v43, v0, 3, 2
  v_xor_b32 v43, v43, v3
  v_xor_b32 v43, s18, v43
  v_lshlrev_b32 v43, 4, v43
  v_and_b32 v6, 60, v0
  v_lshl_add_u32 v43, v6, 4, v43
  v_add_u32 v43, s38, v43
  v_lshrrev_b32 v6, 3, v0
  v_mul_u32_u24 v6, 32768, v6
  v_and_b32 v44, 7, v0
  v_lshl_add_u32 v44, v44, 4, v6
  v_lshlrev_b32 v58, 4, v5
  v_lshl_add_u32 v58, v3, 2, v58
  v_mov_b32 v5, 16384
  v_cndmask_b32 v58, v5, v58, vcc
  v_lshlrev_b32 v59, 2, v0
  v_add_u32 v59, 16512, v59
  v_mov_b32 v5, 16384
  v_cndmask_b32 v59, v5, v59, vcc
  v_and_b32 v60, 7, v0
  v_lshlrev_b32 v60, 4, v60
  s_mul_i32 s60, s12, 4224
  v_add_u32 v5, 4718592, v60
  v_add_u32 v60, 16512, v60
  v_cmp_gt_u32 vcc, 8, v1
  s_nop 1
  v_cndmask_b32 v45, v7, v5, vcc
  s_mov_b32 s36, 0x05040100
  s_mov_b32 s37, 0x07060302
  s_waitcnt vmcnt(19)
  v_lshlrev_b32 v50, 16, v50
  v_lshlrev_b32 v51, 16, v51
  v_lshlrev_b32 v52, 16, v52
  v_lshlrev_b32 v53, 16, v53
  v_lshlrev_b32 v54, 16, v54
  v_lshlrev_b32 v55, 16, v55
  v_lshlrev_b32 v56, 16, v56
  v_lshlrev_b32 v57, 16, v57
  v_add_f32 v50, v50, v51
  v_add_f32 v52, v52, v53
  v_sub_f32 v54, v54, v55
  v_sub_f32 v56, v56, v57
  v_add_f32 v51, v50, v52
  v_sub_f32 v53, v50, v52
  v_add_f32 v55, v54, v56
  v_sub_f32 v57, v54, v56
  v_mul_f32 v51, 0x3e800000, v51
  v_mul_f32 v53, 0x3e800000, v53
  v_mul_f32 v55, 0x3e800000, v55
  v_mul_f32 v57, 0x3e800000, v57
  v_cvt_pk_bf16_f32 v40, v51, v55
  v_cvt_pk_bf16_f32 v41, v53, v57
  ds_write_b32 v59, v41
  ds_read_b128 v[52:55], v60
  s_waitcnt lgkmcnt(0)
  buffer_store_dwordx4 v[52:55], v45, s[32:35], s60 offen sc1
  s_waitcnt vmcnt(12)
  v_perm_b32 v24, v16, v8, s36
  v_perm_b32 v25, v17, v9, s36
  v_perm_b32 v26, v18, v10, s36
  v_perm_b32 v27, v19, v11, s36
  ds_write_b128 v42, v[24:27]
  v_perm_b32 v32, v16, v8, s37
  v_perm_b32 v33, v17, v9, s37
  v_perm_b32 v34, v18, v10, s37
  v_perm_b32 v35, v19, v11, s37
  v_xor_b32 v6, 32, v42
  ds_write_b128 v6, v[32:35]
  s_waitcnt vmcnt(4)
  v_perm_b32 v28, v20, v12, s36
  v_perm_b32 v29, v21, v13, s36
  v_perm_b32 v30, v22, v14, s36
  v_perm_b32 v31, v23, v15, s36
  v_xor_b32 v6, 16, v42
  ds_write_b128 v6, v[28:31]
  v_perm_b32 v36, v20, v12, s37
  v_perm_b32 v37, v21, v13, s37
  v_perm_b32 v38, v22, v14, s37
  v_perm_b32 v39, v23, v15, s37
  v_xor_b32 v6, 48, v42
  ds_write_b128 v6, v[36:39]
  ds_write_b32 v58, v40
  ds_read_b128 v[8:11], v43 offset:0
  ds_read_b128 v[12:15], v43 offset:1024
  ds_read_b128 v[16:19], v43 offset:2048
  ds_read_b128 v[20:23], v43 offset:3072
  s_waitcnt lgkmcnt(3)
  buffer_store_dwordx4 v[8:11], v44, s[32:35], s56 offen sc1
  s_waitcnt lgkmcnt(2)
  buffer_store_dwordx4 v[12:15], v44, s[32:35], s57 offen sc1
  s_waitcnt lgkmcnt(1)
  buffer_store_dwordx4 v[16:19], v44, s[32:35], s58 offen
  s_waitcnt lgkmcnt(0)
  buffer_store_dwordx4 v[20:23], v44, s[32:35], s59 offen
L_f1_end:
  s_endpgm
.globl main_kernel
.p2align 8
.type main_kernel,@function
main_kernel:
  s_cmp_ge_u32 s2, 256
  s_cbranch_scc1 L_f2_end
  s_load_dwordx2 s[10:11], s[0:1], 72
  s_load_dwordx2 s[4:5], s[0:1], 0
  s_load_dwordx4 s[48:51], s[0:1], 32
  s_load_dwordx2 s[66:67], s[0:1], 32
  s_load_dwordx2 s[68:69], s[0:1], 40
  s_load_dwordx2 s[72:73], s[0:1], 48
  s_load_dwordx2 s[94:95], s[0:1], 56
  v_lshrrev_b32 v2, 6, v0
  v_and_b32 v0, 63, v0
  v_lshlrev_b32 v1, 4, v0
  v_readfirstlane_b32 s13, v2
  s_and_b32 s12, s2, 0x1f0
  s_and_b32 s14, s2, 7
  s_lshl_b32 s14, s14, 1
  s_add_u32 s12, s12, s14
  s_bfe_u32 s14, s2, 0x10003
  s_add_u32 s12, s12, s14
  s_lshr_b32 s15, s12, 1
  s_mul_i32 s15, s15, 32768
  s_lshl_b32 s14, s14, 6
  s_add_u32 s14, s14, s15
  s_lshl_b32 s15, s13, 13
  s_add_u32 s14, s14, s15
  s_lshl_b32 s15, s13, 12
  s_add_u32 s15, s15, 57344
  s_mov_b32 m0, s15
  v_and_b32 v216, 60, v0
  v_lshl_add_u32 v216, v216, 4, v1
  s_mov_b32 s22, 10485760
  s_mov_b32 s23, 0x20000
  s_waitcnt lgkmcnt(0)
  s_add_u32 s20, s10, 0
  s_addc_u32 s21, s11, 0
  s_and_b32 s21, s21, 0xffff
  buffer_load_dwordx4 v216, s[20:23], s14 offen offset:0  lds
  s_add_u32 s14, s14, 1024
  buffer_load_dwordx4 v216, s[20:23], s14 offen offset:1024  lds
  s_add_u32 s14, s14, 1024
  buffer_load_dwordx4 v216, s[20:23], s14 offen offset:2048  lds
  s_add_u32 s14, s14, 1024
  buffer_load_dwordx4 v216, s[20:23], s14 offen offset:3072  lds
  s_add_u32 s14, s14, 1024
  s_add_u32 m0, s15, 16384
  s_add_u32 s14, s14, 4190208
  buffer_load_dwordx4 v216, s[20:23], s14 offen offset:0  lds
  s_add_u32 s14, s14, 1024
  buffer_load_dwordx4 v216, s[20:23], s14 offen offset:1024  lds
  s_add_u32 s14, s14, 1024
  buffer_load_dwordx4 v216, s[20:23], s14 offen offset:2048  lds
  s_add_u32 s14, s14, 1024
  buffer_load_dwordx4 v216, s[20:23], s14 offen offset:3072  lds
  s_add_u32 s14, s14, 1024
  s_lshl_b32 s19, s12, 2
  s_add_u32 s19, s19, s13
  v_bfe_u32 v217, v0, 2, 2
  v_xor_b32 v217, s13, v217
  v_lshlrev_b32 v217, 4, v217
  s_movk_i32 s16, 4224
  v_mad_u32_u24 v217, v0, s16, v217
  s_mov_b32 s28, 8912896
  s_and_b32 s16, s2, 7
  s_lshl_b32 s16, s16, 5
  s_lshr_b32 s17, s2, 3
  s_add_u32 s16, s16, s17
  s_mul_i32 s16, s16, 4224
  s_add_u32 s16, s16, 8914944
  v_mov_b64 v[8:9], 0
  v_mov_b64 v[10:11], 0
  s_mov_b64 exec, 0xff
  buffer_store_dwordx4 v[8:11], v1, s[20:23], s16 offen sc1
  s_mov_b64 exec, -1
  s_add_u32 s24, s10, 0
  s_addc_u32 s25, s11, 0
  s_and_b32 s25, s25, 0xffff
  s_mov_b32 s26, 4194304
  s_mov_b32 s27, 0x20000
  v_mul_u32_u24 v248, 0x2493, v0
  v_lshrrev_b32 v248, 16, v248
  v_mad_i32_i24 v249, v248, -7, v0
  v_min_u32 v248, 1, v248
  v_mul_u32_u24 v248, 7168, v248
  v_lshl_add_u32 v248, v249, 7, v248
  s_lshr_b32 s52, s2, 3
  s_and_b32 s52, s52, 31
  s_lshl_b32 s52, s52, 2
  s_add_u32 s52, s52, s13
  s_mul_i32 s52, s52, 14336
  s_and_b32 s53, s2, 7
  s_mul_i32 s53, s53, 896
  s_add_u32 s52, s52, s53
  s_add_u32 s52, s52, 0
  s_mov_b32 s44, s48
  s_and_b32 s45, s49, 0xffff
  s_mov_b32 s46, 7340032
  s_mov_b32 s47, 0x20000
  s_mov_b32 s48, s50
  s_and_b32 s49, s51, 0xffff
  s_mov_b32 s50, 7340032
  s_mov_b32 s51, 0x20000
  s_and_b32 s17, s13, 1
  v_and_b32 v6, 31, v0
  v_cvt_f32_u32 v2, v6
  v_lshrrev_b32 v7, 5, v0
  v_lshlrev_b32 v3, 2, v7
  v_cvt_f32_u32 v3, v3
  v_lshl_add_u32 v4, v6, 1, s17
  v_cvt_f32_u32 v4, v4
  v_lshl_add_u32 v5, v7, 3, s17
  v_cvt_f32_u32 v5, v5
  v_mul_f32 v6, 0x3a800000, v2
  v_mul_f32 v7, v3, v6
  s_cmp_lt_u32 s19, 2
  s_cbranch_scc0 L_f2_nobeta0
  buffer_load_dwordx4 a[0:3], v217, s[20:23], s28 offen
  s_add_u32 s28, s28, 270336
L_f2_nobeta0:
  v_mov_b32 v160, v7
  v_cos_f32 v72, v160
  v_sin_f32 v88, v160
  v_fmamk_f32 v161, v6, 0x3f800000, v7
  v_cos_f32 v73, v161
  v_sin_f32 v89, v161
  v_fmamk_f32 v160, v6, 0x40000000, v7
  v_cos_f32 v74, v160
  v_sin_f32 v90, v160
  v_fmamk_f32 v161, v6, 0x40400000, v7
  v_cos_f32 v75, v161
  v_sin_f32 v91, v161
  v_fmamk_f32 v160, v6, 0x41000000, v7
  v_cos_f32 v76, v160
  v_sin_f32 v92, v160
  v_fmamk_f32 v161, v6, 0x41100000, v7
  v_cos_f32 v77, v161
  v_sin_f32 v93, v161
  v_fmamk_f32 v160, v6, 0x41200000, v7
  v_cos_f32 v78, v160
  v_sin_f32 v94, v160
  v_fmamk_f32 v161, v6, 0x41300000, v7
  v_cos_f32 v79, v161
  v_sin_f32 v95, v161
  v_fmamk_f32 v160, v6, 0x41800000, v7
  v_cos_f32 v80, v160
  v_sin_f32 v96, v160
  v_fmamk_f32 v161, v6, 0x41880000, v7
  v_cos_f32 v81, v161
  v_sin_f32 v97, v161
  v_fmamk_f32 v160, v6, 0x41900000, v7
  v_cos_f32 v82, v160
  v_sin_f32 v98, v160
  v_fmamk_f32 v161, v6, 0x41980000, v7
  v_cos_f32 v83, v161
  v_sin_f32 v99, v161
  v_fmamk_f32 v160, v6, 0x41c00000, v7
  v_cos_f32 v84, v160
  v_sin_f32 v100, v160
  v_fmamk_f32 v161, v6, 0x41c80000, v7
  v_cos_f32 v85, v161
  v_sin_f32 v101, v161
  v_fmamk_f32 v160, v6, 0x41d00000, v7
  v_cos_f32 v86, v160
  v_sin_f32 v102, v160
  v_fmamk_f32 v161, v6, 0x41d80000, v7
  v_cos_f32 v87, v161
  v_sin_f32 v103, v161
  s_cmp_lt_u32 s19, 2
  s_cbranch_scc0 L_f2_nobeta1
  buffer_load_dwordx4 a[4:7], v217, s[20:23], s28 offen
  s_add_u32 s28, s28, 270336
  buffer_load_dwordx4 a[8:11], v217, s[20:23], s28 offen
  s_add_u32 s28, s28, 270336
L_f2_nobeta1:
  v_mul_f32 v6, 0x3d000000, v2
  v_mul_f32 v7, v3, v6
  v_mov_b32 v160, v7
  v_cos_f32 v161, v160
  v_sin_f32 v162, v160
  v_fmamk_f32 v163, v6, 0x3f800000, v7
  v_cos_f32 v164, v163
  v_sin_f32 v165, v163
  s_nop 0
  v_cvt_pk_f16_f32 v40, v161, v162
  v_cvt_pk_f16_f32 v56, -v162, v161
  v_cvt_pk_f16_f32 v41, v164, v165
  v_cvt_pk_f16_f32 v57, -v165, v164
  v_cvt_pk_f16_f32 v136, v161, v164
  v_cvt_pk_f16_f32 v144, v162, v165
  v_cvt_pk_f16_f32 v152, -v162, -v165
  v_cvt_pk_bf16_f32 v168, v161, v164
  v_cvt_pk_bf16_f32 v176, v162, v165
  v_cvt_pk_bf16_f32 v184, -v162, -v165
  v_fmamk_f32 v160, v6, 0x40000000, v7
  v_cos_f32 v161, v160
  v_sin_f32 v162, v160
  v_fmamk_f32 v163, v6, 0x40400000, v7
  v_cos_f32 v164, v163
  v_sin_f32 v165, v163
  s_nop 0
  v_cvt_pk_f16_f32 v42, v161, v162
  v_cvt_pk_f16_f32 v58, -v162, v161
  v_cvt_pk_f16_f32 v43, v164, v165
  v_cvt_pk_f16_f32 v59, -v165, v164
  v_cvt_pk_f16_f32 v137, v161, v164
  v_cvt_pk_f16_f32 v145, v162, v165
  v_cvt_pk_f16_f32 v153, -v162, -v165
  v_cvt_pk_bf16_f32 v169, v161, v164
  v_cvt_pk_bf16_f32 v177, v162, v165
  v_cvt_pk_bf16_f32 v185, -v162, -v165
  v_fmamk_f32 v160, v6, 0x41000000, v7
  v_cos_f32 v161, v160
  v_sin_f32 v162, v160
  v_fmamk_f32 v163, v6, 0x41100000, v7
  v_cos_f32 v164, v163
  v_sin_f32 v165, v163
  s_nop 0
  v_cvt_pk_f16_f32 v44, v161, v162
  v_cvt_pk_f16_f32 v60, -v162, v161
  v_cvt_pk_f16_f32 v45, v164, v165
  v_cvt_pk_f16_f32 v61, -v165, v164
  v_cvt_pk_f16_f32 v138, v161, v164
  v_cvt_pk_f16_f32 v146, v162, v165
  v_cvt_pk_f16_f32 v154, -v162, -v165
  v_cvt_pk_bf16_f32 v170, v161, v164
  v_cvt_pk_bf16_f32 v178, v162, v165
  v_cvt_pk_bf16_f32 v186, -v162, -v165
  v_fmamk_f32 v160, v6, 0x41200000, v7
  v_cos_f32 v161, v160
  v_sin_f32 v162, v160
  v_fmamk_f32 v163, v6, 0x41300000, v7
  v_cos_f32 v164, v163
  v_sin_f32 v165, v163
  s_nop 0
  v_cvt_pk_f16_f32 v46, v161, v162
  v_cvt_pk_f16_f32 v62, -v162, v161
  v_cvt_pk_f16_f32 v47, v164, v165
  v_cvt_pk_f16_f32 v63, -v165, v164
  v_cvt_pk_f16_f32 v139, v161, v164
  v_cvt_pk_f16_f32 v147, v162, v165
  v_cvt_pk_f16_f32 v155, -v162, -v165
  v_cvt_pk_bf16_f32 v171, v161, v164
  v_cvt_pk_bf16_f32 v179, v162, v165
  v_cvt_pk_bf16_f32 v187, -v162, -v165
  v_fmamk_f32 v160, v6, 0x41800000, v7
  v_cos_f32 v161, v160
  v_sin_f32 v162, v160
  v_fmamk_f32 v163, v6, 0x41880000, v7
  v_cos_f32 v164, v163
  v_sin_f32 v165, v163
  s_nop 0
  v_cvt_pk_f16_f32 v48, v161, v162
  v_cvt_pk_f16_f32 v64, -v162, v161
  v_cvt_pk_f16_f32 v49, v164, v165
  v_cvt_pk_f16_f32 v65, -v165, v164
  v_cvt_pk_f16_f32 v140, v161, v164
  v_cvt_pk_f16_f32 v148, v162, v165
  v_cvt_pk_f16_f32 v156, -v162, -v165
  v_cvt_pk_bf16_f32 v172, v161, v164
  v_cvt_pk_bf16_f32 v180, v162, v165
  v_cvt_pk_bf16_f32 v188, -v162, -v165
  v_fmamk_f32 v160, v6, 0x41900000, v7
  v_cos_f32 v161, v160
  v_sin_f32 v162, v160
  v_fmamk_f32 v163, v6, 0x41980000, v7
  v_cos_f32 v164, v163
  v_sin_f32 v165, v163
  s_nop 0
  v_cvt_pk_f16_f32 v50, v161, v162
  v_cvt_pk_f16_f32 v66, -v162, v161
  v_cvt_pk_f16_f32 v51, v164, v165
  v_cvt_pk_f16_f32 v67, -v165, v164
  v_cvt_pk_f16_f32 v141, v161, v164
  v_cvt_pk_f16_f32 v149, v162, v165
  v_cvt_pk_f16_f32 v157, -v162, -v165
  v_cvt_pk_bf16_f32 v173, v161, v164
  v_cvt_pk_bf16_f32 v181, v162, v165
  v_cvt_pk_bf16_f32 v189, -v162, -v165
  v_fmamk_f32 v160, v6, 0x41c00000, v7
  v_cos_f32 v161, v160
  v_sin_f32 v162, v160
  v_fmamk_f32 v163, v6, 0x41c80000, v7
  v_cos_f32 v164, v163
  v_sin_f32 v165, v163
  s_nop 0
  v_cvt_pk_f16_f32 v52, v161, v162
  v_cvt_pk_f16_f32 v68, -v162, v161
  v_cvt_pk_f16_f32 v53, v164, v165
  v_cvt_pk_f16_f32 v69, -v165, v164
  v_cvt_pk_f16_f32 v142, v161, v164
  v_cvt_pk_f16_f32 v150, v162, v165
  v_cvt_pk_f16_f32 v158, -v162, -v165
  v_cvt_pk_bf16_f32 v174, v161, v164
  v_cvt_pk_bf16_f32 v182, v162, v165
  v_cvt_pk_bf16_f32 v190, -v162, -v165
  v_fmamk_f32 v160, v6, 0x41d00000, v7
  v_cos_f32 v161, v160
  v_sin_f32 v162, v160
  v_fmamk_f32 v163, v6, 0x41d80000, v7
  v_cos_f32 v164, v163
  v_sin_f32 v165, v163
  s_nop 0
  v_cvt_pk_f16_f32 v54, v161, v162
  v_cvt_pk_f16_f32 v70, -v162, v161
  v_cvt_pk_f16_f32 v55, v164, v165
  v_cvt_pk_f16_f32 v71, -v165, v164
  v_cvt_pk_f16_f32 v143, v161, v164
  v_cvt_pk_f16_f32 v151, v162, v165
  v_cvt_pk_f16_f32 v159, -v162, -v165
  v_cvt_pk_bf16_f32 v175, v161, v164
  v_cvt_pk_bf16_f32 v183, v162, v165
  v_cvt_pk_bf16_f32 v191, -v162, -v165
  s_cmp_lt_u32 s19, 2
  s_cbranch_scc0 L_f2_nobeta3
  buffer_load_dwordx4 a[12:15], v217, s[20:23], s28 offen
  s_add_u32 s28, s28, 270336
L_f2_nobeta3:
  v_mov_b32 v250, v6
  v_mul_f32 v251, v5, v6
  v_mul_f32 v251, 0.5, v251
  v_mul_f32 v252, 0x3a800000, v2
  v_mul_f32 v253, v5, v252
  v_mul_f32 v253, 0.5, v253
  v_bfe_u32 v2, v0, 2, 2
  v_xor_b32 v2, s13, v2
  v_lshlrev_b32 v2, 4, v2
  v_lshl_add_u32 v2, v0, 6, v2
  v_add_u32 v2, 57344, v2
  s_nop 0
  s_cmp_lt_u32 s19, 2
  s_cbranch_scc1 L_f2_w1
  s_waitcnt vmcnt(5)
L_f2_w1:
  s_waitcnt vmcnt(9)
  s_barrier
  ds_read_b128 v[8:11], v2 offset:0
  ds_read_b128 v[12:15], v2 offset:4096
  ds_read_b128 v[16:19], v2 offset:8192
  ds_read_b128 v[20:23], v2 offset:12288
  s_waitcnt lgkmcnt(3)
  v_mfma_f32_32x32x16_f16 v[216:231], v[8:11], v[40:43], 0
  v_mov_b32 v254, v253
  v_cos_f32 v104, v254
  v_sin_f32 v120, v254
  v_fmamk_f32 v255, v252, 0x3f800000, v253
  v_mfma_f32_32x32x16_f16 v[232:247], v[8:11], v[56:59], 0
  v_cos_f32 v105, v255
  v_sin_f32 v121, v255
  v_fmamk_f32 v254, v252, 0x40000000, v253
  v_cos_f32 v106, v254
  s_waitcnt lgkmcnt(2)
  v_mfma_f32_32x32x16_f16 v[216:231], v[12:15], v[44:47], v[216:231]
  v_sin_f32 v122, v254
  v_fmamk_f32 v255, v252, 0x40400000, v253
  v_cos_f32 v107, v255
  v_sin_f32 v123, v255
  v_mfma_f32_32x32x16_f16 v[232:247], v[12:15], v[60:63], v[232:247]
  v_fmamk_f32 v254, v252, 0x41000000, v253
  v_cos_f32 v108, v254
  v_sin_f32 v124, v254
  v_fmamk_f32 v255, v252, 0x41100000, v253
  s_waitcnt lgkmcnt(1)
  v_mfma_f32_32x32x16_f16 v[216:231], v[16:19], v[48:51], v[216:231]
  v_cos_f32 v109, v255
  v_sin_f32 v125, v255
  v_fmamk_f32 v254, v252, 0x41200000, v253
  v_cos_f32 v110, v254
  v_mfma_f32_32x32x16_f16 v[232:247], v[16:19], v[64:67], v[232:247]
  v_sin_f32 v126, v254
  v_fmamk_f32 v255, v252, 0x41300000, v253
  v_cos_f32 v111, v255
  v_sin_f32 v127, v255
  s_waitcnt lgkmcnt(0)
  v_mfma_f32_32x32x16_f16 v[216:231], v[20:23], v[52:55], v[216:231]
  v_fmamk_f32 v254, v252, 0x41800000, v253
  v_cos_f32 v112, v254
  v_sin_f32 v128, v254
  v_fmamk_f32 v255, v252, 0x41880000, v253
  v_mfma_f32_32x32x16_f16 v[232:247], v[20:23], v[68:71], v[232:247]
  v_cos_f32 v113, v255
  v_sin_f32 v129, v255
  v_fmamk_f32 v254, v252, 0x41900000, v253
  v_cos_f32 v114, v254
  v_sin_f32 v130, v254
  v_fmamk_f32 v255, v252, 0x41980000, v253
  v_cos_f32 v115, v255
  v_sin_f32 v131, v255
  v_fmamk_f32 v254, v252, 0x41c00000, v253
  v_cos_f32 v116, v254
  v_sin_f32 v132, v254
  v_fmamk_f32 v255, v252, 0x41c80000, v253
  v_cos_f32 v117, v255
  v_pk_mul_f32 v[160:161], v[216:217], v[72:73]
  v_pk_mul_f32 v[162:163], v[232:233], v[72:73]
  v_pk_fma_f32 v[160:161], v[232:233], v[88:89], v[160:161]
  v_pk_fma_f32 v[162:163], v[216:217], v[88:89], v[162:163] neg_lo:[1,0,0] neg_hi:[1,0,0]
  v_cvt_pk_f16_f32 v8, v160, v161
  v_cvt_pk_f16_f32 v16, v162, v163
  v_pk_mul_f32 v[164:165], v[218:219], v[74:75]
  v_pk_mul_f32 v[166:167], v[234:235], v[74:75]
  v_pk_fma_f32 v[164:165], v[234:235], v[90:91], v[164:165]
  v_pk_fma_f32 v[166:167], v[218:219], v[90:91], v[166:167] neg_lo:[1,0,0] neg_hi:[1,0,0]
  v_cvt_pk_f16_f32 v9, v164, v165
  v_cvt_pk_f16_f32 v17, v166, v167
  v_pk_mul_f32 v[160:161], v[220:221], v[76:77]
  v_pk_mul_f32 v[162:163], v[236:237], v[76:77]
  v_pk_fma_f32 v[160:161], v[236:237], v[92:93], v[160:161]
  v_pk_fma_f32 v[162:163], v[220:221], v[92:93], v[162:163] neg_lo:[1,0,0] neg_hi:[1,0,0]
  v_cvt_pk_f16_f32 v10, v160, v161
  v_cvt_pk_f16_f32 v18, v162, v163
  v_pk_mul_f32 v[164:165], v[222:223], v[78:79]
  v_pk_mul_f32 v[166:167], v[238:239], v[78:79]
  v_pk_fma_f32 v[164:165], v[238:239], v[94:95], v[164:165]
  v_pk_fma_f32 v[166:167], v[222:223], v[94:95], v[166:167] neg_lo:[1,0,0] neg_hi:[1,0,0]
  v_cvt_pk_f16_f32 v11, v164, v165
  v_cvt_pk_f16_f32 v19, v166, v167
  v_pk_mul_f32 v[160:161], v[224:225], v[80:81]
  v_pk_mul_f32 v[162:163], v[240:241], v[80:81]
  v_pk_fma_f32 v[160:161], v[240:241], v[96:97], v[160:161]
  v_pk_fma_f32 v[162:163], v[224:225], v[96:97], v[162:163] neg_lo:[1,0,0] neg_hi:[1,0,0]
  v_cvt_pk_f16_f32 v12, v160, v161
  v_cvt_pk_f16_f32 v20, v162, v163
  v_pk_mul_f32 v[164:165], v[226:227], v[82:83]
  v_pk_mul_f32 v[166:167], v[242:243], v[82:83]
  v_pk_fma_f32 v[164:165], v[242:243], v[98:99], v[164:165]
  v_pk_fma_f32 v[166:167], v[226:227], v[98:99], v[166:167] neg_lo:[1,0,0] neg_hi:[1,0,0]
  v_cvt_pk_f16_f32 v13, v164, v165
  v_cvt_pk_f16_f32 v21, v166, v167
  v_pk_mul_f32 v[160:161], v[228:229], v[84:85]
  v_pk_mul_f32 v[162:163], v[244:245], v[84:85]
  v_pk_fma_f32 v[160:161], v[244:245], v[100:101], v[160:161]
  v_pk_fma_f32 v[162:163], v[228:229], v[100:101], v[162:163] neg_lo:[1,0,0] neg_hi:[1,0,0]
  v_cvt_pk_f16_f32 v14, v160, v161
  v_cvt_pk_f16_f32 v22, v162, v163
  v_pk_mul_f32 v[164:165], v[230:231], v[86:87]
  v_pk_mul_f32 v[166:167], v[246:247], v[86:87]
  v_pk_fma_f32 v[164:165], v[246:247], v[102:103], v[164:165]
  v_pk_fma_f32 v[166:167], v[230:231], v[102:103], v[166:167] neg_lo:[1,0,0] neg_hi:[1,0,0]
  v_cvt_pk_f16_f32 v15, v164, v165
  v_cvt_pk_f16_f32 v23, v166, v167
  s_cmp_lt_u32 s19, 2
  s_cbranch_scc1 L_f2_w2
  s_waitcnt vmcnt(1)
L_f2_w2:
  s_waitcnt vmcnt(5)
  s_barrier
  ds_read_b128 v[24:27], v2 offset:16384
  ds_read_b128 v[28:31], v2 offset:20480
  ds_read_b128 v[32:35], v2 offset:24576
  ds_read_b128 v[36:39], v2 offset:28672
  buffer_load_dword v249, v248, s[44:47], s52 offen
  buffer_load_dword v249, v248, s[48:51], s52 offen
  v_mfma_f32_32x32x16_f16 v[216:231], v[136:139], v[8:11], 0
  v_sin_f32 v133, v255
  v_fmamk_f32 v254, v252, 0x41d00000, v253
  v_cos_f32 v118, v254
  v_sin_f32 v134, v254
  v_fmamk_f32 v255, v252, 0x41d80000, v253
  v_mfma_f32_32x32x16_f16 v[232:247], v[136:139], v[16:19], 0
  v_cos_f32 v119, v255
  v_sin_f32 v135, v255
  s_nop 3
  s_waitcnt lgkmcnt(0)
  v_lshlrev_b32 v40, 16, v24
  v_mfma_f32_32x32x16_f16 v[216:231], v[140:143], v[12:15], v[216:231]
  v_and_b32 v56, 0xffff0000, v24
  v_lshlrev_b32 v41, 16, v25
  v_and_b32 v57, 0xffff0000, v25
  v_lshlrev_b32 v42, 16, v26
  v_and_b32 v58, 0xffff0000, v26
  v_mfma_f32_32x32x16_f16 v[232:247], v[140:143], v[20:23], v[232:247]
  v_lshlrev_b32 v43, 16, v27
  v_and_b32 v59, 0xffff0000, v27
  v_lshlrev_b32 v44, 16, v28
  v_and_b32 v60, 0xffff0000, v28
  v_lshlrev_b32 v45, 16, v29
  v_mfma_f32_32x32x16_f16 v[216:231], v[144:147], v[16:19], v[216:231]
  v_and_b32 v61, 0xffff0000, v29
  v_lshlrev_b32 v46, 16, v30
  v_and_b32 v62, 0xffff0000, v30
  v_lshlrev_b32 v47, 16, v31
  v_and_b32 v63, 0xffff0000, v31
  v_mfma_f32_32x32x16_f16 v[232:247], v[152:155], v[8:11], v[232:247]
  v_lshlrev_b32 v48, 16, v32
  v_and_b32 v64, 0xffff0000, v32
  v_lshlrev_b32 v49, 16, v33
  v_and_b32 v65, 0xffff0000, v33
  v_lshlrev_b32 v50, 16, v34
  v_mfma_f32_32x32x16_f16 v[216:231], v[148:151], v[20:23], v[216:231]
  v_and_b32 v66, 0xffff0000, v34
  v_lshlrev_b32 v51, 16, v35
  v_and_b32 v67, 0xffff0000, v35
  v_lshlrev_b32 v52, 16, v36
  v_and_b32 v68, 0xffff0000, v36
  v_mfma_f32_32x32x16_f16 v[232:247], v[156:159], v[12:15], v[232:247]
  v_lshlrev_b32 v53, 16, v37
  v_and_b32 v69, 0xffff0000, v37
  v_lshlrev_b32 v54, 16, v38
  v_and_b32 v70, 0xffff0000, v38
  v_lshlrev_b32 v55, 16, v39
  v_and_b32 v71, 0xffff0000, v39
  v_mov_b32 v24, v251
  v_cos_f32 v25, v24
  v_sin_f32 v26, v24
  v_fmamk_f32 v27, v250, 0x3f800000, v251
  v_cos_f32 v28, v27
  v_sin_f32 v29, v27
  v_cvt_pk_bf16_f32 v192, v25, v28
  v_cvt_pk_bf16_f32 v200, v26, v29
  v_cvt_pk_bf16_f32 v208, -v26, -v29
  v_fmamk_f32 v24, v250, 0x40000000, v251
  v_cos_f32 v25, v24
  s_cmp_lt_u32 s19, 2
  s_cbranch_scc1 L_f2_packed
  v_pk_mul_f32 v[160:161], v[216:217], v[40:41]
  v_pk_mul_f32 v[162:163], v[232:233], v[40:41]
  v_pk_fma_f32 v[160:161], v[232:233], v[56:57], v[160:161] neg_lo:[1,0,0] neg_hi:[1,0,0]
  v_pk_fma_f32 v[162:163], v[216:217], v[56:57], v[162:163]
  v_cvt_pk_bf16_f32 v8, v160, v161
  v_cvt_pk_bf16_f32 v16, v162, v163
  v_pk_mul_f32 v[164:165], v[218:219], v[42:43]
  v_pk_mul_f32 v[166:167], v[234:235], v[42:43]
  v_pk_fma_f32 v[164:165], v[234:235], v[58:59], v[164:165] neg_lo:[1,0,0] neg_hi:[1,0,0]
  v_pk_fma_f32 v[166:167], v[218:219], v[58:59], v[166:167]
  v_cvt_pk_bf16_f32 v9, v164, v165
  v_cvt_pk_bf16_f32 v17, v166, v167
  v_pk_mul_f32 v[160:161], v[220:221], v[44:45]
  v_pk_mul_f32 v[162:163], v[236:237], v[44:45]
  v_pk_fma_f32 v[160:161], v[236:237], v[60:61], v[160:161] neg_lo:[1,0,0] neg_hi:[1,0,0]
  v_pk_fma_f32 v[162:163], v[220:221], v[60:61], v[162:163]
  v_cvt_pk_bf16_f32 v10, v160, v161
  v_cvt_pk_bf16_f32 v18, v162, v163
  v_pk_mul_f32 v[164:165], v[222:223], v[46:47]
  v_pk_mul_f32 v[166:167], v[238:239], v[46:47]
  v_pk_fma_f32 v[164:165], v[238:239], v[62:63], v[164:165] neg_lo:[1,0,0] neg_hi:[1,0,0]
  v_pk_fma_f32 v[166:167], v[222:223], v[62:63], v[166:167]
  v_cvt_pk_bf16_f32 v11, v164, v165
  v_cvt_pk_bf16_f32 v19, v166, v167
  v_pk_mul_f32 v[160:161], v[224:225], v[48:49]
  v_pk_mul_f32 v[162:163], v[240:241], v[48:49]
  v_pk_fma_f32 v[160:161], v[240:241], v[64:65], v[160:161] neg_lo:[1,0,0] neg_hi:[1,0,0]
  v_pk_fma_f32 v[162:163], v[224:225], v[64:65], v[162:163]
  v_cvt_pk_bf16_f32 v12, v160, v161
  v_cvt_pk_bf16_f32 v20, v162, v163
  v_pk_mul_f32 v[164:165], v[226:227], v[50:51]
  v_pk_mul_f32 v[166:167], v[242:243], v[50:51]
  v_pk_fma_f32 v[164:165], v[242:243], v[66:67], v[164:165] neg_lo:[1,0,0] neg_hi:[1,0,0]
  v_pk_fma_f32 v[166:167], v[226:227], v[66:67], v[166:167]
  v_cvt_pk_bf16_f32 v13, v164, v165
  v_cvt_pk_bf16_f32 v21, v166, v167
  v_pk_mul_f32 v[160:161], v[228:229], v[52:53]
  v_pk_mul_f32 v[162:163], v[244:245], v[52:53]
  v_pk_fma_f32 v[160:161], v[244:245], v[68:69], v[160:161] neg_lo:[1,0,0] neg_hi:[1,0,0]
  v_pk_fma_f32 v[162:163], v[228:229], v[68:69], v[162:163]
  v_cvt_pk_bf16_f32 v14, v160, v161
  v_cvt_pk_bf16_f32 v22, v162, v163
  v_pk_mul_f32 v[164:165], v[230:231], v[54:55]
  v_pk_mul_f32 v[166:167], v[246:247], v[54:55]
  v_pk_fma_f32 v[164:165], v[246:247], v[70:71], v[164:165] neg_lo:[1,0,0] neg_hi:[1,0,0]
  v_pk_fma_f32 v[166:167], v[230:231], v[70:71], v[166:167]
  v_cvt_pk_bf16_f32 v15, v164, v165
  v_cvt_pk_bf16_f32 v23, v166, v167
L_f2_join:
  v_mfma_f32_32x32x16_bf16 v[216:231], v[8:11], v[168:171], 0
  v_sin_f32 v26, v24
  v_fmamk_f32 v27, v250, 0x40400000, v251
  v_cos_f32 v28, v27
  v_sin_f32 v29, v27
  v_cvt_pk_bf16_f32 v193, v25, v28
  v_mfma_f32_32x32x16_bf16 v[232:247], v[16:19], v[168:171], 0
  v_cvt_pk_bf16_f32 v201, v26, v29
  v_cvt_pk_bf16_f32 v209, -v26, -v29
  v_fmamk_f32 v24, v250, 0x41000000, v251
  v_cos_f32 v25, v24
  v_sin_f32 v26, v24
  v_mfma_f32_32x32x16_bf16 v[216:231], v[12:15], v[172:175], v[216:231]
  v_fmamk_f32 v27, v250, 0x41100000, v251
  v_cos_f32 v28, v27
  v_sin_f32 v29, v27
  v_cvt_pk_bf16_f32 v194, v25, v28
  v_cvt_pk_bf16_f32 v202, v26, v29
  v_mfma_f32_32x32x16_bf16 v[232:247], v[20:23], v[172:175], v[232:247]
  v_cvt_pk_bf16_f32 v210, -v26, -v29
  v_fmamk_f32 v24, v250, 0x41200000, v251
  v_cos_f32 v25, v24
  v_sin_f32 v26, v24
  v_fmamk_f32 v27, v250, 0x41300000, v251
  v_mfma_f32_32x32x16_bf16 v[216:231], v[16:19], v[184:187], v[216:231]
  v_cos_f32 v28, v27
  v_sin_f32 v29, v27
  v_cvt_pk_bf16_f32 v195, v25, v28
  v_cvt_pk_bf16_f32 v203, v26, v29
  v_cvt_pk_bf16_f32 v211, -v26, -v29
  v_mfma_f32_32x32x16_bf16 v[232:247], v[8:11], v[176:179], v[232:247]
  v_fmamk_f32 v24, v250, 0x41800000, v251
  v_cos_f32 v25, v24
  v_sin_f32 v26, v24
  v_fmamk_f32 v27, v250, 0x41880000, v251
  v_cos_f32 v28, v27
  v_mfma_f32_32x32x16_bf16 v[216:231], v[20:23], v[188:191], v[216:231]
  v_sin_f32 v29, v27
  v_cvt_pk_bf16_f32 v196, v25, v28
  v_cvt_pk_bf16_f32 v204, v26, v29
  v_cvt_pk_bf16_f32 v212, -v26, -v29
  v_fmamk_f32 v24, v250, 0x41900000, v251
  v_mfma_f32_32x32x16_bf16 v[232:247], v[12:15], v[180:183], v[232:247]
  v_cos_f32 v25, v24
  v_sin_f32 v26, v24
  v_fmamk_f32 v27, v250, 0x41980000, v251
  v_cos_f32 v28, v27
  v_sin_f32 v29, v27
  v_cvt_pk_bf16_f32 v197, v25, v28
  v_cvt_pk_bf16_f32 v205, v26, v29
  v_cvt_pk_bf16_f32 v213, -v26, -v29
  v_fmamk_f32 v24, v250, 0x41c00000, v251
  v_cos_f32 v25, v24
  v_sin_f32 v26, v24
  v_fmamk_f32 v27, v250, 0x41c80000, v251
  v_cos_f32 v28, v27
  v_sin_f32 v29, v27
  v_cvt_pk_bf16_f32 v198, v25, v28
  v_cvt_pk_bf16_f32 v206, v26, v29
  v_cvt_pk_bf16_f32 v214, -v26, -v29
  v_fmamk_f32 v24, v250, 0x41d00000, v251
  v_cos_f32 v25, v24
  v_sin_f32 v26, v24
  v_fmamk_f32 v27, v250, 0x41d80000, v251
  v_cos_f32 v28, v27
  v_sin_f32 v29, v27
  v_cvt_pk_bf16_f32 v199, v25, v28
  v_cvt_pk_bf16_f32 v207, v26, v29
  v_cvt_pk_bf16_f32 v215, -v26, -v29
  v_pk_mul_f32 v[160:161], v[216:217], v[104:105]
  v_pk_mul_f32 v[162:163], v[232:233], v[104:105]
  v_pk_fma_f32 v[160:161], v[232:233], v[120:121], v[160:161] neg_lo:[1,0,0] neg_hi:[1,0,0]
  v_pk_fma_f32 v[162:163], v[216:217], v[120:121], v[162:163]
  v_cvt_pk_bf16_f32 v8, v160, v161
  v_cvt_pk_bf16_f32 v16, v162, v163
  v_pk_mul_f32 v[164:165], v[218:219], v[106:107]
  v_pk_mul_f32 v[166:167], v[234:235], v[106:107]
  v_pk_fma_f32 v[164:165], v[234:235], v[122:123], v[164:165] neg_lo:[1,0,0] neg_hi:[1,0,0]
  v_pk_fma_f32 v[166:167], v[218:219], v[122:123], v[166:167]
  v_cvt_pk_bf16_f32 v9, v164, v165
  v_cvt_pk_bf16_f32 v17, v166, v167
  v_pk_mul_f32 v[160:161], v[220:221], v[108:109]
  v_pk_mul_f32 v[162:163], v[236:237], v[108:109]
  v_pk_fma_f32 v[160:161], v[236:237], v[124:125], v[160:161] neg_lo:[1,0,0] neg_hi:[1,0,0]
  v_pk_fma_f32 v[162:163], v[220:221], v[124:125], v[162:163]
  v_cvt_pk_bf16_f32 v10, v160, v161
  v_cvt_pk_bf16_f32 v18, v162, v163
  v_pk_mul_f32 v[164:165], v[222:223], v[110:111]
  v_pk_mul_f32 v[166:167], v[238:239], v[110:111]
  v_pk_fma_f32 v[164:165], v[238:239], v[126:127], v[164:165] neg_lo:[1,0,0] neg_hi:[1,0,0]
  v_pk_fma_f32 v[166:167], v[222:223], v[126:127], v[166:167]
  v_cvt_pk_bf16_f32 v11, v164, v165
  v_cvt_pk_bf16_f32 v19, v166, v167
  v_pk_mul_f32 v[160:161], v[224:225], v[112:113]
  v_pk_mul_f32 v[162:163], v[240:241], v[112:113]
  v_pk_fma_f32 v[160:161], v[240:241], v[128:129], v[160:161] neg_lo:[1,0,0] neg_hi:[1,0,0]
  v_pk_fma_f32 v[162:163], v[224:225], v[128:129], v[162:163]
  v_cvt_pk_bf16_f32 v12, v160, v161
  v_cvt_pk_bf16_f32 v20, v162, v163
  v_pk_mul_f32 v[164:165], v[226:227], v[114:115]
  v_pk_mul_f32 v[166:167], v[242:243], v[114:115]
  v_pk_fma_f32 v[164:165], v[242:243], v[130:131], v[164:165] neg_lo:[1,0,0] neg_hi:[1,0,0]
  v_pk_fma_f32 v[166:167], v[226:227], v[130:131], v[166:167]
  v_cvt_pk_bf16_f32 v13, v164, v165
  v_cvt_pk_bf16_f32 v21, v166, v167
  v_pk_mul_f32 v[160:161], v[228:229], v[116:117]
  v_pk_mul_f32 v[162:163], v[244:245], v[116:117]
  v_pk_fma_f32 v[160:161], v[244:245], v[132:133], v[160:161] neg_lo:[1,0,0] neg_hi:[1,0,0]
  v_pk_fma_f32 v[162:163], v[228:229], v[132:133], v[162:163]
  v_cvt_pk_bf16_f32 v14, v160, v161
  v_cvt_pk_bf16_f32 v22, v162, v163
  v_pk_mul_f32 v[164:165], v[230:231], v[118:119]
  v_pk_mul_f32 v[166:167], v[246:247], v[118:119]
  v_pk_fma_f32 v[164:165], v[246:247], v[134:135], v[164:165] neg_lo:[1,0,0] neg_hi:[1,0,0]
  v_pk_fma_f32 v[166:167], v[230:231], v[134:135], v[166:167]
  v_cvt_pk_bf16_f32 v15, v164, v165
  v_cvt_pk_bf16_f32 v23, v166, v167
  v_mfma_f32_32x32x16_bf16 v[216:231], v[8:11], v[192:195], 0
  v_lshrrev_b32 v5, 5, v0
  v_lshl_add_u32 v4, v5, 2, s13
  v_and_b32 v6, 7, v0
  v_xor_b32 v4, v4, v6
  v_lshlrev_b32 v4, 4, v4
  v_mfma_f32_32x32x16_bf16 v[232:247], v[16:19], v[192:195], 0
  v_and_b32 v7, 31, v0
  v_lshl_add_u32 v4, v7, 9, v4
  v_add_u32 v4, 90112, v4
  s_lshl_b32 s18, s13, 1
  v_add_u32 v5, s18, v5
  v_mfma_f32_32x32x16_bf16 v[216:231], v[12:15], v[196:199], v[216:231]
  v_xor_b32 v5, v5, v6
  v_lshlrev_b32 v5, 4, v5
  s_lshl_b32 s18, s13, 10
  v_and_b32 v7, 56, v0
  v_lshl_add_u32 v5, v7, 4, v5
  v_mfma_f32_32x32x16_bf16 v[232:247], v[20:23], v[196:199], v[232:247]
  v_add_u32 v5, s18, v5
  v_add_u32 v5, 90112, v5
  v_add_u32 v6, s18, v1
  s_lshl_b32 s36, s12, 14
  s_add_u32 s37, s36, 4096
  v_mfma_f32_32x32x16_bf16 v[216:231], v[16:19], v[208:211], v[216:231]
  s_add_u32 s38, s36, 8192
  s_add_u32 s39, s36, 12288
  v_and_b32 v7, 0xfc0, v6
  v_add_u32 v6, v6, v7
  s_lshr_b32 s36, s12, 1
  v_mfma_f32_32x32x16_bf16 v[232:247], v[8:11], v[200:203], v[232:247]
  s_mul_i32 s36, s36, 32768
  s_and_b32 s37, s12, 1
  s_lshl_b32 s37, s37, 6
  s_add_u32 s36, s36, s37
  s_add_u32 s37, s36, 8192
  v_mfma_f32_32x32x16_bf16 v[216:231], v[20:23], v[212:215], v[216:231]
  s_add_u32 s38, s36, 16384
  s_add_u32 s39, s36, 24576
  v_mfma_f32_32x32x16_bf16 v[232:247], v[12:15], v[204:207], v[232:247]
  s_mov_b32 s17, 0x07060302
  s_nop 10
  v_cvt_pk_bf16_f32 v8, v216, v232
  v_perm_b32 v8, v8, v216, s17
  v_or_b32 v8, 1, v8
  v_cvt_pk_bf16_f32 v9, v217, v233
  v_perm_b32 v9, v9, v217, s17
  v_or_b32 v9, 1, v9
  v_cvt_pk_bf16_f32 v10, v218, v234
  v_perm_b32 v10, v10, v218, s17
  v_or_b32 v10, 1, v10
  v_cvt_pk_bf16_f32 v11, v219, v235
  v_perm_b32 v11, v11, v219, s17
  v_or_b32 v11, 1, v11
  ds_write_b128 v4, v[8:11] offset:0
  v_cvt_pk_bf16_f32 v12, v220, v236
  v_perm_b32 v12, v12, v220, s17
  v_or_b32 v12, 1, v12
  v_cvt_pk_bf16_f32 v13, v221, v237
  v_perm_b32 v13, v13, v221, s17
  v_or_b32 v13, 1, v13
  v_cvt_pk_bf16_f32 v14, v222, v238
  v_perm_b32 v14, v14, v222, s17
  v_or_b32 v14, 1, v14
  v_cvt_pk_bf16_f32 v15, v223, v239
  v_perm_b32 v15, v15, v223, s17
  v_or_b32 v15, 1, v15
  ds_write_b128 v4, v[12:15] offset:128
  v_cvt_pk_bf16_f32 v16, v224, v240
  v_perm_b32 v16, v16, v224, s17
  v_or_b32 v16, 1, v16
  v_cvt_pk_bf16_f32 v17, v225, v241
  v_perm_b32 v17, v17, v225, s17
  v_or_b32 v17, 1, v17
  v_cvt_pk_bf16_f32 v18, v226, v242
  v_perm_b32 v18, v18, v226, s17
  v_or_b32 v18, 1, v18
  v_cvt_pk_bf16_f32 v19, v227, v243
  v_perm_b32 v19, v19, v227, s17
  v_or_b32 v19, 1, v19
  ds_write_b128 v4, v[16:19] offset:256
  v_cvt_pk_bf16_f32 v20, v228, v244
  v_perm_b32 v20, v20, v228, s17
  v_or_b32 v20, 1, v20
  v_cvt_pk_bf16_f32 v21, v229, v245
  v_perm_b32 v21, v21, v229, s17
  v_or_b32 v21, 1, v21
  v_cvt_pk_bf16_f32 v22, v230, v246
  v_perm_b32 v22, v22, v230, s17
  v_or_b32 v22, 1, v22
  v_cvt_pk_bf16_f32 v23, v231, v247
  v_perm_b32 v23, v23, v231, s17
  v_or_b32 v23, 1, v23
  ds_write_b128 v4, v[20:23] offset:384
  s_waitcnt vmcnt(2)
  s_waitcnt lgkmcnt(0)
  s_barrier
  ds_read_b128 v[24:27], v5 offset:0
  ds_read_b128 v[28:31], v5 offset:4096
  ds_read_b128 v[32:35], v5 offset:8192
  ds_read_b128 v[36:39], v5 offset:12288
  s_waitcnt lgkmcnt(3)
  buffer_store_dwordx4 v[24:27], v6, s[24:27], s36 offen sc1
  s_waitcnt lgkmcnt(2)
  buffer_store_dwordx4 v[28:31], v6, s[24:27], s37 offen sc1
  s_waitcnt lgkmcnt(1)
  buffer_store_dwordx4 v[32:35], v6, s[24:27], s38 offen sc1
  s_waitcnt lgkmcnt(0)
  buffer_store_dwordx4 v[36:39], v6, s[24:27], s39 offen sc1
  s_lshl_b32 s12, s13, 6
  v_add_u32 v1, s12, v0
  s_nop 0
  s_and_b32 s12, s2, 7
  s_lshl_b32 s12, s12, 5
  s_lshr_b32 s14, s2, 3
  s_add_u32 s12, s12, s14
  v_lshrrev_b32 v2, 2, v0
  v_lshlrev_b32 v2, 14, v2
  v_and_b32 v3, 3, v0
  v_lshl_add_u32 v2, v3, 4, v2
  s_lshl_b32 s14, s12, 6
  s_mul_i32 s15, s13, 1048576
  s_add_u32 s15, s15, s14
  v_and_b32 v4, 31, v0
  v_lshlrev_b32 v4, 6, v4
  v_lshrrev_b32 v5, 5, v0
  v_lshl_add_u32 v4, v5, 4, v4
  s_lshl_b32 s16, s12, 2
  s_add_u32 s16, s16, s13
  s_lshl_b32 s16, s16, 11
  s_add_u32 s17, s16, 2097152
  s_waitcnt lgkmcnt(0)
  s_add_u32 s20, s10, 0
  s_addc_u32 s21, s11, 0
  s_and_b32 s21, s21, 0xffff
  s_mov_b32 s22, 4194304
  s_mov_b32 s23, 0x20000
  v_lshrrev_b32 v2, 3, v0
  v_mul_u32_u24 v2, 32768, v2
  v_and_b32 v3, 7, v0
  v_lshl_add_u32 v2, v3, 4, v2
  s_add_u32 s15, s15, s14
  s_add_u32 s60, s15, 262144
  s_add_u32 s61, s15, 524288
  s_add_u32 s62, s15, 786432
  v_mov_b32 v236, v2
  s_mov_b32 s24, s4
  s_and_b32 s25, s5, 0xffff
  s_mov_b32 s26, 4194304
  s_mov_b32 s27, 0x20000
  s_add_u32 s28, s10, 18874368
  s_addc_u32 s29, s11, 0
  s_and_b32 s29, s29, 0xffff
  s_mov_b32 s30, 4194304
  s_mov_b32 s31, 0x20000
  s_add_u32 s32, s10, 14680064
  s_addc_u32 s33, s11, 0
  s_and_b32 s33, s33, 0xffff
  s_mov_b32 s34, 4194304
  s_mov_b32 s35, 0x20000
  s_and_b32 s46, s2, 7
  s_lshl_b32 s46, s46, 2
  s_bfe_u32 s47, s2, 0x20003
  s_add_u32 s46, s46, s47
  s_and_b32 s40, s13, 1
  s_mul_i32 s40, s40, 448
  s_and_b32 s41, s46, 1
  s_lshl_b32 s41, s41, 1
  s_mov_b32 s42, 0x4925
  s_movk_i32 s43, 7168
  v_add_u32 v238, s40, v0
  v_mul_u32_u24 v239, s42, v238
  v_lshrrev_b32 v239, 18, v239
  v_mad_i32_i24 v240, v239, -14, v238
  v_add_u32 v240, s41, v240
  v_subrev_u32 v241, 14, v240
  v_min_u32 v240, v240, v241
  v_lshlrev_b32 v240, 4, v240
  v_mad_u32_u24 v242, v239, s43, v240
  v_add_u32 v238, 64, v238
  v_mul_u32_u24 v239, s42, v238
  v_lshrrev_b32 v239, 18, v239
  v_mad_i32_i24 v240, v239, -14, v238
  v_add_u32 v240, s41, v240
  v_subrev_u32 v241, 14, v240
  v_min_u32 v240, v240, v241
  v_subrev_u32 v240, 64, v240
  v_lshlrev_b32 v240, 4, v240
  v_mad_u32_u24 v243, v239, s43, v240
  v_add_u32 v238, 64, v238
  v_mul_u32_u24 v239, s42, v238
  v_lshrrev_b32 v239, 18, v239
  v_mad_i32_i24 v240, v239, -14, v238
  v_add_u32 v240, s41, v240
  v_subrev_u32 v241, 14, v240
  v_min_u32 v240, v240, v241
  v_subrev_u32 v240, 128, v240
  v_lshlrev_b32 v240, 4, v240
  v_mad_u32_u24 v244, v239, s43, v240
  v_add_u32 v238, 64, v238
  v_mul_u32_u24 v239, s42, v238
  v_lshrrev_b32 v239, 18, v239
  v_mad_i32_i24 v240, v239, -14, v238
  v_add_u32 v240, s41, v240
  v_subrev_u32 v241, 14, v240
  v_min_u32 v240, v240, v241
  v_subrev_u32 v240, 192, v240
  v_lshlrev_b32 v240, 4, v240
  v_mad_u32_u24 v245, v239, s43, v240
  v_add_u32 v238, 64, v238
  v_mul_u32_u24 v239, s42, v238
  v_lshrrev_b32 v239, 18, v239
  v_mad_i32_i24 v240, v239, -14, v238
  v_add_u32 v240, s41, v240
  v_subrev_u32 v241, 14, v240
  v_min_u32 v240, v240, v241
  v_lshlrev_b32 v240, 4, v240
  v_mad_u32_u24 v246, v239, s43, v240
  v_add_u32 v238, 64, v238
  v_mul_u32_u24 v239, s42, v238
  v_lshrrev_b32 v239, 18, v239
  v_mad_i32_i24 v240, v239, -14, v238
  v_add_u32 v240, s41, v240
  v_subrev_u32 v241, 14, v240
  v_min_u32 v240, v240, v241
  v_subrev_u32 v240, 64, v240
  v_lshlrev_b32 v240, 4, v240
  v_mad_u32_u24 v247, v239, s43, v240
  v_add_u32 v238, 64, v238
  v_mul_u32_u24 v239, s42, v238
  v_lshrrev_b32 v239, 18, v239
  v_mad_i32_i24 v240, v239, -14, v238
  v_add_u32 v240, s41, v240
  v_subrev_u32 v241, 14, v240
  v_min_u32 v240, v240, v241
  v_subrev_u32 v240, 128, v240
  v_lshlrev_b32 v240, 4, v240
  v_mad_u32_u24 v248, v239, s43, v240
  s_cmp_lt_u32 s13, 2
  s_cselect_b32 s40, s66, s68
  s_cselect_b32 s41, s67, s69
  s_and_b32 s41, s41, 0xffff
  s_mov_b32 s42, 7340032
  s_mov_b32 s43, 0x20000
  s_mul_i32 s44, s46, 224
  s_mul_i32 s45, s13, 7168
  v_accvgpr_write_b32 a200, v242
  v_accvgpr_write_b32 a201, v243
  v_accvgpr_write_b32 a202, v244
  v_accvgpr_write_b32 a203, v245
  v_accvgpr_write_b32 a204, v246
  v_accvgpr_write_b32 a205, v247
  v_accvgpr_write_b32 a206, v248
  v_bfe_u32 v5, v0, 2, 2
  v_lshlrev_b32 v5, 3, v5
  v_bfe_u32 v6, v0, 4, 1
  v_lshl_add_u32 v5, v6, 2, v5
  v_and_b32 v6, 3, v0
  v_add_u32 v5, v5, v6
  v_cvt_f32_u32 v5, v5
  v_lshrrev_b32 v6, 5, v0
  v_cvt_f32_u32 v6, v6
  v_mul_f32 v6, 4.0, v6
  v_mul_f32 v216, 0x3d000000, v5
  v_mul_f32 v217, v6, v216
  v_mul_f32 v217, 0.5, v217
  v_mov_b32 v176, v217
  v_cos_f32 v177, v176
  v_sin_f32 v178, v176
  v_fmamk_f32 v179, v216, 0x3f800000, v217
  v_cos_f32 v180, v179
  v_sin_f32 v181, v179
  v_cvt_pk_bf16_f32 v56, v177, -v178
  v_cvt_pk_bf16_f32 v57, -v178, -v177
  v_cvt_pk_bf16_f32 v88, v178, v177
  v_cvt_pk_bf16_f32 v89, v177, -v178
  v_fmamk_f32 v176, v216, 0x40800000, v217
  v_cos_f32 v177, v176
  v_sin_f32 v178, v176
  v_cvt_pk_bf16_f32 v58, v180, -v181
  v_cvt_pk_bf16_f32 v59, -v181, -v180
  v_cvt_pk_bf16_f32 v90, v181, v180
  v_cvt_pk_bf16_f32 v91, v180, -v181
  v_fmamk_f32 v179, v216, 0x40a00000, v217
  v_cos_f32 v180, v179
  v_sin_f32 v181, v179
  v_cvt_pk_bf16_f32 v60, v177, -v178
  v_cvt_pk_bf16_f32 v61, -v178, -v177
  v_cvt_pk_bf16_f32 v92, v178, v177
  v_cvt_pk_bf16_f32 v93, v177, -v178
  v_fmamk_f32 v176, v216, 0x41000000, v217
  v_cos_f32 v177, v176
  v_sin_f32 v178, v176
  v_cvt_pk_bf16_f32 v62, v180, -v181
  v_cvt_pk_bf16_f32 v63, -v181, -v180
  v_cvt_pk_bf16_f32 v94, v181, v180
  v_cvt_pk_bf16_f32 v95, v180, -v181
  v_fmamk_f32 v179, v216, 0x41100000, v217
  v_cos_f32 v180, v179
  v_sin_f32 v181, v179
  v_cvt_pk_bf16_f32 v64, v177, -v178
  v_cvt_pk_bf16_f32 v65, -v178, -v177
  v_cvt_pk_bf16_f32 v96, v178, v177
  v_cvt_pk_bf16_f32 v97, v177, -v178
  v_fmamk_f32 v176, v216, 0x41400000, v217
  v_cos_f32 v177, v176
  v_sin_f32 v178, v176
  v_cvt_pk_bf16_f32 v66, v180, -v181
  v_cvt_pk_bf16_f32 v67, -v181, -v180
  v_cvt_pk_bf16_f32 v98, v181, v180
  v_cvt_pk_bf16_f32 v99, v180, -v181
  v_fmamk_f32 v179, v216, 0x41500000, v217
  v_cos_f32 v180, v179
  v_sin_f32 v181, v179
  v_cvt_pk_bf16_f32 v68, v177, -v178
  v_cvt_pk_bf16_f32 v69, -v178, -v177
  v_cvt_pk_bf16_f32 v100, v178, v177
  v_cvt_pk_bf16_f32 v101, v177, -v178
  v_fmamk_f32 v176, v216, 0x41800000, v217
  v_cos_f32 v177, v176
  v_sin_f32 v178, v176
  v_cvt_pk_bf16_f32 v70, v180, -v181
  v_cvt_pk_bf16_f32 v71, -v181, -v180
  v_cvt_pk_bf16_f32 v102, v181, v180
  v_cvt_pk_bf16_f32 v103, v180, -v181
  v_fmamk_f32 v179, v216, 0x41880000, v217
  v_cos_f32 v180, v179
  v_sin_f32 v181, v179
  v_cvt_pk_bf16_f32 v72, v177, v178
  v_cvt_pk_bf16_f32 v73, -v178, v177
  v_cvt_pk_bf16_f32 v104, v178, -v177
  v_cvt_pk_bf16_f32 v105, v177, v178
  v_fmamk_f32 v176, v216, 0x41a00000, v217
  v_cos_f32 v177, v176
  v_sin_f32 v178, v176
  v_cvt_pk_bf16_f32 v74, v180, v181
  v_cvt_pk_bf16_f32 v75, -v181, v180
  v_cvt_pk_bf16_f32 v106, v181, -v180
  v_cvt_pk_bf16_f32 v107, v180, v181
  v_fmamk_f32 v179, v216, 0x41a80000, v217
  v_cos_f32 v180, v179
  v_sin_f32 v181, v179
  v_cvt_pk_bf16_f32 v76, v177, v178
  v_cvt_pk_bf16_f32 v77, -v178, v177
  v_cvt_pk_bf16_f32 v108, v178, -v177
  v_cvt_pk_bf16_f32 v109, v177, v178
  v_fmamk_f32 v176, v216, 0x41c00000, v217
  v_cos_f32 v177, v176
  v_sin_f32 v178, v176
  v_cvt_pk_bf16_f32 v78, v180, v181
  v_cvt_pk_bf16_f32 v79, -v181, v180
  v_cvt_pk_bf16_f32 v110, v181, -v180
  v_cvt_pk_bf16_f32 v111, v180, v181
  v_fmamk_f32 v179, v216, 0x41c80000, v217
  v_cos_f32 v180, v179
  v_sin_f32 v181, v179
  v_cvt_pk_bf16_f32 v80, v177, v178
  v_cvt_pk_bf16_f32 v81, -v178, v177
  v_cvt_pk_bf16_f32 v112, v178, -v177
  v_cvt_pk_bf16_f32 v113, v177, v178
  v_fmamk_f32 v176, v216, 0x41e00000, v217
  v_cos_f32 v177, v176
  v_sin_f32 v178, v176
  v_cvt_pk_bf16_f32 v82, v180, v181
  v_cvt_pk_bf16_f32 v83, -v181, v180
  v_cvt_pk_bf16_f32 v114, v181, -v180
  v_cvt_pk_bf16_f32 v115, v180, v181
  v_fmamk_f32 v179, v216, 0x41e80000, v217
  v_cos_f32 v180, v179
  v_sin_f32 v181, v179
  v_cvt_pk_bf16_f32 v84, v177, v178
  v_cvt_pk_bf16_f32 v85, -v178, v177
  v_cvt_pk_bf16_f32 v116, v178, -v177
  v_cvt_pk_bf16_f32 v117, v177, v178
  s_nop 0
  v_cvt_pk_bf16_f32 v86, v180, v181
  v_cvt_pk_bf16_f32 v87, -v181, v180
  v_cvt_pk_bf16_f32 v118, v181, -v180
  v_cvt_pk_bf16_f32 v119, v180, v181
  buffer_load_dwordx4 v[8:11], v236, s[20:23], s15 offen sc1
  buffer_load_dwordx4 v[12:15], v236, s[20:23], s60 offen sc1
  buffer_load_dwordx4 v[16:19], v236, s[20:23], s61 offen sc1
  buffer_load_dwordx4 v[20:23], v236, s[20:23], s62 offen sc1
  v_mul_f32 v216, 0x3a800000, v5
  v_mul_f32 v217, v6, v216
  v_mov_b32 v176, v217
  v_cos_f32 v120, v176
  v_sin_f32 v136, v176
  v_fmamk_f32 v177, v216, 0x3f800000, v217
  v_cos_f32 v121, v177
  v_sin_f32 v137, v177
  v_fmamk_f32 v176, v216, 0x40000000, v217
  v_cos_f32 v122, v176
  v_sin_f32 v138, v176
  v_fmamk_f32 v177, v216, 0x40400000, v217
  v_cos_f32 v123, v177
  v_sin_f32 v139, v177
  v_fmamk_f32 v176, v216, 0x41000000, v217
  v_cos_f32 v124, v176
  v_sin_f32 v140, v176
  v_fmamk_f32 v177, v216, 0x41100000, v217
  v_cos_f32 v125, v177
  v_sin_f32 v141, v177
  v_fmamk_f32 v176, v216, 0x41200000, v217
  v_cos_f32 v126, v176
  v_sin_f32 v142, v176
  v_fmamk_f32 v177, v216, 0x41300000, v217
  v_cos_f32 v127, v177
  v_sin_f32 v143, v177
  v_fmamk_f32 v176, v216, 0x41800000, v217
  v_cos_f32 v128, v176
  v_sin_f32 v144, v176
  v_fmamk_f32 v177, v216, 0x41880000, v217
  v_cos_f32 v129, v177
  v_sin_f32 v145, v177
  v_fmamk_f32 v176, v216, 0x41900000, v217
  v_cos_f32 v130, v176
  v_sin_f32 v146, v176
  v_fmamk_f32 v177, v216, 0x41980000, v217
  v_cos_f32 v131, v177
  v_sin_f32 v147, v177
  v_fmamk_f32 v176, v216, 0x41c00000, v217
  v_cos_f32 v132, v176
  v_sin_f32 v148, v176
  v_fmamk_f32 v177, v216, 0x41c80000, v217
  v_cos_f32 v133, v177
  v_sin_f32 v149, v177
  v_fmamk_f32 v176, v216, 0x41d00000, v217
  v_cos_f32 v134, v176
  v_sin_f32 v150, v176
  v_fmamk_f32 v177, v216, 0x41d80000, v217
  v_cos_f32 v135, v177
  v_sin_f32 v151, v177
  v_and_b32 v5, 31, v0
  v_cvt_f32_u32 v5, v5
  v_mul_f32 v216, 0x3d000000, v5
  v_mul_f32 v217, v6, v216
  v_mov_b32 v176, v217
  v_cos_f32 v177, v176
  v_sin_f32 v178, v176
  v_fmamk_f32 v179, v216, 0x3f800000, v217
  v_cos_f32 v180, v179
  v_sin_f32 v181, v179
  v_cvt_pk_bf16_f32 v152, v177, v180
  v_cvt_pk_bf16_f32 v160, v178, v181
  v_cvt_pk_bf16_f32 v168, -v178, -v181
  v_fmamk_f32 v176, v216, 0x40000000, v217
  v_cos_f32 v177, v176
  v_sin_f32 v178, v176
  v_fmamk_f32 v179, v216, 0x40400000, v217
  v_cos_f32 v180, v179
  v_sin_f32 v181, v179
  v_cvt_pk_bf16_f32 v153, v177, v180
  v_cvt_pk_bf16_f32 v161, v178, v181
  v_cvt_pk_bf16_f32 v169, -v178, -v181
  v_fmamk_f32 v176, v216, 0x41000000, v217
  v_cos_f32 v177, v176
  v_sin_f32 v178, v176
  v_fmamk_f32 v179, v216, 0x41100000, v217
  v_cos_f32 v180, v179
  v_sin_f32 v181, v179
  v_cvt_pk_bf16_f32 v154, v177, v180
  v_cvt_pk_bf16_f32 v162, v178, v181
  v_cvt_pk_bf16_f32 v170, -v178, -v181
  v_fmamk_f32 v176, v216, 0x41200000, v217
  v_cos_f32 v177, v176
  v_sin_f32 v178, v176
  v_fmamk_f32 v179, v216, 0x41300000, v217
  v_cos_f32 v180, v179
  v_sin_f32 v181, v179
  v_cvt_pk_bf16_f32 v155, v177, v180
  v_cvt_pk_bf16_f32 v163, v178, v181
  v_cvt_pk_bf16_f32 v171, -v178, -v181
  v_fmamk_f32 v176, v216, 0x41800000, v217
  v_cos_f32 v177, v176
  v_sin_f32 v178, v176
  v_fmamk_f32 v179, v216, 0x41880000, v217
  v_cos_f32 v180, v179
  v_sin_f32 v181, v179
  v_cvt_pk_bf16_f32 v156, v177, v180
  v_cvt_pk_bf16_f32 v164, v178, v181
  v_cvt_pk_bf16_f32 v172, -v178, -v181
  v_fmamk_f32 v176, v216, 0x41900000, v217
  v_cos_f32 v177, v176
  v_sin_f32 v178, v176
  v_fmamk_f32 v179, v216, 0x41980000, v217
  v_cos_f32 v180, v179
  v_sin_f32 v181, v179
  v_cvt_pk_bf16_f32 v157, v177, v180
  v_cvt_pk_bf16_f32 v165, v178, v181
  v_cvt_pk_bf16_f32 v173, -v178, -v181
  v_fmamk_f32 v176, v216, 0x41c00000, v217
  v_cos_f32 v177, v176
  v_sin_f32 v178, v176
  v_fmamk_f32 v179, v216, 0x41c80000, v217
  v_cos_f32 v180, v179
  v_sin_f32 v181, v179
  v_cvt_pk_bf16_f32 v158, v177, v180
  v_cvt_pk_bf16_f32 v166, v178, v181
  v_cvt_pk_bf16_f32 v174, -v178, -v181
  v_fmamk_f32 v176, v216, 0x41d00000, v217
  v_cos_f32 v177, v176
  v_sin_f32 v178, v176
  v_fmamk_f32 v179, v216, 0x41d80000, v217
  v_cos_f32 v180, v179
  v_sin_f32 v181, v179
  v_cvt_pk_bf16_f32 v159, v177, v180
  v_cvt_pk_bf16_f32 v167, v178, v181
  v_cvt_pk_bf16_f32 v175, -v178, -v181
  s_lshl_b32 s14, s13, 10
  s_add_u32 s14, s14, 57344
  v_lshl_add_u32 v5, v0, 2, s14
  v_lshlrev_b32 v6, 2, v1
  v_add_u32 v6, 61440, v6
  v_min_u32 v6, 61448, v6
  s_mul_i32 s14, s13, 4352
  s_add_u32 s14, s14, 57344
  v_and_b32 v2, 31, v0
  v_lshrrev_b32 v3, 5, v0
  v_lshl_add_u32 v7, v3, 6, v2
  v_lshl_add_u32 v232, v7, 3, s14
  v_sub_u32 v233, 96, v7
  v_lshl_add_u32 v233, v233, 3, s14
  s_lshr_b32 s18, s12, 1
  s_lshl_b32 s18, s18, 15
  s_and_b32 s19, s12, 1
  s_lshl_b32 s19, s19, 7
  s_add_u32 s56, s18, s19
  s_add_u32 s57, s56, 8192
  s_add_u32 s58, s56, 16384
  s_add_u32 s59, s56, 24576
  v_cmp_gt_u32 vcc, 2, v1
  v_mov_b32 v7, 0xffff
  s_nop 0
  v_cndmask_b32 v7, -1, v7, vcc
  s_mov_b32 s63, 0
  s_branch L_f3_check
L_f3_poll:
  buffer_load_dwordx4 v[8:11], v236, s[20:23], s15 offen sc1
  buffer_load_dwordx4 v[12:15], v236, s[20:23], s60 offen sc1
  buffer_load_dwordx4 v[16:19], v236, s[20:23], s61 offen sc1
  buffer_load_dwordx4 v[20:23], v236, s[20:23], s62 offen sc1
L_f3_check:
  s_add_u32 s63, s63, 1
  s_waitcnt vmcnt(3)
  v_bitop3_b32 v237, v8, v9, v10 bitop3:0x80
  v_and_b32 v237, v237, v11
  s_waitcnt vmcnt(2)
  v_bitop3_b32 v237, v237, v12, v13 bitop3:0x80
  v_bitop3_b32 v237, v237, v14, v15 bitop3:0x80
  s_waitcnt vmcnt(1)
  v_bitop3_b32 v237, v237, v16, v17 bitop3:0x80
  v_bitop3_b32 v237, v237, v18, v19 bitop3:0x80
  s_waitcnt vmcnt(0)
  v_bitop3_b32 v237, v237, v20, v21 bitop3:0x80
  v_bitop3_b32 v237, v237, v22, v23 bitop3:0x80
  v_and_b32 v237, 1, v237
  v_cmp_eq_u32 vcc, 0, v237
  s_cmp_lt_u32 s63, 0x40000
  s_cselect_b64 s[64:65], vcc, 0
  s_cmp_lg_u64 s[64:65], 0
  s_cbranch_scc1 L_f3_poll
  v_lshrrev_b32 v24, 16, v8
  v_and_b32 v8, v7, v8
  v_lshrrev_b32 v25, 16, v9
  v_and_b32 v9, v7, v9
  v_lshrrev_b32 v26, 16, v10
  v_and_b32 v10, v7, v10
  v_lshrrev_b32 v27, 16, v11
  v_and_b32 v11, v7, v11
  ds_write2st64_b32 v6, v24, v25 offset0:0 offset1:17
  ds_write2st64_b32 v6, v26, v27 offset0:34 offset1:51
  ds_write2st64_b32 v5, v8, v9 offset0:0 offset1:17
  ds_write2st64_b32 v5, v10, v11 offset0:34 offset1:51
  ds_write2st64_b32 v5, v12, v13 offset0:1 offset1:18
  ds_write2st64_b32 v5, v14, v15 offset0:35 offset1:52
  ds_write2st64_b32 v5, v16, v17 offset0:2 offset1:19
  ds_write2st64_b32 v5, v18, v19 offset0:36 offset1:53
  ds_write2st64_b32 v5, v20, v21 offset0:3 offset1:20
  ds_write2st64_b32 v5, v22, v23 offset0:37 offset1:54
  buffer_load_dwordx4 v[40:43], v4, s[24:27], s16 offen offset:0
  buffer_load_dwordx4 v[44:47], v4, s[24:27], s16 offen offset:32
  buffer_load_dwordx4 v[48:51], v4, s[24:27], s17 offen offset:0
  buffer_load_dwordx4 v[52:55], v4, s[24:27], s17 offen offset:32
  s_waitcnt lgkmcnt(0)
  s_barrier
  ds_read_b64 v[8:9], v232 offset:0
  ds_read_b64 v[10:11], v232 offset:256
  ds_read_b64 v[12:13], v232 offset:1024
  ds_read_b64 v[14:15], v232 offset:1280
  ds_read_b64 v[16:17], v232 offset:2048
  ds_read_b64 v[18:19], v232 offset:2304
  s_waitcnt lgkmcnt(4)
  v_mfma_f32_32x32x16_bf16 v[184:199], v[8:11], v[56:59], 0
  ds_read_b64 v[20:21], v232 offset:3072
  ds_read_b64 v[22:23], v232 offset:3328
  v_lshrrev_b32 v7, 5, v0
  v_bfe_u32 v2, v0, 1, 2
  v_xor_b32 v2, v2, v7
  v_lshlrev_b32 v2, 4, v2
  v_and_b32 v6, 31, v0
  v_mfma_f32_32x32x16_bf16 v[200:215], v[8:11], v[88:91], 0
  v_lshl_add_u32 v2, v6, 6, v2
  v_add_u32 v2, s14, v2
  v_bfe_u32 v3, v0, 3, 2
  v_xor_b32 v3, v3, v0
  v_lshl_add_u32 v3, v3, 4, s14
  s_add_u32 m0, s45, 0
  s_nop 0
  buffer_load_dwordx4 v242, s[40:43], s44 offen offset:0 lds
  s_waitcnt lgkmcnt(4)
  v_mfma_f32_32x32x16_bf16 v[184:199], v[12:15], v[60:63], v[184:199]
  ds_read_b64 v[24:25], v233 offset:3328
  ds_read_b64 v[26:27], v233 offset:3072
  v_lshlrev_b32 v4, 4, v0
  v_and_b32 v5, 7, v0
  v_xor_b32 v5, s13, v5
  v_lshlrev_b32 v5, 4, v5
  v_lshl_add_u32 v5, v6, 9, v5
  v_mfma_f32_32x32x16_bf16 v[200:215], v[12:15], v[92:95], v[200:215]
  v_lshl_add_u32 v5, v7, 8, v5
  v_add_u32 v5, 74752, v5
  v_lshrrev_b32 v6, 5, v1
  v_xor_b32 v6, v6, v1
  v_and_b32 v6, 7, v6
  buffer_load_dwordx4 v243, s[40:43], s44 offen offset:1024 lds
  s_waitcnt lgkmcnt(4)
  v_mfma_f32_32x32x16_bf16 v[184:199], v[16:19], v[64:67], v[184:199]
  ds_read_b64 v[28:29], v233 offset:2304
  ds_read_b64 v[30:31], v233 offset:2048
  v_and_b32 v7, 0xf8, v1
  v_or_b32 v6, v6, v7
  v_lshlrev_b32 v6, 4, v6
  v_add_u32 v6, 74752, v6
  v_lshlrev_b32 v7, 5, v7
  v_mfma_f32_32x32x16_bf16 v[200:215], v[16:19], v[96:99], v[200:215]
  v_and_b32 v216, 7, v1
  v_lshl_add_u32 v7, v216, 4, v7
  v_xor_b32 v234, 32, v2
  v_xor_b32 v235, 64, v5
  buffer_load_dwordx4 v244, s[40:43], s44 offen offset:2048 lds
  s_waitcnt lgkmcnt(4)
  v_mfma_f32_32x32x16_bf16 v[184:199], v[20:23], v[68:71], v[184:199]
  ds_read_b64 v[32:33], v233 offset:1280
  ds_read_b64 v[34:35], v233 offset:1024
  v_mfma_f32_32x32x16_bf16 v[200:215], v[20:23], v[100:103], v[200:215]
  buffer_load_dwordx4 v245, s[40:43], s44 offen offset:3072 lds
  s_waitcnt lgkmcnt(4)
  v_mfma_f32_32x32x16_bf16 v[184:199], v[24:27], v[72:75], v[184:199]
  ds_read_b64 v[36:37], v233 offset:256
  ds_read_b64 v[38:39], v233 offset:0
  v_mfma_f32_32x32x16_bf16 v[200:215], v[24:27], v[104:107], v[200:215]
  s_add_u32 m0, s45, 4096
  s_nop 0
  buffer_load_dwordx4 v246, s[40:43], s44 offen offset:0 lds
  s_waitcnt lgkmcnt(4)
  v_mfma_f32_32x32x16_bf16 v[184:199], v[28:31], v[76:79], v[184:199]
  v_mfma_f32_32x32x16_bf16 v[200:215], v[28:31], v[108:111], v[200:215]
  buffer_load_dwordx4 v247, s[40:43], s44 offen offset:1024 lds
  s_waitcnt lgkmcnt(2)
  v_mfma_f32_32x32x16_bf16 v[184:199], v[32:35], v[80:83], v[184:199]
  v_mfma_f32_32x32x16_bf16 v[200:215], v[32:35], v[112:115], v[200:215]
  buffer_load_dwordx4 v248, s[40:43], s44 offen offset:2048 lds
  s_add_u32 s44, s44, 458752
  s_waitcnt lgkmcnt(0)
  v_mfma_f32_32x32x16_bf16 v[184:199], v[36:39], v[84:87], v[184:199]
  v_mfma_f32_32x32x16_bf16 v[200:215], v[36:39], v[116:119], v[200:215]
  s_add_u32 m0, s45, 28672
  s_nop 0
  buffer_load_dwordx4 v242, s[40:43], s44 offen offset:0 lds
  s_nop 7
  v_pk_mul_f32 v[176:177], v[184:185], v[120:121]
  v_pk_mul_f32 v[178:179], v[200:201], v[120:121]
  v_pk_fma_f32 v[176:177], v[200:201], v[136:137], v[176:177] neg_lo:[1,0,0] neg_hi:[1,0,0]
  v_pk_fma_f32 v[178:179], v[184:185], v[136:137], v[178:179]
  v_cvt_pk_bf16_f32 v8, v176, v177
  v_cvt_pk_bf16_f32 v16, v178, v179
  v_pk_mul_f32 v[180:181], v[186:187], v[122:123]
  v_pk_mul_f32 v[182:183], v[202:203], v[122:123]
  v_pk_fma_f32 v[180:181], v[202:203], v[138:139], v[180:181] neg_lo:[1,0,0] neg_hi:[1,0,0]
  v_pk_fma_f32 v[182:183], v[186:187], v[138:139], v[182:183]
  v_cvt_pk_bf16_f32 v9, v180, v181
  v_cvt_pk_bf16_f32 v17, v182, v183
  v_pk_mul_f32 v[176:177], v[188:189], v[124:125]
  v_pk_mul_f32 v[178:179], v[204:205], v[124:125]
  v_pk_fma_f32 v[176:177], v[204:205], v[140:141], v[176:177] neg_lo:[1,0,0] neg_hi:[1,0,0]
  v_pk_fma_f32 v[178:179], v[188:189], v[140:141], v[178:179]
  v_cvt_pk_bf16_f32 v10, v176, v177
  v_cvt_pk_bf16_f32 v18, v178, v179
  v_pk_mul_f32 v[180:181], v[190:191], v[126:127]
  v_pk_mul_f32 v[182:183], v[206:207], v[126:127]
  v_pk_fma_f32 v[180:181], v[206:207], v[142:143], v[180:181] neg_lo:[1,0,0] neg_hi:[1,0,0]
  v_pk_fma_f32 v[182:183], v[190:191], v[142:143], v[182:183]
  v_cvt_pk_bf16_f32 v11, v180, v181
  v_cvt_pk_bf16_f32 v19, v182, v183
  v_pk_mul_f32 v[176:177], v[192:193], v[128:129]
  v_pk_mul_f32 v[178:179], v[208:209], v[128:129]
  v_pk_fma_f32 v[176:177], v[208:209], v[144:145], v[176:177] neg_lo:[1,0,0] neg_hi:[1,0,0]
  v_pk_fma_f32 v[178:179], v[192:193], v[144:145], v[178:179]
  v_cvt_pk_bf16_f32 v12, v176, v177
  v_cvt_pk_bf16_f32 v20, v178, v179
  v_pk_mul_f32 v[180:181], v[194:195], v[130:131]
  v_pk_mul_f32 v[182:183], v[210:211], v[130:131]
  v_pk_fma_f32 v[180:181], v[210:211], v[146:147], v[180:181] neg_lo:[1,0,0] neg_hi:[1,0,0]
  v_pk_fma_f32 v[182:183], v[194:195], v[146:147], v[182:183]
  v_cvt_pk_bf16_f32 v13, v180, v181
  v_cvt_pk_bf16_f32 v21, v182, v183
  v_pk_mul_f32 v[176:177], v[196:197], v[132:133]
  v_pk_mul_f32 v[178:179], v[212:213], v[132:133]
  v_pk_fma_f32 v[176:177], v[212:213], v[148:149], v[176:177] neg_lo:[1,0,0] neg_hi:[1,0,0]
  v_pk_fma_f32 v[178:179], v[196:197], v[148:149], v[178:179]
  v_cvt_pk_bf16_f32 v14, v176, v177
  v_cvt_pk_bf16_f32 v22, v178, v179
  v_pk_mul_f32 v[180:181], v[198:199], v[134:135]
  v_pk_mul_f32 v[182:183], v[214:215], v[134:135]
  v_pk_fma_f32 v[180:181], v[214:215], v[150:151], v[180:181] neg_lo:[1,0,0] neg_hi:[1,0,0]
  v_pk_fma_f32 v[182:183], v[198:199], v[150:151], v[182:183]
  v_cvt_pk_bf16_f32 v15, v180, v181
  v_cvt_pk_bf16_f32 v23, v182, v183
  s_waitcnt vmcnt(8)
  v_mfma_f32_32x32x16_bf16 v[184:199], v[8:11], v[152:155], 0
  v_lshlrev_b32 v56, 16, v40
  v_and_b32 v57, 0xffff0000, v40
  v_lshlrev_b32 v58, 16, v41
  v_mfma_f32_32x32x16_bf16 v[200:215], v[16:19], v[152:155], 0
  v_and_b32 v59, 0xffff0000, v41
  buffer_load_dwordx4 v243, s[40:43], s44 offen offset:1024 lds
  v_lshlrev_b32 v64, 16, v42
  v_mfma_f32_32x32x16_bf16 v[184:199], v[12:15], v[156:159], v[184:199]
  v_and_b32 v65, 0xffff0000, v42
  v_lshlrev_b32 v66, 16, v43
  v_and_b32 v67, 0xffff0000, v43
  v_mfma_f32_32x32x16_bf16 v[200:215], v[20:23], v[156:159], v[200:215]
  v_lshlrev_b32 v60, 16, v44
  v_and_b32 v61, 0xffff0000, v44
  v_lshlrev_b32 v62, 16, v45
  v_mfma_f32_32x32x16_bf16 v[184:199], v[16:19], v[168:171], v[184:199]
  v_and_b32 v63, 0xffff0000, v45
  v_lshlrev_b32 v68, 16, v46
  buffer_load_dwordx4 v244, s[40:43], s44 offen offset:2048 lds
  v_mfma_f32_32x32x16_bf16 v[200:215], v[8:11], v[160:163], v[200:215]
  v_and_b32 v69, 0xffff0000, v46
  v_lshlrev_b32 v70, 16, v47
  v_and_b32 v71, 0xffff0000, v47
  v_mfma_f32_32x32x16_bf16 v[184:199], v[20:23], v[172:175], v[184:199]
  v_lshlrev_b32 v72, 16, v48
  v_and_b32 v73, 0xffff0000, v48
  v_lshlrev_b32 v74, 16, v49
  v_mfma_f32_32x32x16_bf16 v[200:215], v[12:15], v[164:167], v[200:215]
  v_and_b32 v75, 0xffff0000, v49
  v_lshlrev_b32 v80, 16, v50
  v_and_b32 v81, 0xffff0000, v50
  buffer_load_dwordx4 v245, s[40:43], s44 offen offset:3072 lds
  v_lshlrev_b32 v82, 16, v51
  v_and_b32 v83, 0xffff0000, v51
  v_lshlrev_b32 v76, 16, v52
  v_and_b32 v77, 0xffff0000, v52
  v_lshlrev_b32 v78, 16, v53
  v_and_b32 v79, 0xffff0000, v53
  v_lshlrev_b32 v84, 16, v54
  v_and_b32 v85, 0xffff0000, v54
  v_lshlrev_b32 v86, 16, v55
  v_and_b32 v87, 0xffff0000, v55
  s_mov_b32 s36, 0x39000000
  v_pk_add_f32 v[176:177], v[184:185], v[200:201]
  v_pk_fma_f32 v[56:57], v[176:177], s[36:37], v[56:57] op_sel_hi:[1,0,1]
  v_cvt_pk_bf16_f32 v40, v56, v57
  v_lshlrev_b32 v56, 16, v40
  v_and_b32 v57, 0xffff0000, v40
  v_pk_add_f32 v[178:179], v[186:187], v[202:203]
  v_pk_fma_f32 v[58:59], v[178:179], s[36:37], v[58:59] op_sel_hi:[1,0,1]
  v_cvt_pk_bf16_f32 v41, v58, v59
  v_lshlrev_b32 v58, 16, v41
  v_and_b32 v59, 0xffff0000, v41
  v_pk_add_f32 v[176:177], v[192:193], v[208:209]
  v_pk_fma_f32 v[64:65], v[176:177], s[36:37], v[64:65] op_sel_hi:[1,0,1]
  v_cvt_pk_bf16_f32 v42, v64, v65
  v_lshlrev_b32 v64, 16, v42
  v_and_b32 v65, 0xffff0000, v42
  v_pk_add_f32 v[178:179], v[194:195], v[210:211]
  v_pk_fma_f32 v[66:67], v[178:179], s[36:37], v[66:67] op_sel_hi:[1,0,1]
  v_cvt_pk_bf16_f32 v43, v66, v67
  v_lshlrev_b32 v66, 16, v43
  v_and_b32 v67, 0xffff0000, v43
  s_add_u32 m0, s45, 32768
  s_nop 0
  buffer_load_dwordx4 v246, s[40:43], s44 offen offset:0 lds
  v_pk_add_f32 v[176:177], v[188:189], v[204:205]
  v_pk_fma_f32 v[60:61], v[176:177], s[36:37], v[60:61] op_sel_hi:[1,0,1]
  v_cvt_pk_bf16_f32 v44, v60, v61
  v_lshlrev_b32 v60, 16, v44
  v_and_b32 v61, 0xffff0000, v44
  v_pk_add_f32 v[178:179], v[190:191], v[206:207]
  v_pk_fma_f32 v[62:63], v[178:179], s[36:37], v[62:63] op_sel_hi:[1,0,1]
  v_cvt_pk_bf16_f32 v45, v62, v63
  v_lshlrev_b32 v62, 16, v45
  v_and_b32 v63, 0xffff0000, v45
  v_pk_add_f32 v[176:177], v[196:197], v[212:213]
  v_pk_fma_f32 v[68:69], v[176:177], s[36:37], v[68:69] op_sel_hi:[1,0,1]
  v_cvt_pk_bf16_f32 v46, v68, v69
  v_lshlrev_b32 v68, 16, v46
  v_and_b32 v69, 0xffff0000, v46
  v_pk_add_f32 v[178:179], v[198:199], v[214:215]
  v_pk_fma_f32 v[70:71], v[178:179], s[36:37], v[70:71] op_sel_hi:[1,0,1]
  v_cvt_pk_bf16_f32 v47, v70, v71
  v_lshlrev_b32 v70, 16, v47
  v_and_b32 v71, 0xffff0000, v47
  buffer_load_dwordx4 v247, s[40:43], s44 offen offset:1024 lds
  v_pk_add_f32 v[176:177], v[184:185], v[200:201] neg_lo:[0,1] neg_hi:[0,1]
  v_pk_fma_f32 v[72:73], v[176:177], s[36:37], v[72:73] op_sel_hi:[1,0,1]
  v_cvt_pk_bf16_f32 v48, v72, v73
  v_lshlrev_b32 v72, 16, v48
  v_and_b32 v73, 0xffff0000, v48
  v_pk_add_f32 v[178:179], v[186:187], v[202:203] neg_lo:[0,1] neg_hi:[0,1]
  v_pk_fma_f32 v[74:75], v[178:179], s[36:37], v[74:75] op_sel_hi:[1,0,1]
  v_cvt_pk_bf16_f32 v49, v74, v75
  v_lshlrev_b32 v74, 16, v49
  v_and_b32 v75, 0xffff0000, v49
  v_pk_add_f32 v[176:177], v[192:193], v[208:209] neg_lo:[0,1] neg_hi:[0,1]
  v_pk_fma_f32 v[80:81], v[176:177], s[36:37], v[80:81] op_sel_hi:[1,0,1]
  v_cvt_pk_bf16_f32 v50, v80, v81
  v_lshlrev_b32 v80, 16, v50
  v_and_b32 v81, 0xffff0000, v50
  v_pk_add_f32 v[178:179], v[194:195], v[210:211] neg_lo:[0,1] neg_hi:[0,1]
  v_pk_fma_f32 v[82:83], v[178:179], s[36:37], v[82:83] op_sel_hi:[1,0,1]
  v_cvt_pk_bf16_f32 v51, v82, v83
  v_lshlrev_b32 v82, 16, v51
  v_and_b32 v83, 0xffff0000, v51
  buffer_load_dwordx4 v248, s[40:43], s44 offen offset:2048 lds
  v_pk_add_f32 v[176:177], v[188:189], v[204:205] neg_lo:[0,1] neg_hi:[0,1]
  v_pk_fma_f32 v[76:77], v[176:177], s[36:37], v[76:77] op_sel_hi:[1,0,1]
  v_cvt_pk_bf16_f32 v52, v76, v77
  v_lshlrev_b32 v76, 16, v52
  v_and_b32 v77, 0xffff0000, v52
  v_pk_add_f32 v[178:179], v[190:191], v[206:207] neg_lo:[0,1] neg_hi:[0,1]
  v_pk_fma_f32 v[78:79], v[178:179], s[36:37], v[78:79] op_sel_hi:[1,0,1]
  v_cvt_pk_bf16_f32 v53, v78, v79
  v_lshlrev_b32 v78, 16, v53
  v_and_b32 v79, 0xffff0000, v53
  v_pk_add_f32 v[176:177], v[196:197], v[212:213] neg_lo:[0,1] neg_hi:[0,1]
  v_pk_fma_f32 v[84:85], v[176:177], s[36:37], v[84:85] op_sel_hi:[1,0,1]
  v_cvt_pk_bf16_f32 v54, v84, v85
  v_lshlrev_b32 v84, 16, v54
  v_and_b32 v85, 0xffff0000, v54
  v_pk_add_f32 v[178:179], v[198:199], v[214:215] neg_lo:[0,1] neg_hi:[0,1]
  v_pk_fma_f32 v[86:87], v[178:179], s[36:37], v[86:87] op_sel_hi:[1,0,1]
  v_cvt_pk_bf16_f32 v55, v86, v87
  v_lshlrev_b32 v86, 16, v55
  v_and_b32 v87, 0xffff0000, v55
  v_pk_mul_f32 v[218:219], v[56:57], v[56:57]
  v_pk_mul_f32 v[222:223], v[72:73], v[72:73]
  v_pk_add_f32 v[216:217], v[56:57], v[58:59]
  v_pk_fma_f32 v[218:219], v[58:59], v[58:59], v[218:219]
  v_pk_add_f32 v[220:221], v[72:73], v[74:75]
  v_pk_fma_f32 v[222:223], v[74:75], v[74:75], v[222:223]
  v_pk_add_f32 v[216:217], v[216:217], v[60:61]
  v_pk_fma_f32 v[218:219], v[60:61], v[60:61], v[218:219]
  v_pk_add_f32 v[220:221], v[220:221], v[76:77]
  v_pk_fma_f32 v[222:223], v[76:77], v[76:77], v[222:223]
  v_pk_add_f32 v[216:217], v[216:217], v[62:63]
  v_pk_fma_f32 v[218:219], v[62:63], v[62:63], v[218:219]
  v_pk_add_f32 v[220:221], v[220:221], v[78:79]
  v_pk_fma_f32 v[222:223], v[78:79], v[78:79], v[222:223]
  v_pk_add_f32 v[216:217], v[216:217], v[64:65]
  v_pk_fma_f32 v[218:219], v[64:65], v[64:65], v[218:219]
  v_pk_add_f32 v[220:221], v[220:221], v[80:81]
  v_pk_fma_f32 v[222:223], v[80:81], v[80:81], v[222:223]
  v_pk_add_f32 v[216:217], v[216:217], v[66:67]
  v_pk_fma_f32 v[218:219], v[66:67], v[66:67], v[218:219]
  v_pk_add_f32 v[220:221], v[220:221], v[82:83]
  v_pk_fma_f32 v[222:223], v[82:83], v[82:83], v[222:223]
  v_pk_add_f32 v[216:217], v[216:217], v[68:69]
  v_pk_fma_f32 v[218:219], v[68:69], v[68:69], v[218:219]
  v_pk_add_f32 v[220:221], v[220:221], v[84:85]
  v_pk_fma_f32 v[222:223], v[84:85], v[84:85], v[222:223]
  v_pk_add_f32 v[216:217], v[216:217], v[70:71]
  v_pk_fma_f32 v[218:219], v[70:71], v[70:71], v[218:219]
  v_pk_add_f32 v[220:221], v[220:221], v[86:87]
  v_pk_fma_f32 v[222:223], v[86:87], v[86:87], v[222:223]
  v_add_f32 v216, v216, v217
  v_add_f32 v218, v218, v219
  v_add_f32 v220, v220, v221
  v_add_f32 v222, v222, v223
  v_add_f32_dpp v216, v216, v216 quad_perm:[1,0,3,2] row_mask:0xf bank_mask:0xf
  v_add_f32_dpp v218, v218, v218 quad_perm:[1,0,3,2] row_mask:0xf bank_mask:0xf
  v_add_f32_dpp v220, v220, v220 quad_perm:[1,0,3,2] row_mask:0xf bank_mask:0xf
  v_add_f32_dpp v222, v222, v222 quad_perm:[1,0,3,2] row_mask:0xf bank_mask:0xf
  v_add_f32_dpp v216, v216, v216 quad_perm:[2,3,0,1] row_mask:0xf bank_mask:0xf
  v_add_f32_dpp v218, v218, v218 quad_perm:[2,3,0,1] row_mask:0xf bank_mask:0xf
  v_add_f32_dpp v220, v220, v220 quad_perm:[2,3,0,1] row_mask:0xf bank_mask:0xf
  v_add_f32_dpp v222, v222, v222 quad_perm:[2,3,0,1] row_mask:0xf bank_mask:0xf
  v_add_f32_dpp v216, v216, v216 row_half_mirror row_mask:0xf bank_mask:0xf
  v_add_f32_dpp v218, v218, v218 row_half_mirror row_mask:0xf bank_mask:0xf
  v_add_f32_dpp v220, v220, v220 row_half_mirror row_mask:0xf bank_mask:0xf
  v_add_f32_dpp v222, v222, v222 row_half_mirror row_mask:0xf bank_mask:0xf
  v_add_f32_dpp v216, v216, v216 row_mirror row_mask:0xf bank_mask:0xf
  v_add_f32_dpp v218, v218, v218 row_mirror row_mask:0xf bank_mask:0xf
  v_add_f32_dpp v220, v220, v220 row_mirror row_mask:0xf bank_mask:0xf
  v_add_f32_dpp v222, v222, v222 row_mirror row_mask:0xf bank_mask:0xf
  v_mov_b32 v217, v216
  v_mov_b32 v219, v218
  v_mov_b32 v221, v220
  v_mov_b32 v223, v222
  v_permlane16_swap_b32 v216, v217
  v_permlane16_swap_b32 v218, v219
  v_permlane16_swap_b32 v220, v221
  v_permlane16_swap_b32 v222, v223
  v_add_f32 v216, v216, v217
  v_add_f32 v218, v218, v219
  v_add_f32 v220, v220, v221
  v_add_f32 v222, v222, v223
  v_mov_b32 v217, v216
  v_mov_b32 v219, v218
  v_mov_b32 v221, v220
  v_mov_b32 v223, v222
  v_permlane32_swap_b32 v216, v217
  v_permlane32_swap_b32 v218, v219
  v_permlane32_swap_b32 v220, v221
  v_permlane32_swap_b32 v222, v223
  v_add_f32 v216, v216, v217
  v_add_f32 v218, v218, v219
  v_add_f32 v220, v220, v221
  v_add_f32 v222, v222, v223
  v_mul_f32 v216, 0x3a800000, v216
  v_mul_f32 v220, 0x3a800000, v220
  v_mul_f32 v217, v216, v216
  v_mul_f32 v221, v220, v220
  v_mul_f32 v218, 0x3a800000, v218
  v_mul_f32 v222, 0x3a800000, v222
  v_sub_f32 v218, v218, v217
  v_sub_f32 v222, v222, v221
  v_max_f32 v218, 0, v218
  v_max_f32 v222, 0, v222
  v_cvt_pk_bf16_f32 v216, v216, v218
  v_cvt_pk_bf16_f32 v220, v220, v222
  v_and_b32 v218, 0xffff0000, v216
  v_and_b32 v222, 0xffff0000, v220
  v_add_f32 v218, 0x3727c5ac, v218
  v_add_f32 v222, 0x3727c5ac, v222
  v_cvt_pk_bf16_f32 v218, v218, v218
  v_cvt_pk_bf16_f32 v222, v222, v222
  v_and_b32 v218, 0xffff0000, v218
  v_and_b32 v222, 0xffff0000, v222
  v_sqrt_f32 v218, v218
  v_sqrt_f32 v222, v222
  v_lshlrev_b32 v216, 16, v216
  v_lshlrev_b32 v220, 16, v220
  v_cvt_pk_bf16_f32 v218, v218, v218
  v_cvt_pk_bf16_f32 v222, v222, v222
  v_and_b32 v218, 0xffff0000, v218
  v_and_b32 v222, 0xffff0000, v222
  v_rcp_f32 v224, v218
  v_rcp_f32 v226, v222
  v_mul_f32 v216, -v216, v224
  v_mul_f32 v220, -v220, v226
  v_pk_fma_f32 v[56:57], v[56:57], v[224:225], v[216:217] op_sel_hi:[1,0,0]
  v_cvt_pk_bf16_f32 v8, v56, v57
  v_pk_fma_f32 v[58:59], v[58:59], v[224:225], v[216:217] op_sel_hi:[1,0,0]
  v_cvt_pk_bf16_f32 v9, v58, v59
  v_pk_fma_f32 v[60:61], v[60:61], v[224:225], v[216:217] op_sel_hi:[1,0,0]
  v_cvt_pk_bf16_f32 v10, v60, v61
  v_pk_fma_f32 v[62:63], v[62:63], v[224:225], v[216:217] op_sel_hi:[1,0,0]
  v_cvt_pk_bf16_f32 v11, v62, v63
  ds_write_b128 v5, v[8:11] offset:0
  v_pk_fma_f32 v[64:65], v[64:65], v[224:225], v[216:217] op_sel_hi:[1,0,0]
  v_cvt_pk_bf16_f32 v12, v64, v65
  v_pk_fma_f32 v[66:67], v[66:67], v[224:225], v[216:217] op_sel_hi:[1,0,0]
  v_cvt_pk_bf16_f32 v13, v66, v67
  v_pk_fma_f32 v[68:69], v[68:69], v[224:225], v[216:217] op_sel_hi:[1,0,0]
  v_cvt_pk_bf16_f32 v14, v68, v69
  v_pk_fma_f32 v[70:71], v[70:71], v[224:225], v[216:217] op_sel_hi:[1,0,0]
  v_cvt_pk_bf16_f32 v15, v70, v71
  ds_write_b128 v5, v[12:15] offset:128
  v_pk_fma_f32 v[72:73], v[72:73], v[226:227], v[220:221] op_sel_hi:[1,0,0]
  v_cvt_pk_bf16_f32 v16, v72, v73
  v_pk_fma_f32 v[74:75], v[74:75], v[226:227], v[220:221] op_sel_hi:[1,0,0]
  v_cvt_pk_bf16_f32 v17, v74, v75
  v_pk_fma_f32 v[76:77], v[76:77], v[226:227], v[220:221] op_sel_hi:[1,0,0]
  v_cvt_pk_bf16_f32 v18, v76, v77
  v_pk_fma_f32 v[78:79], v[78:79], v[226:227], v[220:221] op_sel_hi:[1,0,0]
  v_cvt_pk_bf16_f32 v19, v78, v79
  ds_write_b128 v235, v[16:19] offset:0
  v_pk_fma_f32 v[80:81], v[80:81], v[226:227], v[220:221] op_sel_hi:[1,0,0]
  v_cvt_pk_bf16_f32 v20, v80, v81
  v_pk_fma_f32 v[82:83], v[82:83], v[226:227], v[220:221] op_sel_hi:[1,0,0]
  v_cvt_pk_bf16_f32 v21, v82, v83
  v_pk_fma_f32 v[84:85], v[84:85], v[226:227], v[220:221] op_sel_hi:[1,0,0]
  v_cvt_pk_bf16_f32 v22, v84, v85
  v_pk_fma_f32 v[86:87], v[86:87], v[226:227], v[220:221] op_sel_hi:[1,0,0]
  v_cvt_pk_bf16_f32 v23, v86, v87
  ds_write_b128 v235, v[20:23] offset:128
  s_waitcnt lgkmcnt(0)
  s_barrier
  ds_read_b128 v[24:27], v6 offset:0
  ds_read_b128 v[28:31], v6 offset:4096
  ds_read_b128 v[32:35], v6 offset:8192
  ds_read_b128 v[36:39], v6 offset:12288
  s_waitcnt lgkmcnt(3)
  buffer_store_dwordx4 v[24:27], v7, s[32:35], s56 offen sc1
  s_waitcnt lgkmcnt(2)
  buffer_store_dwordx4 v[28:31], v7, s[32:35], s57 offen sc1
  s_waitcnt lgkmcnt(1)
  buffer_store_dwordx4 v[32:35], v7, s[32:35], s58 offen sc1
  s_waitcnt lgkmcnt(0)
  buffer_store_dwordx4 v[36:39], v7, s[32:35], s59 offen sc1
  ds_write_b128 v2, v[40:43] offset:0
  ds_write_b128 v234, v[44:47] offset:0
  ds_write_b128 v2, v[48:51] offset:2048
  ds_write_b128 v234, v[52:55] offset:2048
  ds_read_b128 a[160:163], v3 offset:0
  ds_read_b128 a[164:167], v3 offset:1024
  ds_read_b128 a[168:171], v3 offset:2048
  ds_read_b128 a[172:175], v3 offset:3072
  s_mul_i32 s52, s12, 4224
  s_lshl_b32 s53, s13, 2
  s_add_u32 s52, s52, s53
  s_mov_b32 s54, s16
  s_mov_b32 s55, s17
  s_mov_b64 s[56:57], s[28:29]
  s_mov_b32 s58, 4194304
  s_mov_b32 s59, 0x20000
  s_mov_b64 s[8:9], s[10:11]
  s_mov_b64 s[4:5], s[66:67]
  s_mov_b64 s[6:7], s[68:69]
  s_mov_b64 s[18:19], s[72:73]
  s_and_b32 s10, s2, 7
  s_lshl_b32 s10, s10, 2
  s_bfe_u32 s11, s2, 0x20003
  s_add_u32 s10, s10, s11
  s_lshr_b32 s12, s2, 5
  v_accvgpr_read_b32 v8, a200
  v_accvgpr_read_b32 v9, a201
  v_accvgpr_read_b32 v10, a202
  v_accvgpr_read_b32 v11, a203
  v_accvgpr_read_b32 v12, a204
  v_accvgpr_read_b32 v13, a205
  v_accvgpr_read_b32 v14, a206
  v_lshlrev_b32 v16, 4, v0
  s_mul_i32 s28, s10, 224
  s_mov_b32 s29, 0
  s_mul_i32 s30, s13, 7168
  s_lshl_b32 s11, s12, 2
  s_add_u32 s11, s11, s13
  s_lshl_b32 s14, s11, 17
  s_mov_b32 s22, 7340032
  s_mov_b32 s23, 0x20000
  s_mov_b32 s26, 131072
  s_mov_b32 s27, 0x20000
  s_add_u32 s28, s28, 917504
  s_add_u32 s14, s14, 14680064
  v_add_u32 v17, 32768, v16
  v_add_u32 v18, 65536, v16
  v_add_u32 v19, 98304, v16
  s_cmp_lt_u32 s13, 2
  s_waitcnt lgkmcnt(0)
  s_cselect_b32 s20, s4, s6
  s_cselect_b32 s21, s5, s7
  s_and_b32 s21, s21, 0xffff
  s_add_u32 s24, s8, s14
  s_addc_u32 s25, s9, 0
  s_and_b32 s25, s25, 0xffff
  v_mov_b32 v4, 0
  v_mov_b32 v5, 0
  v_mov_b32 v6, 0
  v_mov_b32 v7, 0
  v_lshrrev_b32 v2, 2, v0
  v_mul_u32_u24 v2, 224, v2
  v_and_b32 v3, 3, v0
  v_lshl_add_u32 v20, v3, 3, v2
  v_add_u32 v21, 57344, v20
  v_mfma_f32_32x32x16_bf16 v[32:47], v[4:7], v[4:7], 0
  v_mfma_f32_32x32x16_bf16 v[48:63], v[4:7], v[4:7], 0
  v_mfma_f32_32x32x16_bf16 v[64:79], v[4:7], v[4:7], 0
  v_mfma_f32_32x32x16_bf16 v[80:95], v[4:7], v[4:7], 0
  v_mfma_f32_32x32x16_bf16 v[96:111], v[4:7], v[4:7], 0
  v_mfma_f32_32x32x16_bf16 v[112:127], v[4:7], v[4:7], 0
  v_mfma_f32_32x32x16_bf16 v[128:143], v[4:7], v[4:7], 0
  v_mfma_f32_32x32x16_bf16 v[144:159], v[4:7], v[4:7], 0
  v_mfma_f32_32x32x16_bf16 v[160:175], v[4:7], v[4:7], 0
  v_mfma_f32_32x32x16_bf16 v[176:191], v[4:7], v[4:7], 0
  v_mfma_f32_32x32x16_bf16 v[192:207], v[4:7], v[4:7], 0
  v_mfma_f32_32x32x16_bf16 v[208:223], v[4:7], v[4:7], 0
  v_mfma_f32_32x32x16_bf16 v[224:239], v[4:7], v[4:7], 0
  v_mfma_f32_32x32x16_bf16 v[240:255], v[4:7], v[4:7], 0
  s_mov_b32 s32, s18
  s_and_b32 s33, s19, 0xffff
  s_mov_b32 s35, 0x20000
  s_add_u32 s36, s8, 39845888
  s_addc_u32 s37, s9, 0
  s_and_b32 s37, s37, 0xffff
  s_mov_b32 s38, 4194304
  s_mov_b32 s39, 0x20000
  s_lshl_b32 s40, s2, 2
  s_add_u32 s40, s40, s13
  s_mul_i32 s41, s40, 7168
  s_lshl_b32 s40, s40, 12
  v_lshlrev_b32 v22, 7, v0
  v_min_u32 v22, 384, v22
  s_mov_b32 s34, 7340032
  v_mov_b32 v24, -1
  v_mov_b32 v25, -1
  v_mov_b32 v26, -1
  v_mov_b32 v27, -1
  v_min_u32 v28, 6, v0
  v_lshlrev_b32 v28, 7, v28
  s_lshr_b32 s42, s2, 3
  s_lshl_b32 s42, s42, 1
  s_and_b32 s43, s13, 1
  s_add_u32 s42, s42, s43
  s_add_u32 s42, s42, 256
  s_mul_i32 s42, s42, 7168
  s_and_b32 s43, s2, 7
  s_mul_i32 s43, s43, 896
  s_add_u32 s51, s42, s43
  s_mul_i32 s14, s11, 458752
  s_add_u32 s14, s14, 23068672
  s_add_u32 s44, s8, s14
  s_addc_u32 s45, s9, 0
  s_and_b32 s45, s45, 0xffff
  s_mov_b32 s46, 458752
  s_mov_b32 s47, 0x20000
  s_and_b32 s15, s10, 1
  s_lshr_b32 s14, s10, 4
  s_mul_i32 s14, s14, 56
  s_bfe_u32 s16, s10, 0x30001
  s_mul_i32 s17, s16, 5
  s_add_u32 s17, s17, s14
  s_add_u32 s49, s17, 2
  s_lshl_b32 s49, s49, 7
  s_add_u32 s49, s49, s15
  s_lshl_b32 s49, s49, 3
  s_mul_i32 s48, s15, 3
  s_add_u32 s48, s48, s17
  s_lshl_b32 s48, s48, 10
  s_lshl_b32 s16, s16, 1
  s_add_u32 s16, s16, s14
  s_add_u32 s16, s16, s15
  s_add_u32 s16, s16, 38
  s_lshl_b32 s50, s16, 10
  s_mov_b32 s31, 0
  s_add_u32 s60, s8, 8914944
  s_addc_u32 s61, s9, 0
  s_and_b32 s61, s61, 0xffff
  s_mov_b32 s62, 1081344
  s_mov_b32 s63, 0x20000
  v_bfe_u32 v2, v0, 2, 3
  v_mul_u32_u24 v2, 4224, v2
  v_and_b32 v3, 3, v0
  v_lshl_add_u32 v2, v3, 2, v2
  s_mul_i32 s53, s11, 33792
  v_mov_b32 v1, 1
  v_mov_b32 v30, 0
  s_mov_b32 s64, 0
  s_waitcnt vmcnt(0)
  v_and_b32 v2, 7, v0
  v_mul_u32_u24 v2, 4224, v2
  s_barrier
  s_cmp_lg_u32 s13, 0
  s_cbranch_scc1 L_g1_noflag
  s_mov_b64 exec, 1
  buffer_store_dword v1, v30, s[60:63], s52 offen sc1
  s_mov_b64 exec, -1
L_g1_noflag:
  ds_read_b64_tr_b16 a[128:129], v20 offset:0
  ds_read_b64_tr_b16 a[130:131], v20 offset:3584
  ds_read_b64_tr_b16 a[132:133], v20 offset:7168
  ds_read_b64_tr_b16 a[134:135], v20 offset:10752
  ds_read_b64_tr_b16 a[136:137], v20 offset:14336
  ds_read_b64_tr_b16 a[138:139], v20 offset:17920
  ds_read_b64_tr_b16 a[140:141], v20 offset:21504
  ds_read_b64_tr_b16 a[142:143], v20 offset:25088
  ds_read_b64_tr_b16 a[144:145], v20 offset:32
  ds_read_b64_tr_b16 a[146:147], v20 offset:3616
  buffer_store_dwordx4 a[160:163], v16, s[56:59], s54 offen offset:0 sc1
  buffer_store_dwordx4 a[164:167], v16, s[56:59], s54 offen offset:1024 sc1
  buffer_store_dwordx4 a[168:171], v16, s[56:59], s55 offen offset:0 sc1
  buffer_store_dwordx4 a[172:175], v16, s[56:59], s55 offen offset:1024 sc1
  s_sleep 16
L_g1_poll:
  s_sleep 2
  buffer_load_dword v3, v2, s[60:63], s53 offen sc1
  s_add_u32 s64, s64, 1
  s_waitcnt vmcnt(0)
  v_cmp_ne_u32 vcc, 1, v3
  s_cmp_lt_u32 s64, 0x40000
  s_cselect_b64 s[74:75], vcc, 0
  s_cmp_lg_u64 s[74:75], 0
  s_cbranch_scc1 L_g1_poll
  buffer_load_dwordx4 a[0:3], v16, s[24:27], s29 offen offset:0 sc1
  buffer_load_dwordx4 a[4:7], v17, s[24:27], s29 offen offset:0 sc1
  buffer_load_dwordx4 a[8:11], v18, s[24:27], s29 offen offset:0 sc1
  buffer_load_dwordx4 a[12:15], v19, s[24:27], s29 offen offset:0 sc1
  buffer_load_dwordx4 a[16:19], v16, s[24:27], s29 offen offset:1024 sc1
  buffer_load_dwordx4 a[20:23], v17, s[24:27], s29 offen offset:1024 sc1
  buffer_load_dwordx4 a[24:27], v18, s[24:27], s29 offen offset:1024 sc1
  buffer_load_dwordx4 a[28:31], v19, s[24:27], s29 offen offset:1024 sc1
  buffer_load_dwordx4 a[32:35], v16, s[24:27], s29 offen offset:2048 sc1
  buffer_load_dwordx4 a[36:39], v17, s[24:27], s29 offen offset:2048 sc1
  buffer_load_dwordx4 a[40:43], v18, s[24:27], s29 offen offset:2048 sc1
  buffer_load_dwordx4 a[44:47], v19, s[24:27], s29 offen offset:2048 sc1
  buffer_load_dwordx4 a[48:51], v16, s[24:27], s29 offen offset:3072 sc1
  buffer_load_dwordx4 a[52:55], v17, s[24:27], s29 offen offset:3072 sc1
  buffer_load_dwordx4 a[56:59], v18, s[24:27], s29 offen offset:3072 sc1
  buffer_load_dwordx4 a[60:63], v19, s[24:27], s29 offen offset:3072 sc1
  s_add_u32 s29, s29, 4096
  ds_read_b64_tr_b16 a[128:129], v20 offset:0
  ds_read_b64_tr_b16 a[130:131], v20 offset:3584
  ds_read_b64_tr_b16 a[132:133], v20 offset:7168
  ds_read_b64_tr_b16 a[134:135], v20 offset:10752
  ds_read_b64_tr_b16 a[136:137], v20 offset:14336
  ds_read_b64_tr_b16 a[138:139], v20 offset:17920
  ds_read_b64_tr_b16 a[140:141], v20 offset:21504
  ds_read_b64_tr_b16 a[142:143], v20 offset:25088
  ds_read_b64_tr_b16 a[144:145], v20 offset:32
  ds_read_b64_tr_b16 a[146:147], v20 offset:3616
.p2align 6
L_g1_loop:
  s_waitcnt vmcnt(8)
  s_waitcnt lgkmcnt(6)
  v_mfma_f32_16x16x32_bf16 v[32:35], a[128:131], a[0:3], v[32:35]
  ds_read_b64_tr_b16 a[148:149], v20 offset:7200
  v_mfma_f32_16x16x32_bf16 v[32:35], a[132:135], a[16:19], v[32:35]
  ds_read_b64_tr_b16 a[150:151], v20 offset:10784
  s_add_u32 m0, s30, 57344
  v_mfma_f32_16x16x32_bf16 v[36:39], a[132:135], a[20:23], v[36:39]
  buffer_load_dwordx4 v8, s[20:23], s28 offen offset:0 lds
  v_mfma_f32_16x16x32_bf16 v[36:39], a[128:131], a[4:7], v[36:39]
  v_mfma_f32_16x16x32_bf16 v[40:43], a[128:131], a[8:11], v[40:43]
  ds_read_b64_tr_b16 a[152:153], v20 offset:14368
  v_mfma_f32_16x16x32_bf16 v[40:43], a[132:135], a[24:27], v[40:43]
  ds_read_b64_tr_b16 a[154:155], v20 offset:17952
  v_mfma_f32_16x16x32_bf16 v[44:47], a[132:135], a[28:31], v[44:47]
  v_mfma_f32_16x16x32_bf16 v[44:47], a[128:131], a[12:15], v[44:47]
  s_waitcnt lgkmcnt(6)
  v_mfma_f32_16x16x32_bf16 v[60:63], a[136:139], a[12:15], v[60:63]
  ds_read_b64_tr_b16 a[128:129], v20 offset:21536
  v_mfma_f32_16x16x32_bf16 v[60:63], a[140:143], a[28:31], v[60:63]
  ds_read_b64_tr_b16 a[130:131], v20 offset:25120
  v_mfma_f32_16x16x32_bf16 v[56:59], a[140:143], a[24:27], v[56:59]
  buffer_load_dwordx4 v9, s[20:23], s28 offen offset:1024 lds
  v_mfma_f32_16x16x32_bf16 v[56:59], a[136:139], a[8:11], v[56:59]
  v_mfma_f32_16x16x32_bf16 v[52:55], a[136:139], a[4:7], v[52:55]
  ds_read_b64_tr_b16 a[132:133], v20 offset:64
  v_mfma_f32_16x16x32_bf16 v[52:55], a[140:143], a[20:23], v[52:55]
  ds_read_b64_tr_b16 a[134:135], v20 offset:3648
  v_mfma_f32_16x16x32_bf16 v[48:51], a[140:143], a[16:19], v[48:51]
  v_mfma_f32_16x16x32_bf16 v[48:51], a[136:139], a[0:3], v[48:51]
  s_waitcnt lgkmcnt(6)
  v_mfma_f32_16x16x32_bf16 v[64:67], a[144:147], a[0:3], v[64:67]
  ds_read_b64_tr_b16 a[136:137], v20 offset:7232
  v_mfma_f32_16x16x32_bf16 v[64:67], a[148:151], a[16:19], v[64:67]
  ds_read_b64_tr_b16 a[138:139], v20 offset:10816
  v_mfma_f32_16x16x32_bf16 v[68:71], a[148:151], a[20:23], v[68:71]
  buffer_load_dwordx4 v10, s[20:23], s28 offen offset:2048 lds
  v_mfma_f32_16x16x32_bf16 v[68:71], a[144:147], a[4:7], v[68:71]
  v_mfma_f32_16x16x32_bf16 v[72:75], a[144:147], a[8:11], v[72:75]
  ds_read_b64_tr_b16 a[140:141], v20 offset:14400
  v_mfma_f32_16x16x32_bf16 v[72:75], a[148:151], a[24:27], v[72:75]
  ds_read_b64_tr_b16 a[142:143], v20 offset:17984
  v_mfma_f32_16x16x32_bf16 v[76:79], a[148:151], a[28:31], v[76:79]
  v_mfma_f32_16x16x32_bf16 v[76:79], a[144:147], a[12:15], v[76:79]
  s_waitcnt lgkmcnt(6)
  v_mfma_f32_16x16x32_bf16 v[92:95], a[152:155], a[12:15], v[92:95]
  ds_read_b64_tr_b16 a[144:145], v20 offset:21568
  v_mfma_f32_16x16x32_bf16 v[92:95], a[128:131], a[28:31], v[92:95]
  ds_read_b64_tr_b16 a[146:147], v20 offset:25152
  v_mfma_f32_16x16x32_bf16 v[88:91], a[128:131], a[24:27], v[88:91]
  buffer_load_dwordx4 v11, s[20:23], s28 offen offset:3072 lds
  v_mfma_f32_16x16x32_bf16 v[88:91], a[152:155], a[8:11], v[88:91]
  v_mfma_f32_16x16x32_bf16 v[84:87], a[152:155], a[4:7], v[84:87]
  ds_read_b64_tr_b16 a[148:149], v20 offset:96
  v_mfma_f32_16x16x32_bf16 v[84:87], a[128:131], a[20:23], v[84:87]
  ds_read_b64_tr_b16 a[150:151], v20 offset:3680
  v_mfma_f32_16x16x32_bf16 v[80:83], a[128:131], a[16:19], v[80:83]
  v_mfma_f32_16x16x32_bf16 v[80:83], a[152:155], a[0:3], v[80:83]
  s_waitcnt lgkmcnt(6)
  v_mfma_f32_16x16x32_bf16 v[96:99], a[132:135], a[0:3], v[96:99]
  ds_read_b64_tr_b16 a[152:153], v20 offset:7264
  v_mfma_f32_16x16x32_bf16 v[96:99], a[136:139], a[16:19], v[96:99]
  ds_read_b64_tr_b16 a[154:155], v20 offset:10848
  s_add_u32 m0, s30, 61440
  v_mfma_f32_16x16x32_bf16 v[100:103], a[136:139], a[20:23], v[100:103]
  buffer_load_dwordx4 v12, s[20:23], s28 offen offset:0 lds
  v_mfma_f32_16x16x32_bf16 v[100:103], a[132:135], a[4:7], v[100:103]
  v_mfma_f32_16x16x32_bf16 v[104:107], a[132:135], a[8:11], v[104:107]
  ds_read_b64_tr_b16 a[128:129], v20 offset:14432
  v_mfma_f32_16x16x32_bf16 v[104:107], a[136:139], a[24:27], v[104:107]
  ds_read_b64_tr_b16 a[130:131], v20 offset:18016
  v_mfma_f32_16x16x32_bf16 v[108:111], a[136:139], a[28:31], v[108:111]
  v_mfma_f32_16x16x32_bf16 v[108:111], a[132:135], a[12:15], v[108:111]
  s_waitcnt lgkmcnt(6)
  v_mfma_f32_16x16x32_bf16 v[124:127], a[140:143], a[12:15], v[124:127]
  ds_read_b64_tr_b16 a[132:133], v20 offset:21600
  v_mfma_f32_16x16x32_bf16 v[124:127], a[144:147], a[28:31], v[124:127]
  ds_read_b64_tr_b16 a[134:135], v20 offset:25184
  v_mfma_f32_16x16x32_bf16 v[120:123], a[144:147], a[24:27], v[120:123]
  buffer_load_dwordx4 v13, s[20:23], s28 offen offset:1024 lds
  v_mfma_f32_16x16x32_bf16 v[120:123], a[140:143], a[8:11], v[120:123]
  v_mfma_f32_16x16x32_bf16 v[116:119], a[140:143], a[4:7], v[116:119]
  ds_read_b64_tr_b16 a[136:137], v20 offset:128
  v_mfma_f32_16x16x32_bf16 v[116:119], a[144:147], a[20:23], v[116:119]
  ds_read_b64_tr_b16 a[138:139], v20 offset:3712
  v_mfma_f32_16x16x32_bf16 v[112:115], a[144:147], a[16:19], v[112:115]
  v_mfma_f32_16x16x32_bf16 v[112:115], a[140:143], a[0:3], v[112:115]
  s_waitcnt lgkmcnt(6)
  v_mfma_f32_16x16x32_bf16 v[128:131], a[148:151], a[0:3], v[128:131]
  ds_read_b64_tr_b16 a[140:141], v20 offset:7296
  v_mfma_f32_16x16x32_bf16 v[128:131], a[152:155], a[16:19], v[128:131]
  ds_read_b64_tr_b16 a[142:143], v20 offset:10880
  v_mfma_f32_16x16x32_bf16 v[132:135], a[152:155], a[20:23], v[132:135]
  buffer_load_dwordx4 v14, s[20:23], s28 offen offset:2048 lds
  s_add_u32 s28, s28, 458752
  v_mfma_f32_16x16x32_bf16 v[132:135], a[148:151], a[4:7], v[132:135]
  v_mfma_f32_16x16x32_bf16 v[136:139], a[148:151], a[8:11], v[136:139]
  ds_read_b64_tr_b16 a[144:145], v20 offset:14464
  v_mfma_f32_16x16x32_bf16 v[136:139], a[152:155], a[24:27], v[136:139]
  ds_read_b64_tr_b16 a[146:147], v20 offset:18048
  v_mfma_f32_16x16x32_bf16 v[140:143], a[152:155], a[28:31], v[140:143]
  buffer_load_dwordx4 a[64:67], v16, s[24:27], s29 offen offset:0 sc1
  v_mfma_f32_16x16x32_bf16 v[140:143], a[148:151], a[12:15], v[140:143]
  s_waitcnt lgkmcnt(6)
  v_mfma_f32_16x16x32_bf16 v[156:159], a[128:131], a[12:15], v[156:159]
  ds_read_b64_tr_b16 a[148:149], v20 offset:21632
  v_mfma_f32_16x16x32_bf16 v[156:159], a[132:135], a[28:31], v[156:159]
  ds_read_b64_tr_b16 a[150:151], v20 offset:25216
  v_mfma_f32_16x16x32_bf16 v[152:155], a[132:135], a[24:27], v[152:155]
  buffer_load_dword v29, v28, s[20:23], s51 offen
  s_add_u32 s51, s51, 458752
  v_mfma_f32_16x16x32_bf16 v[152:155], a[128:131], a[8:11], v[152:155]
  v_mfma_f32_16x16x32_bf16 v[148:151], a[128:131], a[4:7], v[148:151]
  ds_read_b64_tr_b16 a[152:153], v20 offset:160
  v_mfma_f32_16x16x32_bf16 v[148:151], a[132:135], a[20:23], v[148:151]
  ds_read_b64_tr_b16 a[154:155], v20 offset:3744
  v_mfma_f32_16x16x32_bf16 v[144:147], a[132:135], a[16:19], v[144:147]
  buffer_load_dwordx4 a[68:71], v17, s[24:27], s29 offen offset:0 sc1
  v_mfma_f32_16x16x32_bf16 v[144:147], a[128:131], a[0:3], v[144:147]
  s_waitcnt lgkmcnt(6)
  v_mfma_f32_16x16x32_bf16 v[160:163], a[136:139], a[0:3], v[160:163]
  ds_read_b64_tr_b16 a[128:129], v20 offset:7328
  v_mfma_f32_16x16x32_bf16 v[160:163], a[140:143], a[16:19], v[160:163]
  ds_read_b64_tr_b16 a[130:131], v20 offset:10912
  v_mfma_f32_16x16x32_bf16 v[164:167], a[140:143], a[20:23], v[164:167]
  buffer_load_dword v29, v22, s[32:35], s41 offen
  s_add_u32 s41, s41, 512
  v_mfma_f32_16x16x32_bf16 v[164:167], a[136:139], a[4:7], v[164:167]
  v_mfma_f32_16x16x32_bf16 v[168:171], a[136:139], a[8:11], v[168:171]
  ds_read_b64_tr_b16 a[132:133], v20 offset:14496
  v_mfma_f32_16x16x32_bf16 v[168:171], a[140:143], a[24:27], v[168:171]
  ds_read_b64_tr_b16 a[134:135], v20 offset:18080
  v_mfma_f32_16x16x32_bf16 v[172:175], a[140:143], a[28:31], v[172:175]
  buffer_load_dwordx4 a[72:75], v18, s[24:27], s29 offen offset:0 sc1
  v_mfma_f32_16x16x32_bf16 v[172:175], a[136:139], a[12:15], v[172:175]
  s_waitcnt lgkmcnt(6)
  v_mfma_f32_16x16x32_bf16 v[188:191], a[144:147], a[12:15], v[188:191]
  ds_read_b64_tr_b16 a[136:137], v20 offset:21664
  v_mfma_f32_16x16x32_bf16 v[188:191], a[148:151], a[28:31], v[188:191]
  ds_read_b64_tr_b16 a[138:139], v20 offset:25248
  v_mfma_f32_16x16x32_bf16 v[184:187], a[148:151], a[24:27], v[184:187]
  v_mfma_f32_16x16x32_bf16 v[184:187], a[144:147], a[8:11], v[184:187]
  v_mfma_f32_16x16x32_bf16 v[180:183], a[144:147], a[4:7], v[180:183]
  ds_read_b64_tr_b16 a[140:141], v20 offset:192
  v_mfma_f32_16x16x32_bf16 v[180:183], a[148:151], a[20:23], v[180:183]
  ds_read_b64_tr_b16 a[142:143], v20 offset:3776
  v_mfma_f32_16x16x32_bf16 v[176:179], a[148:151], a[16:19], v[176:179]
  buffer_load_dwordx4 a[76:79], v19, s[24:27], s29 offen offset:0 sc1
  v_mfma_f32_16x16x32_bf16 v[176:179], a[144:147], a[0:3], v[176:179]
  s_waitcnt lgkmcnt(6)
  v_mfma_f32_16x16x32_bf16 v[192:195], a[152:155], a[0:3], v[192:195]
  ds_read_b64_tr_b16 a[144:145], v20 offset:7360
  v_mfma_f32_16x16x32_bf16 v[192:195], a[128:131], a[16:19], v[192:195]
  ds_read_b64_tr_b16 a[146:147], v20 offset:10944
  v_mfma_f32_16x16x32_bf16 v[196:199], a[128:131], a[20:23], v[196:199]
  v_mfma_f32_16x16x32_bf16 v[196:199], a[152:155], a[4:7], v[196:199]
  v_mfma_f32_16x16x32_bf16 v[200:203], a[152:155], a[8:11], v[200:203]
  ds_read_b64_tr_b16 a[148:149], v20 offset:14528
  v_mfma_f32_16x16x32_bf16 v[200:203], a[128:131], a[24:27], v[200:203]
  ds_read_b64_tr_b16 a[150:151], v20 offset:18112
  v_mfma_f32_16x16x32_bf16 v[204:207], a[128:131], a[28:31], v[204:207]
  buffer_load_dwordx4 a[80:83], v16, s[24:27], s29 offen offset:1024 sc1
  v_mfma_f32_16x16x32_bf16 v[204:207], a[152:155], a[12:15], v[204:207]
  s_waitcnt lgkmcnt(6)
  v_mfma_f32_16x16x32_bf16 v[220:223], a[132:135], a[12:15], v[220:223]
  ds_read_b64_tr_b16 a[152:153], v20 offset:21696
  v_mfma_f32_16x16x32_bf16 v[220:223], a[136:139], a[28:31], v[220:223]
  ds_read_b64_tr_b16 a[154:155], v20 offset:25280
  v_mfma_f32_16x16x32_bf16 v[216:219], a[136:139], a[24:27], v[216:219]
  v_mfma_f32_16x16x32_bf16 v[216:219], a[132:135], a[8:11], v[216:219]
  s_waitcnt vmcnt(24)
  s_barrier
  v_mfma_f32_16x16x32_bf16 v[212:215], a[132:135], a[4:7], v[212:215]
  ds_read_b64_tr_b16 a[128:129], v20 offset:28672
  v_mfma_f32_16x16x32_bf16 v[212:215], a[136:139], a[20:23], v[212:215]
  ds_read_b64_tr_b16 a[130:131], v20 offset:32256
  v_mfma_f32_16x16x32_bf16 v[208:211], a[136:139], a[16:19], v[208:211]
  buffer_load_dwordx4 a[84:87], v17, s[24:27], s29 offen offset:1024 sc1
  v_mfma_f32_16x16x32_bf16 v[208:211], a[132:135], a[0:3], v[208:211]
  s_waitcnt lgkmcnt(6)
  v_mfma_f32_16x16x32_bf16 v[224:227], a[140:143], a[0:3], v[224:227]
  ds_read_b64_tr_b16 a[132:133], v20 offset:35840
  v_mfma_f32_16x16x32_bf16 v[224:227], a[144:147], a[16:19], v[224:227]
  ds_read_b64_tr_b16 a[134:135], v20 offset:39424
  v_mfma_f32_16x16x32_bf16 v[228:231], a[144:147], a[20:23], v[228:231]
  v_mfma_f32_16x16x32_bf16 v[228:231], a[140:143], a[4:7], v[228:231]
  v_mfma_f32_16x16x32_bf16 v[232:235], a[140:143], a[8:11], v[232:235]
  ds_read_b64_tr_b16 a[136:137], v20 offset:43008
  v_mfma_f32_16x16x32_bf16 v[232:235], a[144:147], a[24:27], v[232:235]
  ds_read_b64_tr_b16 a[138:139], v20 offset:46592
  v_mfma_f32_16x16x32_bf16 v[236:239], a[144:147], a[28:31], v[236:239]
  buffer_load_dwordx4 a[88:91], v18, s[24:27], s29 offen offset:1024 sc1
  v_mfma_f32_16x16x32_bf16 v[236:239], a[140:143], a[12:15], v[236:239]
  s_waitcnt lgkmcnt(6)
  v_mfma_f32_16x16x32_bf16 v[252:255], a[148:151], a[12:15], v[252:255]
  ds_read_b64_tr_b16 a[140:141], v20 offset:50176
  v_mfma_f32_16x16x32_bf16 v[252:255], a[152:155], a[28:31], v[252:255]
  ds_read_b64_tr_b16 a[142:143], v20 offset:53760
  v_mfma_f32_16x16x32_bf16 v[248:251], a[152:155], a[24:27], v[248:251]
  v_mfma_f32_16x16x32_bf16 v[248:251], a[148:151], a[8:11], v[248:251]
  v_mfma_f32_16x16x32_bf16 v[244:247], a[148:151], a[4:7], v[244:247]
  ds_read_b64_tr_b16 a[144:145], v20 offset:28704
  v_mfma_f32_16x16x32_bf16 v[244:247], a[152:155], a[20:23], v[244:247]
  ds_read_b64_tr_b16 a[146:147], v20 offset:32288
  v_mfma_f32_16x16x32_bf16 v[240:243], a[152:155], a[16:19], v[240:243]
  buffer_load_dwordx4 a[92:95], v19, s[24:27], s29 offen offset:1024 sc1
  v_mfma_f32_16x16x32_bf16 v[240:243], a[148:151], a[0:3], v[240:243]
  s_waitcnt vmcnt(17)
  s_waitcnt lgkmcnt(6)
  v_mfma_f32_16x16x32_bf16 v[32:35], a[128:131], a[32:35], v[32:35]
  ds_read_b64_tr_b16 a[148:149], v20 offset:35872
  v_mfma_f32_16x16x32_bf16 v[32:35], a[132:135], a[48:51], v[32:35]
  ds_read_b64_tr_b16 a[150:151], v20 offset:39456
  s_add_u32 m0, s30, 86016
  v_mfma_f32_16x16x32_bf16 v[36:39], a[132:135], a[52:55], v[36:39]
  buffer_load_dwordx4 v8, s[20:23], s28 offen offset:0 lds
  v_mfma_f32_16x16x32_bf16 v[36:39], a[128:131], a[36:39], v[36:39]
  v_mfma_f32_16x16x32_bf16 v[40:43], a[128:131], a[40:43], v[40:43]
  ds_read_b64_tr_b16 a[152:153], v20 offset:43040
  v_mfma_f32_16x16x32_bf16 v[40:43], a[132:135], a[56:59], v[40:43]
  ds_read_b64_tr_b16 a[154:155], v20 offset:46624
  v_mfma_f32_16x16x32_bf16 v[44:47], a[132:135], a[60:63], v[44:47]
  v_mfma_f32_16x16x32_bf16 v[44:47], a[128:131], a[44:47], v[44:47]
  s_waitcnt lgkmcnt(6)
  v_mfma_f32_16x16x32_bf16 v[60:63], a[136:139], a[44:47], v[60:63]
  ds_read_b64_tr_b16 a[128:129], v20 offset:50208
  v_mfma_f32_16x16x32_bf16 v[60:63], a[140:143], a[60:63], v[60:63]
  ds_read_b64_tr_b16 a[130:131], v20 offset:53792
  v_mfma_f32_16x16x32_bf16 v[56:59], a[140:143], a[56:59], v[56:59]
  buffer_load_dwordx4 v9, s[20:23], s28 offen offset:1024 lds
  v_mfma_f32_16x16x32_bf16 v[56:59], a[136:139], a[40:43], v[56:59]
  v_mfma_f32_16x16x32_bf16 v[52:55], a[136:139], a[36:39], v[52:55]
  ds_read_b64_tr_b16 a[132:133], v20 offset:28736
  v_mfma_f32_16x16x32_bf16 v[52:55], a[140:143], a[52:55], v[52:55]
  ds_read_b64_tr_b16 a[134:135], v20 offset:32320
  v_mfma_f32_16x16x32_bf16 v[48:51], a[140:143], a[48:51], v[48:51]
  v_mfma_f32_16x16x32_bf16 v[48:51], a[136:139], a[32:35], v[48:51]
  s_waitcnt lgkmcnt(6)
  v_mfma_f32_16x16x32_bf16 v[64:67], a[144:147], a[32:35], v[64:67]
  ds_read_b64_tr_b16 a[136:137], v20 offset:35904
  v_mfma_f32_16x16x32_bf16 v[64:67], a[148:151], a[48:51], v[64:67]
  ds_read_b64_tr_b16 a[138:139], v20 offset:39488
  v_mfma_f32_16x16x32_bf16 v[68:71], a[148:151], a[52:55], v[68:71]
  buffer_load_dwordx4 v10, s[20:23], s28 offen offset:2048 lds
  v_mfma_f32_16x16x32_bf16 v[68:71], a[144:147], a[36:39], v[68:71]
  v_mfma_f32_16x16x32_bf16 v[72:75], a[144:147], a[40:43], v[72:75]
  ds_read_b64_tr_b16 a[140:141], v20 offset:43072
  v_mfma_f32_16x16x32_bf16 v[72:75], a[148:151], a[56:59], v[72:75]
  ds_read_b64_tr_b16 a[142:143], v20 offset:46656
  v_mfma_f32_16x16x32_bf16 v[76:79], a[148:151], a[60:63], v[76:79]
  v_mfma_f32_16x16x32_bf16 v[76:79], a[144:147], a[44:47], v[76:79]
  s_waitcnt lgkmcnt(6)
  v_mfma_f32_16x16x32_bf16 v[92:95], a[152:155], a[44:47], v[92:95]
  ds_read_b64_tr_b16 a[144:145], v20 offset:50240
  v_mfma_f32_16x16x32_bf16 v[92:95], a[128:131], a[60:63], v[92:95]
  ds_read_b64_tr_b16 a[146:147], v20 offset:53824
  v_mfma_f32_16x16x32_bf16 v[88:91], a[128:131], a[56:59], v[88:91]
  buffer_load_dwordx4 v11, s[20:23], s28 offen offset:3072 lds
  v_mfma_f32_16x16x32_bf16 v[88:91], a[152:155], a[40:43], v[88:91]
  v_mfma_f32_16x16x32_bf16 v[84:87], a[152:155], a[36:39], v[84:87]
  ds_read_b64_tr_b16 a[148:149], v20 offset:28768
  v_mfma_f32_16x16x32_bf16 v[84:87], a[128:131], a[52:55], v[84:87]
  ds_read_b64_tr_b16 a[150:151], v20 offset:32352
  v_mfma_f32_16x16x32_bf16 v[80:83], a[128:131], a[48:51], v[80:83]
  v_mfma_f32_16x16x32_bf16 v[80:83], a[152:155], a[32:35], v[80:83]
  s_waitcnt lgkmcnt(6)
  v_mfma_f32_16x16x32_bf16 v[96:99], a[132:135], a[32:35], v[96:99]
  ds_read_b64_tr_b16 a[152:153], v20 offset:35936
  v_mfma_f32_16x16x32_bf16 v[96:99], a[136:139], a[48:51], v[96:99]
  ds_read_b64_tr_b16 a[154:155], v20 offset:39520
  s_add_u32 m0, s30, 90112
  v_mfma_f32_16x16x32_bf16 v[100:103], a[136:139], a[52:55], v[100:103]
  buffer_load_dwordx4 v12, s[20:23], s28 offen offset:0 lds
  v_mfma_f32_16x16x32_bf16 v[100:103], a[132:135], a[36:39], v[100:103]
  v_mfma_f32_16x16x32_bf16 v[104:107], a[132:135], a[40:43], v[104:107]
  ds_read_b64_tr_b16 a[128:129], v20 offset:43104
  v_mfma_f32_16x16x32_bf16 v[104:107], a[136:139], a[56:59], v[104:107]
  ds_read_b64_tr_b16 a[130:131], v20 offset:46688
  v_mfma_f32_16x16x32_bf16 v[108:111], a[136:139], a[60:63], v[108:111]
  v_mfma_f32_16x16x32_bf16 v[108:111], a[132:135], a[44:47], v[108:111]
  s_waitcnt lgkmcnt(6)
  v_mfma_f32_16x16x32_bf16 v[124:127], a[140:143], a[44:47], v[124:127]
  ds_read_b64_tr_b16 a[132:133], v20 offset:50272
  v_mfma_f32_16x16x32_bf16 v[124:127], a[144:147], a[60:63], v[124:127]
  ds_read_b64_tr_b16 a[134:135], v20 offset:53856
  v_mfma_f32_16x16x32_bf16 v[120:123], a[144:147], a[56:59], v[120:123]
  buffer_load_dwordx4 v13, s[20:23], s28 offen offset:1024 lds
  v_mfma_f32_16x16x32_bf16 v[120:123], a[140:143], a[40:43], v[120:123]
  v_mfma_f32_16x16x32_bf16 v[116:119], a[140:143], a[36:39], v[116:119]
  ds_read_b64_tr_b16 a[136:137], v20 offset:28800
  v_mfma_f32_16x16x32_bf16 v[116:119], a[144:147], a[52:55], v[116:119]
  ds_read_b64_tr_b16 a[138:139], v20 offset:32384
  v_mfma_f32_16x16x32_bf16 v[112:115], a[144:147], a[48:51], v[112:115]
  v_mfma_f32_16x16x32_bf16 v[112:115], a[140:143], a[32:35], v[112:115]
  s_waitcnt lgkmcnt(6)
  v_mfma_f32_16x16x32_bf16 v[128:131], a[148:151], a[32:35], v[128:131]
  ds_read_b64_tr_b16 a[140:141], v20 offset:35968
  v_mfma_f32_16x16x32_bf16 v[128:131], a[152:155], a[48:51], v[128:131]
  ds_read_b64_tr_b16 a[142:143], v20 offset:39552
  v_mfma_f32_16x16x32_bf16 v[132:135], a[152:155], a[52:55], v[132:135]
  buffer_load_dwordx4 v14, s[20:23], s28 offen offset:2048 lds
  s_add_u32 s28, s28, 458752
  v_mfma_f32_16x16x32_bf16 v[132:135], a[148:151], a[36:39], v[132:135]
  v_mfma_f32_16x16x32_bf16 v[136:139], a[148:151], a[40:43], v[136:139]
  ds_read_b64_tr_b16 a[144:145], v20 offset:43136
  v_mfma_f32_16x16x32_bf16 v[136:139], a[152:155], a[56:59], v[136:139]
  ds_read_b64_tr_b16 a[146:147], v20 offset:46720
  v_mfma_f32_16x16x32_bf16 v[140:143], a[152:155], a[60:63], v[140:143]
  buffer_load_dwordx4 a[96:99], v16, s[24:27], s29 offen offset:2048 sc1
  v_mfma_f32_16x16x32_bf16 v[140:143], a[148:151], a[44:47], v[140:143]
  s_waitcnt lgkmcnt(6)
  v_mfma_f32_16x16x32_bf16 v[156:159], a[128:131], a[44:47], v[156:159]
  ds_read_b64_tr_b16 a[148:149], v20 offset:50304
  v_mfma_f32_16x16x32_bf16 v[156:159], a[132:135], a[60:63], v[156:159]
  ds_read_b64_tr_b16 a[150:151], v20 offset:53888
  v_mfma_f32_16x16x32_bf16 v[152:155], a[132:135], a[56:59], v[152:155]
  buffer_load_dword v29, v28, s[20:23], s51 offen
  s_add_u32 s51, s51, 458752
  v_mfma_f32_16x16x32_bf16 v[152:155], a[128:131], a[40:43], v[152:155]
  v_mfma_f32_16x16x32_bf16 v[148:151], a[128:131], a[36:39], v[148:151]
  ds_read_b64_tr_b16 a[152:153], v20 offset:28832
  v_mfma_f32_16x16x32_bf16 v[148:151], a[132:135], a[52:55], v[148:151]
  ds_read_b64_tr_b16 a[154:155], v20 offset:32416
  v_mfma_f32_16x16x32_bf16 v[144:147], a[132:135], a[48:51], v[144:147]
  buffer_load_dwordx4 a[100:103], v17, s[24:27], s29 offen offset:2048 sc1
  v_mfma_f32_16x16x32_bf16 v[144:147], a[128:131], a[32:35], v[144:147]
  s_waitcnt lgkmcnt(6)
  v_mfma_f32_16x16x32_bf16 v[160:163], a[136:139], a[32:35], v[160:163]
  ds_read_b64_tr_b16 a[128:129], v20 offset:36000
  v_mfma_f32_16x16x32_bf16 v[160:163], a[140:143], a[48:51], v[160:163]
  ds_read_b64_tr_b16 a[130:131], v20 offset:39584
  v_mfma_f32_16x16x32_bf16 v[164:167], a[140:143], a[52:55], v[164:167]
  buffer_load_dword v29, v22, s[32:35], s41 offen
  s_add_u32 s41, s41, 512
  v_mfma_f32_16x16x32_bf16 v[164:167], a[136:139], a[36:39], v[164:167]
  v_mfma_f32_16x16x32_bf16 v[168:171], a[136:139], a[40:43], v[168:171]
  ds_read_b64_tr_b16 a[132:133], v20 offset:43168
  v_mfma_f32_16x16x32_bf16 v[168:171], a[140:143], a[56:59], v[168:171]
  ds_read_b64_tr_b16 a[134:135], v20 offset:46752
  v_mfma_f32_16x16x32_bf16 v[172:175], a[140:143], a[60:63], v[172:175]
  buffer_load_dwordx4 a[104:107], v18, s[24:27], s29 offen offset:2048 sc1
  v_mfma_f32_16x16x32_bf16 v[172:175], a[136:139], a[44:47], v[172:175]
  s_waitcnt lgkmcnt(6)
  v_mfma_f32_16x16x32_bf16 v[188:191], a[144:147], a[44:47], v[188:191]
  ds_read_b64_tr_b16 a[136:137], v20 offset:50336
  v_mfma_f32_16x16x32_bf16 v[188:191], a[148:151], a[60:63], v[188:191]
  ds_read_b64_tr_b16 a[138:139], v20 offset:53920
  v_mfma_f32_16x16x32_bf16 v[184:187], a[148:151], a[56:59], v[184:187]
  v_mfma_f32_16x16x32_bf16 v[184:187], a[144:147], a[40:43], v[184:187]
  v_mfma_f32_16x16x32_bf16 v[180:183], a[144:147], a[36:39], v[180:183]
  ds_read_b64_tr_b16 a[140:141], v20 offset:28864
  v_mfma_f32_16x16x32_bf16 v[180:183], a[148:151], a[52:55], v[180:183]
  ds_read_b64_tr_b16 a[142:143], v20 offset:32448
  v_mfma_f32_16x16x32_bf16 v[176:179], a[148:151], a[48:51], v[176:179]
  buffer_load_dwordx4 a[108:111], v19, s[24:27], s29 offen offset:2048 sc1
  v_mfma_f32_16x16x32_bf16 v[176:179], a[144:147], a[32:35], v[176:179]
  s_waitcnt lgkmcnt(6)
  v_mfma_f32_16x16x32_bf16 v[192:195], a[152:155], a[32:35], v[192:195]
  ds_read_b64_tr_b16 a[144:145], v20 offset:36032
  v_mfma_f32_16x16x32_bf16 v[192:195], a[128:131], a[48:51], v[192:195]
  ds_read_b64_tr_b16 a[146:147], v20 offset:39616
  v_mfma_f32_16x16x32_bf16 v[196:199], a[128:131], a[52:55], v[196:199]
  v_mfma_f32_16x16x32_bf16 v[196:199], a[152:155], a[36:39], v[196:199]
  v_mfma_f32_16x16x32_bf16 v[200:203], a[152:155], a[40:43], v[200:203]
  ds_read_b64_tr_b16 a[148:149], v20 offset:43200
  v_mfma_f32_16x16x32_bf16 v[200:203], a[128:131], a[56:59], v[200:203]
  ds_read_b64_tr_b16 a[150:151], v20 offset:46784
  v_mfma_f32_16x16x32_bf16 v[204:207], a[128:131], a[60:63], v[204:207]
  buffer_load_dwordx4 a[112:115], v16, s[24:27], s29 offen offset:3072 sc1
  v_mfma_f32_16x16x32_bf16 v[204:207], a[152:155], a[44:47], v[204:207]
  s_waitcnt lgkmcnt(6)
  v_mfma_f32_16x16x32_bf16 v[220:223], a[132:135], a[44:47], v[220:223]
  ds_read_b64_tr_b16 a[152:153], v20 offset:50368
  v_mfma_f32_16x16x32_bf16 v[220:223], a[136:139], a[60:63], v[220:223]
  ds_read_b64_tr_b16 a[154:155], v20 offset:53952
  v_mfma_f32_16x16x32_bf16 v[216:219], a[136:139], a[56:59], v[216:219]
  v_mfma_f32_16x16x32_bf16 v[216:219], a[132:135], a[40:43], v[216:219]
  s_waitcnt vmcnt(24)
  s_barrier
  v_mfma_f32_16x16x32_bf16 v[212:215], a[132:135], a[36:39], v[212:215]
  ds_read_b64_tr_b16 a[128:129], v21 offset:0
  v_mfma_f32_16x16x32_bf16 v[212:215], a[136:139], a[52:55], v[212:215]
  ds_read_b64_tr_b16 a[130:131], v21 offset:3584
  v_mfma_f32_16x16x32_bf16 v[208:211], a[136:139], a[48:51], v[208:211]
  buffer_load_dwordx4 a[116:119], v17, s[24:27], s29 offen offset:3072 sc1
  v_mfma_f32_16x16x32_bf16 v[208:211], a[132:135], a[32:35], v[208:211]
  s_waitcnt lgkmcnt(6)
  v_mfma_f32_16x16x32_bf16 v[224:227], a[140:143], a[32:35], v[224:227]
  ds_read_b64_tr_b16 a[132:133], v21 offset:7168
  v_mfma_f32_16x16x32_bf16 v[224:227], a[144:147], a[48:51], v[224:227]
  ds_read_b64_tr_b16 a[134:135], v21 offset:10752
  v_mfma_f32_16x16x32_bf16 v[228:231], a[144:147], a[52:55], v[228:231]
  v_mfma_f32_16x16x32_bf16 v[228:231], a[140:143], a[36:39], v[228:231]
  v_mfma_f32_16x16x32_bf16 v[232:235], a[140:143], a[40:43], v[232:235]
  ds_read_b64_tr_b16 a[136:137], v21 offset:14336
  v_mfma_f32_16x16x32_bf16 v[232:235], a[144:147], a[56:59], v[232:235]
  ds_read_b64_tr_b16 a[138:139], v21 offset:17920
  v_mfma_f32_16x16x32_bf16 v[236:239], a[144:147], a[60:63], v[236:239]
  buffer_load_dwordx4 a[120:123], v18, s[24:27], s29 offen offset:3072 sc1
  v_mfma_f32_16x16x32_bf16 v[236:239], a[140:143], a[44:47], v[236:239]
  s_waitcnt lgkmcnt(6)
  v_mfma_f32_16x16x32_bf16 v[252:255], a[148:151], a[44:47], v[252:255]
  ds_read_b64_tr_b16 a[140:141], v21 offset:21504
  v_mfma_f32_16x16x32_bf16 v[252:255], a[152:155], a[60:63], v[252:255]
  ds_read_b64_tr_b16 a[142:143], v21 offset:25088
  v_mfma_f32_16x16x32_bf16 v[248:251], a[152:155], a[56:59], v[248:251]
  buffer_store_dwordx4 v[24:27], v16, s[36:39], s40 offen sc1
  s_add_u32 s40, s40, 1024
  v_mfma_f32_16x16x32_bf16 v[248:251], a[148:151], a[40:43], v[248:251]
  v_mfma_f32_16x16x32_bf16 v[244:247], a[148:151], a[36:39], v[244:247]
  ds_read_b64_tr_b16 a[144:145], v21 offset:32
  v_mfma_f32_16x16x32_bf16 v[244:247], a[152:155], a[52:55], v[244:247]
  ds_read_b64_tr_b16 a[146:147], v21 offset:3616
  v_mfma_f32_16x16x32_bf16 v[240:243], a[152:155], a[48:51], v[240:243]
  buffer_load_dwordx4 a[124:127], v19, s[24:27], s29 offen offset:3072 sc1
  s_add_u32 s29, s29, 4096
  v_mfma_f32_16x16x32_bf16 v[240:243], a[148:151], a[32:35], v[240:243]
  s_waitcnt vmcnt(18)
  s_waitcnt lgkmcnt(6)
  v_mfma_f32_16x16x32_bf16 v[32:35], a[128:131], a[64:67], v[32:35]
  ds_read_b64_tr_b16 a[148:149], v21 offset:7200
  v_mfma_f32_16x16x32_bf16 v[32:35], a[132:135], a[80:83], v[32:35]
  ds_read_b64_tr_b16 a[150:151], v21 offset:10784
  s_add_u32 m0, s30, 0
  v_mfma_f32_16x16x32_bf16 v[36:39], a[132:135], a[84:87], v[36:39]
  buffer_load_dwordx4 v8, s[20:23], s28 offen offset:0 lds
  v_mfma_f32_16x16x32_bf16 v[36:39], a[128:131], a[68:71], v[36:39]
  v_mfma_f32_16x16x32_bf16 v[40:43], a[128:131], a[72:75], v[40:43]
  ds_read_b64_tr_b16 a[152:153], v21 offset:14368
  v_mfma_f32_16x16x32_bf16 v[40:43], a[132:135], a[88:91], v[40:43]
  ds_read_b64_tr_b16 a[154:155], v21 offset:17952
  v_mfma_f32_16x16x32_bf16 v[44:47], a[132:135], a[92:95], v[44:47]
  v_mfma_f32_16x16x32_bf16 v[44:47], a[128:131], a[76:79], v[44:47]
  s_waitcnt lgkmcnt(6)
  v_mfma_f32_16x16x32_bf16 v[60:63], a[136:139], a[76:79], v[60:63]
  ds_read_b64_tr_b16 a[128:129], v21 offset:21536
  v_mfma_f32_16x16x32_bf16 v[60:63], a[140:143], a[92:95], v[60:63]
  ds_read_b64_tr_b16 a[130:131], v21 offset:25120
  v_mfma_f32_16x16x32_bf16 v[56:59], a[140:143], a[88:91], v[56:59]
  buffer_load_dwordx4 v9, s[20:23], s28 offen offset:1024 lds
  v_mfma_f32_16x16x32_bf16 v[56:59], a[136:139], a[72:75], v[56:59]
  v_mfma_f32_16x16x32_bf16 v[52:55], a[136:139], a[68:71], v[52:55]
  ds_read_b64_tr_b16 a[132:133], v21 offset:64
  v_mfma_f32_16x16x32_bf16 v[52:55], a[140:143], a[84:87], v[52:55]
  ds_read_b64_tr_b16 a[134:135], v21 offset:3648
  v_mfma_f32_16x16x32_bf16 v[48:51], a[140:143], a[80:83], v[48:51]
  v_mfma_f32_16x16x32_bf16 v[48:51], a[136:139], a[64:67], v[48:51]
  s_waitcnt lgkmcnt(6)
  v_mfma_f32_16x16x32_bf16 v[64:67], a[144:147], a[64:67], v[64:67]
  ds_read_b64_tr_b16 a[136:137], v21 offset:7232
  v_mfma_f32_16x16x32_bf16 v[64:67], a[148:151], a[80:83], v[64:67]
  ds_read_b64_tr_b16 a[138:139], v21 offset:10816
  v_mfma_f32_16x16x32_bf16 v[68:71], a[148:151], a[84:87], v[68:71]
  buffer_load_dwordx4 v10, s[20:23], s28 offen offset:2048 lds
  v_mfma_f32_16x16x32_bf16 v[68:71], a[144:147], a[68:71], v[68:71]
  v_mfma_f32_16x16x32_bf16 v[72:75], a[144:147], a[72:75], v[72:75]
  ds_read_b64_tr_b16 a[140:141], v21 offset:14400
  v_mfma_f32_16x16x32_bf16 v[72:75], a[148:151], a[88:91], v[72:75]
  ds_read_b64_tr_b16 a[142:143], v21 offset:17984
  v_mfma_f32_16x16x32_bf16 v[76:79], a[148:151], a[92:95], v[76:79]
  v_mfma_f32_16x16x32_bf16 v[76:79], a[144:147], a[76:79], v[76:79]
  s_waitcnt lgkmcnt(6)
  v_mfma_f32_16x16x32_bf16 v[92:95], a[152:155], a[76:79], v[92:95]
  ds_read_b64_tr_b16 a[144:145], v21 offset:21568
  v_mfma_f32_16x16x32_bf16 v[92:95], a[128:131], a[92:95], v[92:95]
  ds_read_b64_tr_b16 a[146:147], v21 offset:25152
  v_mfma_f32_16x16x32_bf16 v[88:91], a[128:131], a[88:91], v[88:91]
  buffer_load_dwordx4 v11, s[20:23], s28 offen offset:3072 lds
  v_mfma_f32_16x16x32_bf16 v[88:91], a[152:155], a[72:75], v[88:91]
  v_mfma_f32_16x16x32_bf16 v[84:87], a[152:155], a[68:71], v[84:87]
  ds_read_b64_tr_b16 a[148:149], v21 offset:96
  v_mfma_f32_16x16x32_bf16 v[84:87], a[128:131], a[84:87], v[84:87]
  ds_read_b64_tr_b16 a[150:151], v21 offset:3680
  v_mfma_f32_16x16x32_bf16 v[80:83], a[128:131], a[80:83], v[80:83]
  v_mfma_f32_16x16x32_bf16 v[80:83], a[152:155], a[64:67], v[80:83]
  s_waitcnt lgkmcnt(6)
  v_mfma_f32_16x16x32_bf16 v[96:99], a[132:135], a[64:67], v[96:99]
  ds_read_b64_tr_b16 a[152:153], v21 offset:7264
  v_mfma_f32_16x16x32_bf16 v[96:99], a[136:139], a[80:83], v[96:99]
  ds_read_b64_tr_b16 a[154:155], v21 offset:10848
  s_add_u32 m0, s30, 4096
  v_mfma_f32_16x16x32_bf16 v[100:103], a[136:139], a[84:87], v[100:103]
  buffer_load_dwordx4 v12, s[20:23], s28 offen offset:0 lds
  v_mfma_f32_16x16x32_bf16 v[100:103], a[132:135], a[68:71], v[100:103]
  v_mfma_f32_16x16x32_bf16 v[104:107], a[132:135], a[72:75], v[104:107]
  ds_read_b64_tr_b16 a[128:129], v21 offset:14432
  v_mfma_f32_16x16x32_bf16 v[104:107], a[136:139], a[88:91], v[104:107]
  ds_read_b64_tr_b16 a[130:131], v21 offset:18016
  v_mfma_f32_16x16x32_bf16 v[108:111], a[136:139], a[92:95], v[108:111]
  v_mfma_f32_16x16x32_bf16 v[108:111], a[132:135], a[76:79], v[108:111]
  s_waitcnt lgkmcnt(6)
  v_mfma_f32_16x16x32_bf16 v[124:127], a[140:143], a[76:79], v[124:127]
  ds_read_b64_tr_b16 a[132:133], v21 offset:21600
  v_mfma_f32_16x16x32_bf16 v[124:127], a[144:147], a[92:95], v[124:127]
  ds_read_b64_tr_b16 a[134:135], v21 offset:25184
  v_mfma_f32_16x16x32_bf16 v[120:123], a[144:147], a[88:91], v[120:123]
  buffer_load_dwordx4 v13, s[20:23], s28 offen offset:1024 lds
  v_mfma_f32_16x16x32_bf16 v[120:123], a[140:143], a[72:75], v[120:123]
  v_mfma_f32_16x16x32_bf16 v[116:119], a[140:143], a[68:71], v[116:119]
  ds_read_b64_tr_b16 a[136:137], v21 offset:128
  v_mfma_f32_16x16x32_bf16 v[116:119], a[144:147], a[84:87], v[116:119]
  ds_read_b64_tr_b16 a[138:139], v21 offset:3712
  v_mfma_f32_16x16x32_bf16 v[112:115], a[144:147], a[80:83], v[112:115]
  v_mfma_f32_16x16x32_bf16 v[112:115], a[140:143], a[64:67], v[112:115]
  s_waitcnt lgkmcnt(6)
  v_mfma_f32_16x16x32_bf16 v[128:131], a[148:151], a[64:67], v[128:131]
  ds_read_b64_tr_b16 a[140:141], v21 offset:7296
  v_mfma_f32_16x16x32_bf16 v[128:131], a[152:155], a[80:83], v[128:131]
  ds_read_b64_tr_b16 a[142:143], v21 offset:10880
  v_mfma_f32_16x16x32_bf16 v[132:135], a[152:155], a[84:87], v[132:135]
  buffer_load_dwordx4 v14, s[20:23], s28 offen offset:2048 lds
  s_add_u32 s28, s28, 458752
  v_mfma_f32_16x16x32_bf16 v[132:135], a[148:151], a[68:71], v[132:135]
  v_mfma_f32_16x16x32_bf16 v[136:139], a[148:151], a[72:75], v[136:139]
  ds_read_b64_tr_b16 a[144:145], v21 offset:14464
  v_mfma_f32_16x16x32_bf16 v[136:139], a[152:155], a[88:91], v[136:139]
  ds_read_b64_tr_b16 a[146:147], v21 offset:18048
  v_mfma_f32_16x16x32_bf16 v[140:143], a[152:155], a[92:95], v[140:143]
  buffer_load_dwordx4 a[0:3], v16, s[24:27], s29 offen offset:0 sc1
  v_mfma_f32_16x16x32_bf16 v[140:143], a[148:151], a[76:79], v[140:143]
  s_waitcnt lgkmcnt(6)
  v_mfma_f32_16x16x32_bf16 v[156:159], a[128:131], a[76:79], v[156:159]
  ds_read_b64_tr_b16 a[148:149], v21 offset:21632
  v_mfma_f32_16x16x32_bf16 v[156:159], a[132:135], a[92:95], v[156:159]
  ds_read_b64_tr_b16 a[150:151], v21 offset:25216
  v_mfma_f32_16x16x32_bf16 v[152:155], a[132:135], a[88:91], v[152:155]
  buffer_load_dword v29, v28, s[20:23], s51 offen
  s_add_u32 s51, s51, 458752
  v_mfma_f32_16x16x32_bf16 v[152:155], a[128:131], a[72:75], v[152:155]
  v_mfma_f32_16x16x32_bf16 v[148:151], a[128:131], a[68:71], v[148:151]
  ds_read_b64_tr_b16 a[152:153], v21 offset:160
  v_mfma_f32_16x16x32_bf16 v[148:151], a[132:135], a[84:87], v[148:151]
  ds_read_b64_tr_b16 a[154:155], v21 offset:3744
  v_mfma_f32_16x16x32_bf16 v[144:147], a[132:135], a[80:83], v[144:147]
  buffer_load_dwordx4 a[4:7], v17, s[24:27], s29 offen offset:0 sc1
  v_mfma_f32_16x16x32_bf16 v[144:147], a[128:131], a[64:67], v[144:147]
  s_waitcnt lgkmcnt(6)
  v_mfma_f32_16x16x32_bf16 v[160:163], a[136:139], a[64:67], v[160:163]
  ds_read_b64_tr_b16 a[128:129], v21 offset:7328
  v_mfma_f32_16x16x32_bf16 v[160:163], a[140:143], a[80:83], v[160:163]
  ds_read_b64_tr_b16 a[130:131], v21 offset:10912
  v_mfma_f32_16x16x32_bf16 v[164:167], a[140:143], a[84:87], v[164:167]
  buffer_load_dword v29, v22, s[32:35], s41 offen
  s_add_u32 s41, s41, 512
  v_mfma_f32_16x16x32_bf16 v[164:167], a[136:139], a[68:71], v[164:167]
  v_mfma_f32_16x16x32_bf16 v[168:171], a[136:139], a[72:75], v[168:171]
  ds_read_b64_tr_b16 a[132:133], v21 offset:14496
  v_mfma_f32_16x16x32_bf16 v[168:171], a[140:143], a[88:91], v[168:171]
  ds_read_b64_tr_b16 a[134:135], v21 offset:18080
  v_mfma_f32_16x16x32_bf16 v[172:175], a[140:143], a[92:95], v[172:175]
  buffer_load_dwordx4 a[8:11], v18, s[24:27], s29 offen offset:0 sc1
  v_mfma_f32_16x16x32_bf16 v[172:175], a[136:139], a[76:79], v[172:175]
  s_waitcnt lgkmcnt(6)
  v_mfma_f32_16x16x32_bf16 v[188:191], a[144:147], a[76:79], v[188:191]
  ds_read_b64_tr_b16 a[136:137], v21 offset:21664
  v_mfma_f32_16x16x32_bf16 v[188:191], a[148:151], a[92:95], v[188:191]
  ds_read_b64_tr_b16 a[138:139], v21 offset:25248
  v_mfma_f32_16x16x32_bf16 v[184:187], a[148:151], a[88:91], v[184:187]
  v_mfma_f32_16x16x32_bf16 v[184:187], a[144:147], a[72:75], v[184:187]
  v_mfma_f32_16x16x32_bf16 v[180:183], a[144:147], a[68:71], v[180:183]
  ds_read_b64_tr_b16 a[140:141], v21 offset:192
  v_mfma_f32_16x16x32_bf16 v[180:183], a[148:151], a[84:87], v[180:183]
  ds_read_b64_tr_b16 a[142:143], v21 offset:3776
  v_mfma_f32_16x16x32_bf16 v[176:179], a[148:151], a[80:83], v[176:179]
  buffer_load_dwordx4 a[12:15], v19, s[24:27], s29 offen offset:0 sc1
  v_mfma_f32_16x16x32_bf16 v[176:179], a[144:147], a[64:67], v[176:179]
  s_waitcnt lgkmcnt(6)
  v_mfma_f32_16x16x32_bf16 v[192:195], a[152:155], a[64:67], v[192:195]
  ds_read_b64_tr_b16 a[144:145], v21 offset:7360
  v_mfma_f32_16x16x32_bf16 v[192:195], a[128:131], a[80:83], v[192:195]
  ds_read_b64_tr_b16 a[146:147], v21 offset:10944
  v_mfma_f32_16x16x32_bf16 v[196:199], a[128:131], a[84:87], v[196:199]
  v_mfma_f32_16x16x32_bf16 v[196:199], a[152:155], a[68:71], v[196:199]
  v_mfma_f32_16x16x32_bf16 v[200:203], a[152:155], a[72:75], v[200:203]
  ds_read_b64_tr_b16 a[148:149], v21 offset:14528
  v_mfma_f32_16x16x32_bf16 v[200:203], a[128:131], a[88:91], v[200:203]
  ds_read_b64_tr_b16 a[150:151], v21 offset:18112
  v_mfma_f32_16x16x32_bf16 v[204:207], a[128:131], a[92:95], v[204:207]
  buffer_load_dwordx4 a[16:19], v16, s[24:27], s29 offen offset:1024 sc1
  v_mfma_f32_16x16x32_bf16 v[204:207], a[152:155], a[76:79], v[204:207]
  s_waitcnt lgkmcnt(6)
  v_mfma_f32_16x16x32_bf16 v[220:223], a[132:135], a[76:79], v[220:223]
  ds_read_b64_tr_b16 a[152:153], v21 offset:21696
  v_mfma_f32_16x16x32_bf16 v[220:223], a[136:139], a[92:95], v[220:223]
  ds_read_b64_tr_b16 a[154:155], v21 offset:25280
  v_mfma_f32_16x16x32_bf16 v[216:219], a[136:139], a[88:91], v[216:219]
  v_mfma_f32_16x16x32_bf16 v[216:219], a[132:135], a[72:75], v[216:219]
  s_waitcnt vmcnt(25)
  s_barrier
  v_mfma_f32_16x16x32_bf16 v[212:215], a[132:135], a[68:71], v[212:215]
  ds_read_b64_tr_b16 a[128:129], v21 offset:28672
  v_mfma_f32_16x16x32_bf16 v[212:215], a[136:139], a[84:87], v[212:215]
  ds_read_b64_tr_b16 a[130:131], v21 offset:32256
  v_mfma_f32_16x16x32_bf16 v[208:211], a[136:139], a[80:83], v[208:211]
  buffer_load_dwordx4 a[20:23], v17, s[24:27], s29 offen offset:1024 sc1
  v_mfma_f32_16x16x32_bf16 v[208:211], a[132:135], a[64:67], v[208:211]
  s_waitcnt lgkmcnt(6)
  v_mfma_f32_16x16x32_bf16 v[224:227], a[140:143], a[64:67], v[224:227]
  ds_read_b64_tr_b16 a[132:133], v21 offset:35840
  v_mfma_f32_16x16x32_bf16 v[224:227], a[144:147], a[80:83], v[224:227]
  ds_read_b64_tr_b16 a[134:135], v21 offset:39424
  v_mfma_f32_16x16x32_bf16 v[228:231], a[144:147], a[84:87], v[228:231]
  v_mfma_f32_16x16x32_bf16 v[228:231], a[140:143], a[68:71], v[228:231]
  v_mfma_f32_16x16x32_bf16 v[232:235], a[140:143], a[72:75], v[232:235]
  ds_read_b64_tr_b16 a[136:137], v21 offset:43008
  v_mfma_f32_16x16x32_bf16 v[232:235], a[144:147], a[88:91], v[232:235]
  ds_read_b64_tr_b16 a[138:139], v21 offset:46592
  v_mfma_f32_16x16x32_bf16 v[236:239], a[144:147], a[92:95], v[236:239]
  buffer_load_dwordx4 a[24:27], v18, s[24:27], s29 offen offset:1024 sc1
  v_mfma_f32_16x16x32_bf16 v[236:239], a[140:143], a[76:79], v[236:239]
  s_waitcnt lgkmcnt(6)
  v_mfma_f32_16x16x32_bf16 v[252:255], a[148:151], a[76:79], v[252:255]
  ds_read_b64_tr_b16 a[140:141], v21 offset:50176
  v_mfma_f32_16x16x32_bf16 v[252:255], a[152:155], a[92:95], v[252:255]
  ds_read_b64_tr_b16 a[142:143], v21 offset:53760
  v_mfma_f32_16x16x32_bf16 v[248:251], a[152:155], a[88:91], v[248:251]
  v_mfma_f32_16x16x32_bf16 v[248:251], a[148:151], a[72:75], v[248:251]
  v_mfma_f32_16x16x32_bf16 v[244:247], a[148:151], a[68:71], v[244:247]
  ds_read_b64_tr_b16 a[144:145], v21 offset:28704
  v_mfma_f32_16x16x32_bf16 v[244:247], a[152:155], a[84:87], v[244:247]
  ds_read_b64_tr_b16 a[146:147], v21 offset:32288
  v_mfma_f32_16x16x32_bf16 v[240:243], a[152:155], a[80:83], v[240:243]
  buffer_load_dwordx4 a[28:31], v19, s[24:27], s29 offen offset:1024 sc1
  v_mfma_f32_16x16x32_bf16 v[240:243], a[148:151], a[64:67], v[240:243]
  s_waitcnt vmcnt(17)
  s_waitcnt lgkmcnt(6)
  v_mfma_f32_16x16x32_bf16 v[32:35], a[128:131], a[96:99], v[32:35]
  ds_read_b64_tr_b16 a[148:149], v21 offset:35872
  v_mfma_f32_16x16x32_bf16 v[32:35], a[132:135], a[112:115], v[32:35]
  ds_read_b64_tr_b16 a[150:151], v21 offset:39456
  s_add_u32 m0, s30, 28672
  v_mfma_f32_16x16x32_bf16 v[36:39], a[132:135], a[116:119], v[36:39]
  buffer_load_dwordx4 v8, s[20:23], s28 offen offset:0 lds
  v_mfma_f32_16x16x32_bf16 v[36:39], a[128:131], a[100:103], v[36:39]
  v_mfma_f32_16x16x32_bf16 v[40:43], a[128:131], a[104:107], v[40:43]
  ds_read_b64_tr_b16 a[152:153], v21 offset:43040
  v_mfma_f32_16x16x32_bf16 v[40:43], a[132:135], a[120:123], v[40:43]
  ds_read_b64_tr_b16 a[154:155], v21 offset:46624
  v_mfma_f32_16x16x32_bf16 v[44:47], a[132:135], a[124:127], v[44:47]
  v_mfma_f32_16x16x32_bf16 v[44:47], a[128:131], a[108:111], v[44:47]
  s_waitcnt lgkmcnt(6)
  v_mfma_f32_16x16x32_bf16 v[60:63], a[136:139], a[108:111], v[60:63]
  ds_read_b64_tr_b16 a[128:129], v21 offset:50208
  v_mfma_f32_16x16x32_bf16 v[60:63], a[140:143], a[124:127], v[60:63]
  ds_read_b64_tr_b16 a[130:131], v21 offset:53792
  v_mfma_f32_16x16x32_bf16 v[56:59], a[140:143], a[120:123], v[56:59]
  buffer_load_dwordx4 v9, s[20:23], s28 offen offset:1024 lds
  v_mfma_f32_16x16x32_bf16 v[56:59], a[136:139], a[104:107], v[56:59]
  v_mfma_f32_16x16x32_bf16 v[52:55], a[136:139], a[100:103], v[52:55]
  ds_read_b64_tr_b16 a[132:133], v21 offset:28736
  v_mfma_f32_16x16x32_bf16 v[52:55], a[140:143], a[116:119], v[52:55]
  ds_read_b64_tr_b16 a[134:135], v21 offset:32320
  v_mfma_f32_16x16x32_bf16 v[48:51], a[140:143], a[112:115], v[48:51]
  v_mfma_f32_16x16x32_bf16 v[48:51], a[136:139], a[96:99], v[48:51]
  s_waitcnt lgkmcnt(6)
  v_mfma_f32_16x16x32_bf16 v[64:67], a[144:147], a[96:99], v[64:67]
  ds_read_b64_tr_b16 a[136:137], v21 offset:35904
  v_mfma_f32_16x16x32_bf16 v[64:67], a[148:151], a[112:115], v[64:67]
  ds_read_b64_tr_b16 a[138:139], v21 offset:39488
  v_mfma_f32_16x16x32_bf16 v[68:71], a[148:151], a[116:119], v[68:71]
  buffer_load_dwordx4 v10, s[20:23], s28 offen offset:2048 lds
  v_mfma_f32_16x16x32_bf16 v[68:71], a[144:147], a[100:103], v[68:71]
  v_mfma_f32_16x16x32_bf16 v[72:75], a[144:147], a[104:107], v[72:75]
  ds_read_b64_tr_b16 a[140:141], v21 offset:43072
  v_mfma_f32_16x16x32_bf16 v[72:75], a[148:151], a[120:123], v[72:75]
  ds_read_b64_tr_b16 a[142:143], v21 offset:46656
  v_mfma_f32_16x16x32_bf16 v[76:79], a[148:151], a[124:127], v[76:79]
  v_mfma_f32_16x16x32_bf16 v[76:79], a[144:147], a[108:111], v[76:79]
  s_waitcnt lgkmcnt(6)
  v_mfma_f32_16x16x32_bf16 v[92:95], a[152:155], a[108:111], v[92:95]
  ds_read_b64_tr_b16 a[144:145], v21 offset:50240
  v_mfma_f32_16x16x32_bf16 v[92:95], a[128:131], a[124:127], v[92:95]
  ds_read_b64_tr_b16 a[146:147], v21 offset:53824
  v_mfma_f32_16x16x32_bf16 v[88:91], a[128:131], a[120:123], v[88:91]
  buffer_load_dwordx4 v11, s[20:23], s28 offen offset:3072 lds
  v_mfma_f32_16x16x32_bf16 v[88:91], a[152:155], a[104:107], v[88:91]
  v_mfma_f32_16x16x32_bf16 v[84:87], a[152:155], a[100:103], v[84:87]
  ds_read_b64_tr_b16 a[148:149], v21 offset:28768
  v_mfma_f32_16x16x32_bf16 v[84:87], a[128:131], a[116:119], v[84:87]
  ds_read_b64_tr_b16 a[150:151], v21 offset:32352
  v_mfma_f32_16x16x32_bf16 v[80:83], a[128:131], a[112:115], v[80:83]
  v_mfma_f32_16x16x32_bf16 v[80:83], a[152:155], a[96:99], v[80:83]
  s_waitcnt lgkmcnt(6)
  v_mfma_f32_16x16x32_bf16 v[96:99], a[132:135], a[96:99], v[96:99]
  ds_read_b64_tr_b16 a[152:153], v21 offset:35936
  v_mfma_f32_16x16x32_bf16 v[96:99], a[136:139], a[112:115], v[96:99]
  ds_read_b64_tr_b16 a[154:155], v21 offset:39520
  s_add_u32 m0, s30, 32768
  v_mfma_f32_16x16x32_bf16 v[100:103], a[136:139], a[116:119], v[100:103]
  buffer_load_dwordx4 v12, s[20:23], s28 offen offset:0 lds
  v_mfma_f32_16x16x32_bf16 v[100:103], a[132:135], a[100:103], v[100:103]
  v_mfma_f32_16x16x32_bf16 v[104:107], a[132:135], a[104:107], v[104:107]
  ds_read_b64_tr_b16 a[128:129], v21 offset:43104
  v_mfma_f32_16x16x32_bf16 v[104:107], a[136:139], a[120:123], v[104:107]
  ds_read_b64_tr_b16 a[130:131], v21 offset:46688
  v_mfma_f32_16x16x32_bf16 v[108:111], a[136:139], a[124:127], v[108:111]
  v_mfma_f32_16x16x32_bf16 v[108:111], a[132:135], a[108:111], v[108:111]
  s_waitcnt lgkmcnt(6)
  v_mfma_f32_16x16x32_bf16 v[124:127], a[140:143], a[108:111], v[124:127]
  ds_read_b64_tr_b16 a[132:133], v21 offset:50272
  v_mfma_f32_16x16x32_bf16 v[124:127], a[144:147], a[124:127], v[124:127]
  ds_read_b64_tr_b16 a[134:135], v21 offset:53856
  v_mfma_f32_16x16x32_bf16 v[120:123], a[144:147], a[120:123], v[120:123]
  buffer_load_dwordx4 v13, s[20:23], s28 offen offset:1024 lds
  v_mfma_f32_16x16x32_bf16 v[120:123], a[140:143], a[104:107], v[120:123]
  v_mfma_f32_16x16x32_bf16 v[116:119], a[140:143], a[100:103], v[116:119]
  ds_read_b64_tr_b16 a[136:137], v21 offset:28800
  v_mfma_f32_16x16x32_bf16 v[116:119], a[144:147], a[116:119], v[116:119]
  ds_read_b64_tr_b16 a[138:139], v21 offset:32384
  v_mfma_f32_16x16x32_bf16 v[112:115], a[144:147], a[112:115], v[112:115]
  v_mfma_f32_16x16x32_bf16 v[112:115], a[140:143], a[96:99], v[112:115]
  s_waitcnt lgkmcnt(6)
  v_mfma_f32_16x16x32_bf16 v[128:131], a[148:151], a[96:99], v[128:131]
  ds_read_b64_tr_b16 a[140:141], v21 offset:35968
  v_mfma_f32_16x16x32_bf16 v[128:131], a[152:155], a[112:115], v[128:131]
  ds_read_b64_tr_b16 a[142:143], v21 offset:39552
  v_mfma_f32_16x16x32_bf16 v[132:135], a[152:155], a[116:119], v[132:135]
  buffer_load_dwordx4 v14, s[20:23], s28 offen offset:2048 lds
  s_add_u32 s28, s28, 458752
  v_mfma_f32_16x16x32_bf16 v[132:135], a[148:151], a[100:103], v[132:135]
  v_mfma_f32_16x16x32_bf16 v[136:139], a[148:151], a[104:107], v[136:139]
  ds_read_b64_tr_b16 a[144:145], v21 offset:43136
  v_mfma_f32_16x16x32_bf16 v[136:139], a[152:155], a[120:123], v[136:139]
  ds_read_b64_tr_b16 a[146:147], v21 offset:46720
  v_mfma_f32_16x16x32_bf16 v[140:143], a[152:155], a[124:127], v[140:143]
  buffer_load_dwordx4 a[32:35], v16, s[24:27], s29 offen offset:2048 sc1
  v_mfma_f32_16x16x32_bf16 v[140:143], a[148:151], a[108:111], v[140:143]
  s_waitcnt lgkmcnt(6)
  v_mfma_f32_16x16x32_bf16 v[156:159], a[128:131], a[108:111], v[156:159]
  ds_read_b64_tr_b16 a[148:149], v21 offset:50304
  v_mfma_f32_16x16x32_bf16 v[156:159], a[132:135], a[124:127], v[156:159]
  ds_read_b64_tr_b16 a[150:151], v21 offset:53888
  v_mfma_f32_16x16x32_bf16 v[152:155], a[132:135], a[120:123], v[152:155]
  buffer_load_dword v29, v28, s[20:23], s51 offen
  s_add_u32 s51, s51, 458752
  v_mfma_f32_16x16x32_bf16 v[152:155], a[128:131], a[104:107], v[152:155]
  v_mfma_f32_16x16x32_bf16 v[148:151], a[128:131], a[100:103], v[148:151]
  ds_read_b64_tr_b16 a[152:153], v21 offset:28832
  v_mfma_f32_16x16x32_bf16 v[148:151], a[132:135], a[116:119], v[148:151]
  ds_read_b64_tr_b16 a[154:155], v21 offset:32416
  v_mfma_f32_16x16x32_bf16 v[144:147], a[132:135], a[112:115], v[144:147]
  buffer_load_dwordx4 a[36:39], v17, s[24:27], s29 offen offset:2048 sc1
  v_mfma_f32_16x16x32_bf16 v[144:147], a[128:131], a[96:99], v[144:147]
  s_waitcnt lgkmcnt(6)
  v_mfma_f32_16x16x32_bf16 v[160:163], a[136:139], a[96:99], v[160:163]
  ds_read_b64_tr_b16 a[128:129], v21 offset:36000
  v_mfma_f32_16x16x32_bf16 v[160:163], a[140:143], a[112:115], v[160:163]
  ds_read_b64_tr_b16 a[130:131], v21 offset:39584
  v_mfma_f32_16x16x32_bf16 v[164:167], a[140:143], a[116:119], v[164:167]
  buffer_load_dword v29, v22, s[32:35], s41 offen
  s_add_u32 s41, s41, 512
  v_mfma_f32_16x16x32_bf16 v[164:167], a[136:139], a[100:103], v[164:167]
  v_mfma_f32_16x16x32_bf16 v[168:171], a[136:139], a[104:107], v[168:171]
  ds_read_b64_tr_b16 a[132:133], v21 offset:43168
  v_mfma_f32_16x16x32_bf16 v[168:171], a[140:143], a[120:123], v[168:171]
  ds_read_b64_tr_b16 a[134:135], v21 offset:46752
  v_mfma_f32_16x16x32_bf16 v[172:175], a[140:143], a[124:127], v[172:175]
  buffer_load_dwordx4 a[40:43], v18, s[24:27], s29 offen offset:2048 sc1
  v_mfma_f32_16x16x32_bf16 v[172:175], a[136:139], a[108:111], v[172:175]
  s_waitcnt lgkmcnt(6)
  v_mfma_f32_16x16x32_bf16 v[188:191], a[144:147], a[108:111], v[188:191]
  ds_read_b64_tr_b16 a[136:137], v21 offset:50336
  v_mfma_f32_16x16x32_bf16 v[188:191], a[148:151], a[124:127], v[188:191]
  ds_read_b64_tr_b16 a[138:139], v21 offset:53920
  v_mfma_f32_16x16x32_bf16 v[184:187], a[148:151], a[120:123], v[184:187]
  v_mfma_f32_16x16x32_bf16 v[184:187], a[144:147], a[104:107], v[184:187]
  v_mfma_f32_16x16x32_bf16 v[180:183], a[144:147], a[100:103], v[180:183]
  ds_read_b64_tr_b16 a[140:141], v21 offset:28864
  v_mfma_f32_16x16x32_bf16 v[180:183], a[148:151], a[116:119], v[180:183]
  ds_read_b64_tr_b16 a[142:143], v21 offset:32448
  v_mfma_f32_16x16x32_bf16 v[176:179], a[148:151], a[112:115], v[176:179]
  buffer_load_dwordx4 a[44:47], v19, s[24:27], s29 offen offset:2048 sc1
  v_mfma_f32_16x16x32_bf16 v[176:179], a[144:147], a[96:99], v[176:179]
  s_waitcnt lgkmcnt(6)
  v_mfma_f32_16x16x32_bf16 v[192:195], a[152:155], a[96:99], v[192:195]
  ds_read_b64_tr_b16 a[144:145], v21 offset:36032
  v_mfma_f32_16x16x32_bf16 v[192:195], a[128:131], a[112:115], v[192:195]
  ds_read_b64_tr_b16 a[146:147], v21 offset:39616
  v_mfma_f32_16x16x32_bf16 v[196:199], a[128:131], a[116:119], v[196:199]
  v_mfma_f32_16x16x32_bf16 v[196:199], a[152:155], a[100:103], v[196:199]
  v_mfma_f32_16x16x32_bf16 v[200:203], a[152:155], a[104:107], v[200:203]
  ds_read_b64_tr_b16 a[148:149], v21 offset:43200
  v_mfma_f32_16x16x32_bf16 v[200:203], a[128:131], a[120:123], v[200:203]
  ds_read_b64_tr_b16 a[150:151], v21 offset:46784
  v_mfma_f32_16x16x32_bf16 v[204:207], a[128:131], a[124:127], v[204:207]
  buffer_load_dwordx4 a[48:51], v16, s[24:27], s29 offen offset:3072 sc1
  v_mfma_f32_16x16x32_bf16 v[204:207], a[152:155], a[108:111], v[204:207]
  s_waitcnt lgkmcnt(6)
  v_mfma_f32_16x16x32_bf16 v[220:223], a[132:135], a[108:111], v[220:223]
  ds_read_b64_tr_b16 a[152:153], v21 offset:50368
  v_mfma_f32_16x16x32_bf16 v[220:223], a[136:139], a[124:127], v[220:223]
  ds_read_b64_tr_b16 a[154:155], v21 offset:53952
  v_mfma_f32_16x16x32_bf16 v[216:219], a[136:139], a[120:123], v[216:219]
  v_mfma_f32_16x16x32_bf16 v[216:219], a[132:135], a[104:107], v[216:219]
  s_waitcnt vmcnt(24)
  s_barrier
  v_mfma_f32_16x16x32_bf16 v[212:215], a[132:135], a[100:103], v[212:215]
  ds_read_b64_tr_b16 a[128:129], v20 offset:0
  v_mfma_f32_16x16x32_bf16 v[212:215], a[136:139], a[116:119], v[212:215]
  ds_read_b64_tr_b16 a[130:131], v20 offset:3584
  v_mfma_f32_16x16x32_bf16 v[208:211], a[136:139], a[112:115], v[208:211]
  buffer_load_dwordx4 a[52:55], v17, s[24:27], s29 offen offset:3072 sc1
  v_mfma_f32_16x16x32_bf16 v[208:211], a[132:135], a[96:99], v[208:211]
  s_waitcnt lgkmcnt(6)
  v_mfma_f32_16x16x32_bf16 v[224:227], a[140:143], a[96:99], v[224:227]
  ds_read_b64_tr_b16 a[132:133], v20 offset:7168
  v_mfma_f32_16x16x32_bf16 v[224:227], a[144:147], a[112:115], v[224:227]
  ds_read_b64_tr_b16 a[134:135], v20 offset:10752
  v_mfma_f32_16x16x32_bf16 v[228:231], a[144:147], a[116:119], v[228:231]
  v_mfma_f32_16x16x32_bf16 v[228:231], a[140:143], a[100:103], v[228:231]
  v_mfma_f32_16x16x32_bf16 v[232:235], a[140:143], a[104:107], v[232:235]
  ds_read_b64_tr_b16 a[136:137], v20 offset:14336
  v_mfma_f32_16x16x32_bf16 v[232:235], a[144:147], a[120:123], v[232:235]
  ds_read_b64_tr_b16 a[138:139], v20 offset:17920
  v_mfma_f32_16x16x32_bf16 v[236:239], a[144:147], a[124:127], v[236:239]
  buffer_load_dwordx4 a[56:59], v18, s[24:27], s29 offen offset:3072 sc1
  v_mfma_f32_16x16x32_bf16 v[236:239], a[140:143], a[108:111], v[236:239]
  s_waitcnt lgkmcnt(6)
  v_mfma_f32_16x16x32_bf16 v[252:255], a[148:151], a[108:111], v[252:255]
  ds_read_b64_tr_b16 a[140:141], v20 offset:21504
  v_mfma_f32_16x16x32_bf16 v[252:255], a[152:155], a[124:127], v[252:255]
  ds_read_b64_tr_b16 a[142:143], v20 offset:25088
  v_mfma_f32_16x16x32_bf16 v[248:251], a[152:155], a[120:123], v[248:251]
  v_mfma_f32_16x16x32_bf16 v[248:251], a[148:151], a[104:107], v[248:251]
  v_mfma_f32_16x16x32_bf16 v[244:247], a[148:151], a[100:103], v[244:247]
  ds_read_b64_tr_b16 a[144:145], v20 offset:32
  v_mfma_f32_16x16x32_bf16 v[244:247], a[152:155], a[116:119], v[244:247]
  ds_read_b64_tr_b16 a[146:147], v20 offset:3616
  v_mfma_f32_16x16x32_bf16 v[240:243], a[152:155], a[112:115], v[240:243]
  buffer_load_dwordx4 a[60:63], v19, s[24:27], s29 offen offset:3072 sc1
  s_add_u32 s29, s29, 4096
  s_add_u32 s31, s31, 1
  v_mfma_f32_16x16x32_bf16 v[240:243], a[148:151], a[96:99], v[240:243]
  s_cmp_lt_u32 s31, 3
  s_cbranch_scc1 L_g1_loop
  s_waitcnt vmcnt(17)
  s_waitcnt lgkmcnt(6)
  v_mfma_f32_16x16x32_bf16 v[32:35], a[128:131], a[0:3], v[32:35]
  ds_read_b64_tr_b16 a[148:149], v20 offset:7200
  v_mfma_f32_16x16x32_bf16 v[32:35], a[132:135], a[16:19], v[32:35]
  ds_read_b64_tr_b16 a[150:151], v20 offset:10784
  s_add_u32 m0, s30, 57344
  v_mfma_f32_16x16x32_bf16 v[36:39], a[132:135], a[20:23], v[36:39]
  buffer_load_dwordx4 v8, s[20:23], s28 offen offset:0 lds
  v_mfma_f32_16x16x32_bf16 v[36:39], a[128:131], a[4:7], v[36:39]
  v_mfma_f32_16x16x32_bf16 v[40:43], a[128:131], a[8:11], v[40:43]
  ds_read_b64_tr_b16 a[152:153], v20 offset:14368
  v_mfma_f32_16x16x32_bf16 v[40:43], a[132:135], a[24:27], v[40:43]
  ds_read_b64_tr_b16 a[154:155], v20 offset:17952
  v_mfma_f32_16x16x32_bf16 v[44:47], a[132:135], a[28:31], v[44:47]
  buffer_load_dwordx4 a[64:67], v16, s[24:27], s29 offen offset:0 sc1
  v_mfma_f32_16x16x32_bf16 v[44:47], a[128:131], a[12:15], v[44:47]
  s_waitcnt lgkmcnt(6)
  v_mfma_f32_16x16x32_bf16 v[60:63], a[136:139], a[12:15], v[60:63]
  ds_read_b64_tr_b16 a[128:129], v20 offset:21536
  v_mfma_f32_16x16x32_bf16 v[60:63], a[140:143], a[28:31], v[60:63]
  ds_read_b64_tr_b16 a[130:131], v20 offset:25120
  v_mfma_f32_16x16x32_bf16 v[56:59], a[140:143], a[24:27], v[56:59]
  buffer_load_dwordx4 v9, s[20:23], s28 offen offset:1024 lds
  v_mfma_f32_16x16x32_bf16 v[56:59], a[136:139], a[8:11], v[56:59]
  v_mfma_f32_16x16x32_bf16 v[52:55], a[136:139], a[4:7], v[52:55]
  ds_read_b64_tr_b16 a[132:133], v20 offset:64
  v_mfma_f32_16x16x32_bf16 v[52:55], a[140:143], a[20:23], v[52:55]
  ds_read_b64_tr_b16 a[134:135], v20 offset:3648
  v_mfma_f32_16x16x32_bf16 v[48:51], a[140:143], a[16:19], v[48:51]
  buffer_load_dwordx4 a[68:71], v17, s[24:27], s29 offen offset:0 sc1
  v_mfma_f32_16x16x32_bf16 v[48:51], a[136:139], a[0:3], v[48:51]
  s_waitcnt lgkmcnt(6)
  v_mfma_f32_16x16x32_bf16 v[64:67], a[144:147], a[0:3], v[64:67]
  ds_read_b64_tr_b16 a[136:137], v20 offset:7232
  v_mfma_f32_16x16x32_bf16 v[64:67], a[148:151], a[16:19], v[64:67]
  ds_read_b64_tr_b16 a[138:139], v20 offset:10816
  v_mfma_f32_16x16x32_bf16 v[68:71], a[148:151], a[20:23], v[68:71]
  buffer_load_dwordx4 v10, s[20:23], s28 offen offset:2048 lds
  v_mfma_f32_16x16x32_bf16 v[68:71], a[144:147], a[4:7], v[68:71]
  v_mfma_f32_16x16x32_bf16 v[72:75], a[144:147], a[8:11], v[72:75]
  ds_read_b64_tr_b16 a[140:141], v20 offset:14400
  v_mfma_f32_16x16x32_bf16 v[72:75], a[148:151], a[24:27], v[72:75]
  ds_read_b64_tr_b16 a[142:143], v20 offset:17984
  v_mfma_f32_16x16x32_bf16 v[76:79], a[148:151], a[28:31], v[76:79]
  buffer_load_dwordx4 a[72:75], v18, s[24:27], s29 offen offset:0 sc1
  v_mfma_f32_16x16x32_bf16 v[76:79], a[144:147], a[12:15], v[76:79]
  s_waitcnt lgkmcnt(6)
  v_mfma_f32_16x16x32_bf16 v[92:95], a[152:155], a[12:15], v[92:95]
  ds_read_b64_tr_b16 a[144:145], v20 offset:21568
  v_mfma_f32_16x16x32_bf16 v[92:95], a[128:131], a[28:31], v[92:95]
  ds_read_b64_tr_b16 a[146:147], v20 offset:25152
  v_mfma_f32_16x16x32_bf16 v[88:91], a[128:131], a[24:27], v[88:91]
  buffer_load_dwordx4 v11, s[20:23], s28 offen offset:3072 lds
  v_mfma_f32_16x16x32_bf16 v[88:91], a[152:155], a[8:11], v[88:91]
  v_mfma_f32_16x16x32_bf16 v[84:87], a[152:155], a[4:7], v[84:87]
  ds_read_b64_tr_b16 a[148:149], v20 offset:96
  v_mfma_f32_16x16x32_bf16 v[84:87], a[128:131], a[20:23], v[84:87]
  ds_read_b64_tr_b16 a[150:151], v20 offset:3680
  v_mfma_f32_16x16x32_bf16 v[80:83], a[128:131], a[16:19], v[80:83]
  buffer_load_dwordx4 a[76:79], v19, s[24:27], s29 offen offset:0 sc1
  v_mfma_f32_16x16x32_bf16 v[80:83], a[152:155], a[0:3], v[80:83]
  s_waitcnt lgkmcnt(6)
  v_mfma_f32_16x16x32_bf16 v[96:99], a[132:135], a[0:3], v[96:99]
  ds_read_b64_tr_b16 a[152:153], v20 offset:7264
  v_mfma_f32_16x16x32_bf16 v[96:99], a[136:139], a[16:19], v[96:99]
  ds_read_b64_tr_b16 a[154:155], v20 offset:10848
  s_add_u32 m0, s30, 61440
  v_mfma_f32_16x16x32_bf16 v[100:103], a[136:139], a[20:23], v[100:103]
  buffer_load_dwordx4 v12, s[20:23], s28 offen offset:0 lds
  v_mfma_f32_16x16x32_bf16 v[100:103], a[132:135], a[4:7], v[100:103]
  v_mfma_f32_16x16x32_bf16 v[104:107], a[132:135], a[8:11], v[104:107]
  ds_read_b64_tr_b16 a[128:129], v20 offset:14432
  v_mfma_f32_16x16x32_bf16 v[104:107], a[136:139], a[24:27], v[104:107]
  ds_read_b64_tr_b16 a[130:131], v20 offset:18016
  v_mfma_f32_16x16x32_bf16 v[108:111], a[136:139], a[28:31], v[108:111]
  buffer_load_dwordx4 a[80:83], v16, s[24:27], s29 offen offset:1024 sc1
  v_mfma_f32_16x16x32_bf16 v[108:111], a[132:135], a[12:15], v[108:111]
  s_waitcnt lgkmcnt(6)
  v_mfma_f32_16x16x32_bf16 v[124:127], a[140:143], a[12:15], v[124:127]
  ds_read_b64_tr_b16 a[132:133], v20 offset:21600
  v_mfma_f32_16x16x32_bf16 v[124:127], a[144:147], a[28:31], v[124:127]
  ds_read_b64_tr_b16 a[134:135], v20 offset:25184
  v_mfma_f32_16x16x32_bf16 v[120:123], a[144:147], a[24:27], v[120:123]
  buffer_load_dwordx4 v13, s[20:23], s28 offen offset:1024 lds
  v_mfma_f32_16x16x32_bf16 v[120:123], a[140:143], a[8:11], v[120:123]
  v_mfma_f32_16x16x32_bf16 v[116:119], a[140:143], a[4:7], v[116:119]
  ds_read_b64_tr_b16 a[136:137], v20 offset:128
  v_mfma_f32_16x16x32_bf16 v[116:119], a[144:147], a[20:23], v[116:119]
  ds_read_b64_tr_b16 a[138:139], v20 offset:3712
  v_mfma_f32_16x16x32_bf16 v[112:115], a[144:147], a[16:19], v[112:115]
  buffer_load_dwordx4 a[84:87], v17, s[24:27], s29 offen offset:1024 sc1
  v_mfma_f32_16x16x32_bf16 v[112:115], a[140:143], a[0:3], v[112:115]
  s_waitcnt lgkmcnt(6)
  v_mfma_f32_16x16x32_bf16 v[128:131], a[148:151], a[0:3], v[128:131]
  ds_read_b64_tr_b16 a[140:141], v20 offset:7296
  v_mfma_f32_16x16x32_bf16 v[128:131], a[152:155], a[16:19], v[128:131]
  ds_read_b64_tr_b16 a[142:143], v20 offset:10880
  v_mfma_f32_16x16x32_bf16 v[132:135], a[152:155], a[20:23], v[132:135]
  buffer_load_dwordx4 v14, s[20:23], s28 offen offset:2048 lds
  s_add_u32 s28, s28, 458752
  v_mfma_f32_16x16x32_bf16 v[132:135], a[148:151], a[4:7], v[132:135]
  v_mfma_f32_16x16x32_bf16 v[136:139], a[148:151], a[8:11], v[136:139]
  ds_read_b64_tr_b16 a[144:145], v20 offset:14464
  v_mfma_f32_16x16x32_bf16 v[136:139], a[152:155], a[24:27], v[136:139]
  ds_read_b64_tr_b16 a[146:147], v20 offset:18048
  v_mfma_f32_16x16x32_bf16 v[140:143], a[152:155], a[28:31], v[140:143]
  buffer_load_dwordx4 a[88:91], v18, s[24:27], s29 offen offset:1024 sc1
  v_mfma_f32_16x16x32_bf16 v[140:143], a[148:151], a[12:15], v[140:143]
  s_waitcnt lgkmcnt(6)
  v_mfma_f32_16x16x32_bf16 v[156:159], a[128:131], a[12:15], v[156:159]
  ds_read_b64_tr_b16 a[148:149], v20 offset:21632
  v_mfma_f32_16x16x32_bf16 v[156:159], a[132:135], a[28:31], v[156:159]
  ds_read_b64_tr_b16 a[150:151], v20 offset:25216
  v_mfma_f32_16x16x32_bf16 v[152:155], a[132:135], a[24:27], v[152:155]
  v_mfma_f32_16x16x32_bf16 v[152:155], a[128:131], a[8:11], v[152:155]
  v_mfma_f32_16x16x32_bf16 v[148:151], a[128:131], a[4:7], v[148:151]
  ds_read_b64_tr_b16 a[152:153], v20 offset:160
  v_mfma_f32_16x16x32_bf16 v[148:151], a[132:135], a[20:23], v[148:151]
  ds_read_b64_tr_b16 a[154:155], v20 offset:3744
  v_mfma_f32_16x16x32_bf16 v[144:147], a[132:135], a[16:19], v[144:147]
  v_mfma_f32_16x16x32_bf16 v[144:147], a[128:131], a[0:3], v[144:147]
  s_waitcnt lgkmcnt(6)
  v_mfma_f32_16x16x32_bf16 v[160:163], a[136:139], a[0:3], v[160:163]
  ds_read_b64_tr_b16 a[128:129], v20 offset:7328
  v_mfma_f32_16x16x32_bf16 v[160:163], a[140:143], a[16:19], v[160:163]
  ds_read_b64_tr_b16 a[130:131], v20 offset:10912
  v_mfma_f32_16x16x32_bf16 v[164:167], a[140:143], a[20:23], v[164:167]
  buffer_load_dwordx4 a[92:95], v19, s[24:27], s29 offen offset:1024 sc1
  v_mfma_f32_16x16x32_bf16 v[164:167], a[136:139], a[4:7], v[164:167]
  v_mfma_f32_16x16x32_bf16 v[168:171], a[136:139], a[8:11], v[168:171]
  ds_read_b64_tr_b16 a[132:133], v20 offset:14496
  v_mfma_f32_16x16x32_bf16 v[168:171], a[140:143], a[24:27], v[168:171]
  ds_read_b64_tr_b16 a[134:135], v20 offset:18080
  v_mfma_f32_16x16x32_bf16 v[172:175], a[140:143], a[28:31], v[172:175]
  buffer_load_dword v29, v22, s[32:35], s41 offen
  s_add_u32 s41, s41, 512
  v_mfma_f32_16x16x32_bf16 v[172:175], a[136:139], a[12:15], v[172:175]
  s_waitcnt lgkmcnt(6)
  v_mfma_f32_16x16x32_bf16 v[188:191], a[144:147], a[12:15], v[188:191]
  ds_read_b64_tr_b16 a[136:137], v20 offset:21664
  v_mfma_f32_16x16x32_bf16 v[188:191], a[148:151], a[28:31], v[188:191]
  ds_read_b64_tr_b16 a[138:139], v20 offset:25248
  v_mfma_f32_16x16x32_bf16 v[184:187], a[148:151], a[24:27], v[184:187]
  buffer_load_dwordx4 a[96:99], v16, s[24:27], s29 offen offset:2048 sc1
  v_mfma_f32_16x16x32_bf16 v[184:187], a[144:147], a[8:11], v[184:187]
  v_mfma_f32_16x16x32_bf16 v[180:183], a[144:147], a[4:7], v[180:183]
  ds_read_b64_tr_b16 a[140:141], v20 offset:192
  v_mfma_f32_16x16x32_bf16 v[180:183], a[148:151], a[20:23], v[180:183]
  ds_read_b64_tr_b16 a[142:143], v20 offset:3776
  v_mfma_f32_16x16x32_bf16 v[176:179], a[148:151], a[16:19], v[176:179]
  v_mfma_f32_16x16x32_bf16 v[176:179], a[144:147], a[0:3], v[176:179]
  s_waitcnt lgkmcnt(6)
  v_mfma_f32_16x16x32_bf16 v[192:195], a[152:155], a[0:3], v[192:195]
  ds_read_b64_tr_b16 a[144:145], v20 offset:7360
  v_mfma_f32_16x16x32_bf16 v[192:195], a[128:131], a[16:19], v[192:195]
  ds_read_b64_tr_b16 a[146:147], v20 offset:10944
  v_mfma_f32_16x16x32_bf16 v[196:199], a[128:131], a[20:23], v[196:199]
  buffer_load_dwordx4 a[100:103], v17, s[24:27], s29 offen offset:2048 sc1
  v_mfma_f32_16x16x32_bf16 v[196:199], a[152:155], a[4:7], v[196:199]
  v_mfma_f32_16x16x32_bf16 v[200:203], a[152:155], a[8:11], v[200:203]
  ds_read_b64_tr_b16 a[148:149], v20 offset:14528
  v_mfma_f32_16x16x32_bf16 v[200:203], a[128:131], a[24:27], v[200:203]
  ds_read_b64_tr_b16 a[150:151], v20 offset:18112
  v_mfma_f32_16x16x32_bf16 v[204:207], a[128:131], a[28:31], v[204:207]
  v_mfma_f32_16x16x32_bf16 v[204:207], a[152:155], a[12:15], v[204:207]
  s_waitcnt lgkmcnt(6)
  v_mfma_f32_16x16x32_bf16 v[220:223], a[132:135], a[12:15], v[220:223]
  ds_read_b64_tr_b16 a[152:153], v20 offset:21696
  v_mfma_f32_16x16x32_bf16 v[220:223], a[136:139], a[28:31], v[220:223]
  ds_read_b64_tr_b16 a[154:155], v20 offset:25280
  v_mfma_f32_16x16x32_bf16 v[216:219], a[136:139], a[24:27], v[216:219]
  v_mfma_f32_16x16x32_bf16 v[216:219], a[132:135], a[8:11], v[216:219]
  s_waitcnt vmcnt(28)
  s_barrier
  v_mfma_f32_16x16x32_bf16 v[212:215], a[132:135], a[4:7], v[212:215]
  ds_read_b64_tr_b16 a[128:129], v20 offset:28672
  v_mfma_f32_16x16x32_bf16 v[212:215], a[136:139], a[20:23], v[212:215]
  ds_read_b64_tr_b16 a[130:131], v20 offset:32256
  v_mfma_f32_16x16x32_bf16 v[208:211], a[136:139], a[16:19], v[208:211]
  buffer_load_dwordx4 a[104:107], v18, s[24:27], s29 offen offset:2048 sc1
  v_mfma_f32_16x16x32_bf16 v[208:211], a[132:135], a[0:3], v[208:211]
  s_waitcnt lgkmcnt(6)
  v_mfma_f32_16x16x32_bf16 v[224:227], a[140:143], a[0:3], v[224:227]
  ds_read_b64_tr_b16 a[132:133], v20 offset:35840
  v_mfma_f32_16x16x32_bf16 v[224:227], a[144:147], a[16:19], v[224:227]
  ds_read_b64_tr_b16 a[134:135], v20 offset:39424
  s_add_u32 m0, s30, 86016
  v_mfma_f32_16x16x32_bf16 v[228:231], a[144:147], a[20:23], v[228:231]
  buffer_load_dwordx4 v8, s[20:23], s28 offen offset:0 lds
  v_mfma_f32_16x16x32_bf16 v[228:231], a[140:143], a[4:7], v[228:231]
  v_mfma_f32_16x16x32_bf16 v[232:235], a[140:143], a[8:11], v[232:235]
  ds_read_b64_tr_b16 a[136:137], v20 offset:43008
  v_mfma_f32_16x16x32_bf16 v[232:235], a[144:147], a[24:27], v[232:235]
  ds_read_b64_tr_b16 a[138:139], v20 offset:46592
  v_mfma_f32_16x16x32_bf16 v[236:239], a[144:147], a[28:31], v[236:239]
  buffer_load_dwordx4 a[108:111], v19, s[24:27], s29 offen offset:2048 sc1
  v_mfma_f32_16x16x32_bf16 v[236:239], a[140:143], a[12:15], v[236:239]
  s_waitcnt lgkmcnt(6)
  v_mfma_f32_16x16x32_bf16 v[252:255], a[148:151], a[12:15], v[252:255]
  ds_read_b64_tr_b16 a[140:141], v20 offset:50176
  v_mfma_f32_16x16x32_bf16 v[252:255], a[152:155], a[28:31], v[252:255]
  ds_read_b64_tr_b16 a[142:143], v20 offset:53760
  v_mfma_f32_16x16x32_bf16 v[248:251], a[152:155], a[24:27], v[248:251]
  buffer_load_dwordx4 v9, s[20:23], s28 offen offset:1024 lds
  v_mfma_f32_16x16x32_bf16 v[248:251], a[148:151], a[8:11], v[248:251]
  v_mfma_f32_16x16x32_bf16 v[244:247], a[148:151], a[4:7], v[244:247]
  ds_read_b64_tr_b16 a[144:145], v20 offset:28704
  v_mfma_f32_16x16x32_bf16 v[244:247], a[152:155], a[20:23], v[244:247]
  ds_read_b64_tr_b16 a[146:147], v20 offset:32288
  v_mfma_f32_16x16x32_bf16 v[240:243], a[152:155], a[16:19], v[240:243]
  buffer_load_dwordx4 a[112:115], v16, s[24:27], s29 offen offset:3072 sc1
  v_mfma_f32_16x16x32_bf16 v[240:243], a[148:151], a[0:3], v[240:243]
  v_add_u32 v5, 114688, v16
  v_add_u32 v6, 229376, v16
  v_add_u32 v7, 344064, v16
  s_waitcnt vmcnt(23)
  s_waitcnt lgkmcnt(6)
  v_mfma_f32_16x16x32_bf16 v[32:35], a[128:131], a[32:35], v[32:35]
  ds_read_b64_tr_b16 a[148:149], v20 offset:35872
  v_mfma_f32_16x16x32_bf16 v[32:35], a[132:135], a[48:51], v[32:35]
  ds_read_b64_tr_b16 a[150:151], v20 offset:39456
  v_mfma_f32_16x16x32_bf16 v[36:39], a[132:135], a[52:55], v[36:39]
  buffer_load_dwordx4 v10, s[20:23], s28 offen offset:2048 lds
  v_mfma_f32_16x16x32_bf16 v[36:39], a[128:131], a[36:39], v[36:39]
  v_mfma_f32_16x16x32_bf16 v[40:43], a[128:131], a[40:43], v[40:43]
  ds_read_b64_tr_b16 a[152:153], v20 offset:43040
  v_mfma_f32_16x16x32_bf16 v[40:43], a[132:135], a[56:59], v[40:43]
  ds_read_b64_tr_b16 a[154:155], v20 offset:46624
  v_mfma_f32_16x16x32_bf16 v[44:47], a[132:135], a[60:63], v[44:47]
  buffer_load_dwordx4 a[116:119], v17, s[24:27], s29 offen offset:3072 sc1
  v_mfma_f32_16x16x32_bf16 v[44:47], a[128:131], a[44:47], v[44:47]
  s_waitcnt lgkmcnt(6)
  v_mfma_f32_16x16x32_bf16 v[60:63], a[136:139], a[44:47], v[60:63]
  ds_read_b64_tr_b16 a[128:129], v20 offset:50208
  v_mfma_f32_16x16x32_bf16 v[60:63], a[140:143], a[60:63], v[60:63]
  ds_read_b64_tr_b16 a[130:131], v20 offset:53792
  v_mfma_f32_16x16x32_bf16 v[56:59], a[140:143], a[56:59], v[56:59]
  buffer_load_dwordx4 v11, s[20:23], s28 offen offset:3072 lds
  v_mfma_f32_16x16x32_bf16 v[56:59], a[136:139], a[40:43], v[56:59]
  v_mfma_f32_16x16x32_bf16 v[52:55], a[136:139], a[36:39], v[52:55]
  ds_read_b64_tr_b16 a[132:133], v20 offset:28736
  v_mfma_f32_16x16x32_bf16 v[52:55], a[140:143], a[52:55], v[52:55]
  ds_read_b64_tr_b16 a[134:135], v20 offset:32320
  v_mfma_f32_16x16x32_bf16 v[48:51], a[140:143], a[48:51], v[48:51]
  buffer_load_dwordx4 a[120:123], v18, s[24:27], s29 offen offset:3072 sc1
  v_mfma_f32_16x16x32_bf16 v[48:51], a[136:139], a[32:35], v[48:51]
  s_waitcnt lgkmcnt(6)
  v_mfma_f32_16x16x32_bf16 v[64:67], a[144:147], a[32:35], v[64:67]
  ds_read_b64_tr_b16 a[136:137], v20 offset:35904
  v_mfma_f32_16x16x32_bf16 v[64:67], a[148:151], a[48:51], v[64:67]
  ds_read_b64_tr_b16 a[138:139], v20 offset:39488
  s_add_u32 m0, s30, 90112
  v_mfma_f32_16x16x32_bf16 v[68:71], a[148:151], a[52:55], v[68:71]
  buffer_load_dwordx4 v12, s[20:23], s28 offen offset:0 lds
  v_mfma_f32_16x16x32_bf16 v[68:71], a[144:147], a[36:39], v[68:71]
  v_mfma_f32_16x16x32_bf16 v[72:75], a[144:147], a[40:43], v[72:75]
  ds_read_b64_tr_b16 a[140:141], v20 offset:43072
  v_mfma_f32_16x16x32_bf16 v[72:75], a[148:151], a[56:59], v[72:75]
  ds_read_b64_tr_b16 a[142:143], v20 offset:46656
  v_mfma_f32_16x16x32_bf16 v[76:79], a[148:151], a[60:63], v[76:79]
  buffer_load_dwordx4 a[124:127], v19, s[24:27], s29 offen offset:3072 sc1
  s_add_u32 s29, s29, 4096
  v_mfma_f32_16x16x32_bf16 v[76:79], a[144:147], a[44:47], v[76:79]
  s_waitcnt lgkmcnt(6)
  v_mfma_f32_16x16x32_bf16 v[92:95], a[152:155], a[44:47], v[92:95]
  ds_read_b64_tr_b16 a[144:145], v20 offset:50240
  v_mfma_f32_16x16x32_bf16 v[92:95], a[128:131], a[60:63], v[92:95]
  ds_read_b64_tr_b16 a[146:147], v20 offset:53824
  v_mfma_f32_16x16x32_bf16 v[88:91], a[128:131], a[56:59], v[88:91]
  buffer_load_dwordx4 v13, s[20:23], s28 offen offset:1024 lds
  v_mfma_f32_16x16x32_bf16 v[88:91], a[152:155], a[40:43], v[88:91]
  v_mfma_f32_16x16x32_bf16 v[84:87], a[152:155], a[36:39], v[84:87]
  ds_read_b64_tr_b16 a[148:149], v20 offset:28768
  v_mfma_f32_16x16x32_bf16 v[84:87], a[128:131], a[52:55], v[84:87]
  ds_read_b64_tr_b16 a[150:151], v20 offset:32352
  v_mfma_f32_16x16x32_bf16 v[80:83], a[128:131], a[48:51], v[80:83]
  v_mfma_f32_16x16x32_bf16 v[80:83], a[152:155], a[32:35], v[80:83]
  s_waitcnt lgkmcnt(6)
  v_mfma_f32_16x16x32_bf16 v[96:99], a[132:135], a[32:35], v[96:99]
  ds_read_b64_tr_b16 a[152:153], v20 offset:35936
  v_mfma_f32_16x16x32_bf16 v[96:99], a[136:139], a[48:51], v[96:99]
  ds_read_b64_tr_b16 a[154:155], v20 offset:39520
  v_mfma_f32_16x16x32_bf16 v[100:103], a[136:139], a[52:55], v[100:103]
  buffer_load_dwordx4 v14, s[20:23], s28 offen offset:2048 lds
  s_add_u32 s28, s28, 458752
  buffer_load_dword v29, v22, s[32:35], s41 offen
  s_add_u32 s41, s41, 512
  v_mfma_f32_16x16x32_bf16 v[100:103], a[132:135], a[36:39], v[100:103]
  v_mfma_f32_16x16x32_bf16 v[104:107], a[132:135], a[40:43], v[104:107]
  ds_read_b64_tr_b16 a[128:129], v20 offset:43104
  v_mfma_f32_16x16x32_bf16 v[104:107], a[136:139], a[56:59], v[104:107]
  ds_read_b64_tr_b16 a[130:131], v20 offset:46688
  v_mfma_f32_16x16x32_bf16 v[108:111], a[136:139], a[60:63], v[108:111]
  v_mfma_f32_16x16x32_bf16 v[108:111], a[132:135], a[44:47], v[108:111]
  s_waitcnt lgkmcnt(6)
  v_mfma_f32_16x16x32_bf16 v[124:127], a[140:143], a[44:47], v[124:127]
  ds_read_b64_tr_b16 a[132:133], v20 offset:50272
  v_mfma_f32_16x16x32_bf16 v[124:127], a[144:147], a[60:63], v[124:127]
  ds_read_b64_tr_b16 a[134:135], v20 offset:53856
  v_mfma_f32_16x16x32_bf16 v[120:123], a[144:147], a[56:59], v[120:123]
  v_mfma_f32_16x16x32_bf16 v[120:123], a[140:143], a[40:43], v[120:123]
  v_mfma_f32_16x16x32_bf16 v[116:119], a[140:143], a[36:39], v[116:119]
  ds_read_b64_tr_b16 a[136:137], v20 offset:28800
  v_mfma_f32_16x16x32_bf16 v[116:119], a[144:147], a[52:55], v[116:119]
  ds_read_b64_tr_b16 a[138:139], v20 offset:32384
  v_mfma_f32_16x16x32_bf16 v[112:115], a[144:147], a[48:51], v[112:115]
  buffer_store_dwordx4 v[24:27], v16, s[36:39], s40 offen sc1
  s_add_u32 s40, s40, 1024
  v_mfma_f32_16x16x32_bf16 v[112:115], a[140:143], a[32:35], v[112:115]
  s_waitcnt lgkmcnt(6)
  v_mfma_f32_16x16x32_bf16 v[128:131], a[148:151], a[32:35], v[128:131]
  ds_read_b64_tr_b16 a[140:141], v20 offset:35968
  v_mfma_f32_16x16x32_bf16 v[128:131], a[152:155], a[48:51], v[128:131]
  ds_read_b64_tr_b16 a[142:143], v20 offset:39552
  v_mfma_f32_16x16x32_bf16 v[132:135], a[152:155], a[52:55], v[132:135]
  v_mfma_f32_16x16x32_bf16 v[132:135], a[148:151], a[36:39], v[132:135]
  v_mfma_f32_16x16x32_bf16 v[136:139], a[148:151], a[40:43], v[136:139]
  ds_read_b64_tr_b16 a[144:145], v20 offset:43136
  v_mfma_f32_16x16x32_bf16 v[136:139], a[152:155], a[56:59], v[136:139]
  ds_read_b64_tr_b16 a[146:147], v20 offset:46720
  v_mfma_f32_16x16x32_bf16 v[140:143], a[152:155], a[60:63], v[140:143]
  v_mfma_f32_16x16x32_bf16 v[140:143], a[148:151], a[44:47], v[140:143]
  s_waitcnt lgkmcnt(6)
  v_mfma_f32_16x16x32_bf16 v[156:159], a[128:131], a[44:47], v[156:159]
  ds_read_b64_tr_b16 a[148:149], v20 offset:50304
  v_mfma_f32_16x16x32_bf16 v[156:159], a[132:135], a[60:63], v[156:159]
  ds_read_b64_tr_b16 a[150:151], v20 offset:53888
  v_mfma_f32_16x16x32_bf16 v[152:155], a[132:135], a[56:59], v[152:155]
  v_mfma_f32_16x16x32_bf16 v[152:155], a[128:131], a[40:43], v[152:155]
  v_mfma_f32_16x16x32_bf16 v[148:151], a[128:131], a[36:39], v[148:151]
  ds_read_b64_tr_b16 a[152:153], v20 offset:28832
  v_mfma_f32_16x16x32_bf16 v[148:151], a[132:135], a[52:55], v[148:151]
  ds_read_b64_tr_b16 a[154:155], v20 offset:32416
  v_mfma_f32_16x16x32_bf16 v[144:147], a[132:135], a[48:51], v[144:147]
  v_mfma_f32_16x16x32_bf16 v[144:147], a[128:131], a[32:35], v[144:147]
  s_mov_b32 s34, 7340032
  s_waitcnt lgkmcnt(6)
  v_mfma_f32_16x16x32_bf16 v[160:163], a[136:139], a[32:35], v[160:163]
  ds_read_b64_tr_b16 a[128:129], v20 offset:36000
  v_mfma_f32_16x16x32_bf16 v[160:163], a[140:143], a[48:51], v[160:163]
  ds_read_b64_tr_b16 a[130:131], v20 offset:39584
  v_mfma_f32_16x16x32_bf16 v[164:167], a[140:143], a[52:55], v[164:167]
  v_mfma_f32_16x16x32_bf16 v[164:167], a[136:139], a[36:39], v[164:167]
  v_lshrrev_b32 v2, 4, v0
  v_lshlrev_b32 v3, 1, v2
  v_and_b32 v8, 15, v0
  v_mfma_f32_16x16x32_bf16 v[168:171], a[136:139], a[40:43], v[168:171]
  ds_read_b64_tr_b16 a[132:133], v20 offset:43168
  v_mfma_f32_16x16x32_bf16 v[168:171], a[140:143], a[56:59], v[168:171]
  ds_read_b64_tr_b16 a[134:135], v20 offset:46752
  v_mfma_f32_16x16x32_bf16 v[172:175], a[140:143], a[60:63], v[172:175]
  v_mfma_f32_16x16x32_bf16 v[172:175], a[136:139], a[44:47], v[172:175]
  v_xor_b32 v3, v3, v8
  v_lshlrev_b32 v2, 11, v2
  v_lshl_add_u32 v8, v3, 4, v2
  s_waitcnt lgkmcnt(6)
  v_mfma_f32_16x16x32_bf16 v[188:191], a[144:147], a[44:47], v[188:191]
  ds_read_b64_tr_b16 a[136:137], v20 offset:50336
  v_mfma_f32_16x16x32_bf16 v[188:191], a[148:151], a[60:63], v[188:191]
  ds_read_b64_tr_b16 a[138:139], v20 offset:53920
  v_mfma_f32_16x16x32_bf16 v[184:187], a[148:151], a[56:59], v[184:187]
  v_mfma_f32_16x16x32_bf16 v[184:187], a[144:147], a[40:43], v[184:187]
  v_xor_b32 v9, 128, v8
  v_add_u32 v9, 7168, v9
  v_add_u32 v10, 14336, v8
  v_mfma_f32_16x16x32_bf16 v[180:183], a[144:147], a[36:39], v[180:183]
  ds_read_b64_tr_b16 a[140:141], v20 offset:28864
  v_mfma_f32_16x16x32_bf16 v[180:183], a[148:151], a[52:55], v[180:183]
  ds_read_b64_tr_b16 a[142:143], v20 offset:32448
  v_mfma_f32_16x16x32_bf16 v[176:179], a[148:151], a[48:51], v[176:179]
  v_mfma_f32_16x16x32_bf16 v[176:179], a[144:147], a[32:35], v[176:179]
  v_add_u32 v11, 14336, v9
  s_bfe_u32 s56, s2, 0x10001
  s_lshl_b32 s56, s56, 3
  s_waitcnt lgkmcnt(6)
  v_mfma_f32_16x16x32_bf16 v[192:195], a[152:155], a[32:35], v[192:195]
  ds_read_b64_tr_b16 a[144:145], v20 offset:36032
  v_mfma_f32_16x16x32_bf16 v[192:195], a[128:131], a[48:51], v[192:195]
  ds_read_b64_tr_b16 a[146:147], v20 offset:39616
  v_mfma_f32_16x16x32_bf16 v[196:199], a[128:131], a[52:55], v[196:199]
  v_mfma_f32_16x16x32_bf16 v[196:199], a[152:155], a[36:39], v[196:199]
  s_bfe_u32 s55, s2, 0x30003
  s_add_u32 s56, s56, s55
  s_and_b32 s54, s2, 1
  v_mfma_f32_16x16x32_bf16 v[200:203], a[152:155], a[40:43], v[200:203]
  ds_read_b64_tr_b16 a[148:149], v20 offset:43200
  v_mfma_f32_16x16x32_bf16 v[200:203], a[128:131], a[56:59], v[200:203]
  ds_read_b64_tr_b16 a[150:151], v20 offset:46784
  v_mfma_f32_16x16x32_bf16 v[204:207], a[128:131], a[60:63], v[204:207]
  v_mfma_f32_16x16x32_bf16 v[204:207], a[152:155], a[44:47], v[204:207]
  s_lshl_b32 s54, s54, 2
  s_lshr_b32 s55, s2, 6
  s_add_u32 s54, s54, s55
  s_waitcnt lgkmcnt(6)
  v_mfma_f32_16x16x32_bf16 v[220:223], a[132:135], a[44:47], v[220:223]
  ds_read_b64_tr_b16 a[152:153], v20 offset:50368
  v_mfma_f32_16x16x32_bf16 v[220:223], a[136:139], a[60:63], v[220:223]
  ds_read_b64_tr_b16 a[154:155], v20 offset:53952
  v_mfma_f32_16x16x32_bf16 v[216:219], a[136:139], a[56:59], v[216:219]
  v_mfma_f32_16x16x32_bf16 v[216:219], a[132:135], a[40:43], v[216:219]
  s_bfe_u32 s55, s2, 0x10002
  s_mul_i32 s52, s55, 3670016
  s_lshl_b32 s54, s54, 8
  s_waitcnt vmcnt(20)
  s_barrier
  v_mfma_f32_16x16x32_bf16 v[212:215], a[132:135], a[36:39], v[212:215]
  ds_read_b64_tr_b16 a[128:129], v21 offset:192
  v_mfma_f32_16x16x32_bf16 v[212:215], a[136:139], a[52:55], v[212:215]
  ds_read_b64_tr_b16 a[130:131], v21 offset:3776
  v_mfma_f32_16x16x32_bf16 v[208:211], a[136:139], a[48:51], v[208:211]
  v_mfma_f32_16x16x32_bf16 v[208:211], a[132:135], a[32:35], v[208:211]
  s_add_u32 s52, s52, s54
  s_lshl_b32 s54, s13, 15
  s_add_u32 s52, s52, s54
  s_waitcnt lgkmcnt(6)
  v_mfma_f32_16x16x32_bf16 v[224:227], a[140:143], a[32:35], v[224:227]
  ds_read_b64_tr_b16 a[132:133], v21 offset:7360
  v_mfma_f32_16x16x32_bf16 v[224:227], a[144:147], a[48:51], v[224:227]
  ds_read_b64_tr_b16 a[134:135], v21 offset:10944
  v_mfma_f32_16x16x32_bf16 v[228:231], a[144:147], a[52:55], v[228:231]
  v_mfma_f32_16x16x32_bf16 v[228:231], a[140:143], a[36:39], v[228:231]
  s_lshl_b32 s53, s13, 12
  s_mov_b32 s57, 196608
  s_cmp_lt_u32 s13, 2
  v_mfma_f32_16x16x32_bf16 v[232:235], a[140:143], a[40:43], v[232:235]
  ds_read_b64_tr_b16 a[136:137], v21 offset:14528
  v_mfma_f32_16x16x32_bf16 v[232:235], a[144:147], a[56:59], v[232:235]
  ds_read_b64_tr_b16 a[138:139], v21 offset:18112
  v_mfma_f32_16x16x32_bf16 v[236:239], a[144:147], a[60:63], v[236:239]
  v_mfma_f32_16x16x32_bf16 v[236:239], a[140:143], a[44:47], v[236:239]
  s_cselect_b32 s57, 131072, s57
  s_waitcnt lgkmcnt(6)
  v_mfma_f32_16x16x32_bf16 v[252:255], a[148:151], a[44:47], v[252:255]
  ds_read_b64_tr_b16 a[140:141], v21 offset:21696
  v_mfma_f32_16x16x32_bf16 v[252:255], a[152:155], a[60:63], v[252:255]
  ds_read_b64_tr_b16 a[142:143], v21 offset:25280
  v_mfma_f32_16x16x32_bf16 v[248:251], a[152:155], a[56:59], v[248:251]
  v_mfma_f32_16x16x32_bf16 v[248:251], a[148:151], a[40:43], v[248:251]
  s_waitcnt vmcnt(2)
  s_barrier
  v_mfma_f32_16x16x32_bf16 v[244:247], a[148:151], a[36:39], v[244:247]
  ds_read_b64_tr_b16 a[144:145], v21 offset:28864
  v_mfma_f32_16x16x32_bf16 v[244:247], a[152:155], a[52:55], v[244:247]
  ds_read_b64_tr_b16 a[146:147], v21 offset:32448
  v_mfma_f32_16x16x32_bf16 v[240:243], a[152:155], a[48:51], v[240:243]
  v_mfma_f32_16x16x32_bf16 v[240:243], a[148:151], a[32:35], v[240:243]
  s_waitcnt vmcnt(18)
  s_waitcnt lgkmcnt(6)
  v_mfma_f32_16x16x32_bf16 v[224:227], a[128:131], a[64:67], v[224:227]
  ds_read_b64_tr_b16 a[148:149], v21 offset:36032
  v_mfma_f32_16x16x32_bf16 v[224:227], a[132:135], a[80:83], v[224:227]
  ds_read_b64_tr_b16 a[150:151], v21 offset:39616
  v_mfma_f32_16x16x32_bf16 v[228:231], a[132:135], a[84:87], v[228:231]
  v_mfma_f32_16x16x32_bf16 v[228:231], a[128:131], a[68:71], v[228:231]
  v_mfma_f32_16x16x32_bf16 v[232:235], a[128:131], a[72:75], v[232:235]
  ds_read_b64_tr_b16 a[152:153], v21 offset:43200
  v_mfma_f32_16x16x32_bf16 v[232:235], a[132:135], a[88:91], v[232:235]
  ds_read_b64_tr_b16 a[154:155], v21 offset:46784
  v_mfma_f32_16x16x32_bf16 v[236:239], a[132:135], a[92:95], v[236:239]
  v_mfma_f32_16x16x32_bf16 v[236:239], a[128:131], a[76:79], v[236:239]
  s_waitcnt lgkmcnt(6)
  v_mfma_f32_16x16x32_bf16 v[252:255], a[136:139], a[76:79], v[252:255]
  ds_read_b64_tr_b16 a[128:129], v21 offset:50368
  v_mfma_f32_16x16x32_bf16 v[252:255], a[140:143], a[92:95], v[252:255]
  ds_read_b64_tr_b16 a[130:131], v21 offset:53952
  v_mfma_f32_16x16x32_bf16 v[248:251], a[140:143], a[88:91], v[248:251]
  v_mfma_f32_16x16x32_bf16 v[248:251], a[136:139], a[72:75], v[248:251]
  v_mfma_f32_16x16x32_bf16 v[244:247], a[136:139], a[68:71], v[244:247]
  ds_read_b64_tr_b16 a[132:133], v21 offset:0
  v_mfma_f32_16x16x32_bf16 v[244:247], a[140:143], a[84:87], v[244:247]
  ds_read_b64_tr_b16 a[134:135], v21 offset:3584
  v_mfma_f32_16x16x32_bf16 v[240:243], a[140:143], a[80:83], v[240:243]
  v_mfma_f32_16x16x32_bf16 v[240:243], a[136:139], a[64:67], v[240:243]
  s_waitcnt vmcnt(4)
  s_waitcnt lgkmcnt(6)
  v_mfma_f32_16x16x32_bf16 v[224:227], a[144:147], a[96:99], v[224:227]
  ds_read_b64_tr_b16 a[136:137], v21 offset:7168
  v_mfma_f32_16x16x32_bf16 v[224:227], a[148:151], a[112:115], v[224:227]
  ds_read_b64_tr_b16 a[138:139], v21 offset:10752
  v_mfma_f32_16x16x32_bf16 v[228:231], a[148:151], a[116:119], v[228:231]
  v_mfma_f32_16x16x32_bf16 v[228:231], a[144:147], a[100:103], v[228:231]
  v_mfma_f32_16x16x32_bf16 v[232:235], a[144:147], a[104:107], v[232:235]
  ds_read_b64_tr_b16 a[140:141], v21 offset:14336
  v_mfma_f32_16x16x32_bf16 v[232:235], a[148:151], a[120:123], v[232:235]
  ds_read_b64_tr_b16 a[142:143], v21 offset:17920
  v_mfma_f32_16x16x32_bf16 v[236:239], a[148:151], a[124:127], v[236:239]
  v_mfma_f32_16x16x32_bf16 v[236:239], a[144:147], a[108:111], v[236:239]
  s_waitcnt lgkmcnt(6)
  v_mfma_f32_16x16x32_bf16 v[252:255], a[152:155], a[108:111], v[252:255]
  ds_read_b64_tr_b16 a[144:145], v21 offset:21504
  v_mfma_f32_16x16x32_bf16 v[252:255], a[128:131], a[124:127], v[252:255]
  ds_read_b64_tr_b16 a[146:147], v21 offset:25088
  v_mfma_f32_16x16x32_bf16 v[248:251], a[128:131], a[120:123], v[248:251]
  v_mfma_f32_16x16x32_bf16 v[248:251], a[152:155], a[104:107], v[248:251]
  v_mfma_f32_16x16x32_bf16 v[244:247], a[152:155], a[100:103], v[244:247]
  ds_read_b64_tr_b16 a[148:149], v21 offset:32
  v_mfma_f32_16x16x32_bf16 v[244:247], a[128:131], a[116:119], v[244:247]
  ds_read_b64_tr_b16 a[150:151], v21 offset:3616
  v_mfma_f32_16x16x32_bf16 v[240:243], a[128:131], a[112:115], v[240:243]
  v_mfma_f32_16x16x32_bf16 v[240:243], a[152:155], a[96:99], v[240:243]
  s_waitcnt lgkmcnt(6)
  v_mfma_f32_16x16x32_bf16 v[32:35], a[132:135], a[64:67], v[32:35]
  ds_read_b64_tr_b16 a[152:153], v21 offset:7200
  v_mfma_f32_16x16x32_bf16 v[32:35], a[136:139], a[80:83], v[32:35]
  ds_read_b64_tr_b16 a[154:155], v21 offset:10784
  v_mfma_f32_16x16x32_bf16 v[36:39], a[136:139], a[84:87], v[36:39]
  v_mfma_f32_16x16x32_bf16 v[36:39], a[132:135], a[68:71], v[36:39]
  v_mfma_f32_16x16x32_bf16 v[40:43], a[132:135], a[72:75], v[40:43]
  ds_read_b64_tr_b16 a[128:129], v21 offset:14368
  v_mul_f32 v224, v224, v240
  v_mfma_f32_16x16x32_bf16 v[40:43], a[136:139], a[88:91], v[40:43]
  ds_read_b64_tr_b16 a[130:131], v21 offset:17952
  v_mul_f32 v225, v225, v241
  v_mfma_f32_16x16x32_bf16 v[44:47], a[136:139], a[92:95], v[44:47]
  v_mul_f32 v226, v226, v242
  v_mfma_f32_16x16x32_bf16 v[44:47], a[132:135], a[76:79], v[44:47]
  v_mul_f32 v227, v227, v243
  s_waitcnt lgkmcnt(6)
  v_mfma_f32_16x16x32_bf16 v[60:63], a[140:143], a[76:79], v[60:63]
  ds_read_b64_tr_b16 a[132:133], v21 offset:21536
  v_cvt_pk_bf16_f32 v240, v224, v225
  v_mfma_f32_16x16x32_bf16 v[60:63], a[144:147], a[92:95], v[60:63]
  ds_read_b64_tr_b16 a[134:135], v21 offset:25120
  v_cvt_pk_bf16_f32 v241, v226, v227
  v_mfma_f32_16x16x32_bf16 v[56:59], a[144:147], a[88:91], v[56:59]
  buffer_store_dwordx2 v[240:241], v16, s[44:47], s49 offen sc1
  v_mfma_f32_16x16x32_bf16 v[56:59], a[140:143], a[72:75], v[56:59]
  v_mul_f32 v228, v228, v244
  v_mfma_f32_16x16x32_bf16 v[52:55], a[140:143], a[68:71], v[52:55]
  ds_read_b64_tr_b16 a[136:137], v21 offset:28672
  v_mul_f32 v229, v229, v245
  v_mfma_f32_16x16x32_bf16 v[52:55], a[144:147], a[84:87], v[52:55]
  ds_read_b64_tr_b16 a[138:139], v21 offset:32256
  v_mul_f32 v230, v230, v246
  v_mfma_f32_16x16x32_bf16 v[48:51], a[144:147], a[80:83], v[48:51]
  v_mul_f32 v231, v231, v247
  v_mfma_f32_16x16x32_bf16 v[48:51], a[140:143], a[64:67], v[48:51]
  v_cvt_pk_bf16_f32 v244, v228, v229
  s_waitcnt lgkmcnt(6)
  v_mfma_f32_16x16x32_bf16 v[64:67], a[148:151], a[64:67], v[64:67]
  ds_read_b64_tr_b16 a[140:141], v21 offset:35840
  v_cvt_pk_bf16_f32 v245, v230, v231
  v_mfma_f32_16x16x32_bf16 v[64:67], a[152:155], a[80:83], v[64:67]
  ds_read_b64_tr_b16 a[142:143], v21 offset:39424
  buffer_store_dwordx2 v[244:245], v5, s[44:47], s49 offen sc1
  v_mfma_f32_16x16x32_bf16 v[68:71], a[152:155], a[84:87], v[68:71]
  v_mul_f32 v232, v232, v248
  v_mfma_f32_16x16x32_bf16 v[68:71], a[148:151], a[68:71], v[68:71]
  v_mul_f32 v233, v233, v249
  v_mfma_f32_16x16x32_bf16 v[72:75], a[148:151], a[72:75], v[72:75]
  ds_read_b64_tr_b16 a[144:145], v21 offset:43008
  v_mul_f32 v234, v234, v250
  v_mfma_f32_16x16x32_bf16 v[72:75], a[152:155], a[88:91], v[72:75]
  ds_read_b64_tr_b16 a[146:147], v21 offset:46592
  v_mul_f32 v235, v235, v251
  v_mfma_f32_16x16x32_bf16 v[76:79], a[152:155], a[92:95], v[76:79]
  v_cvt_pk_bf16_f32 v248, v232, v233
  v_mfma_f32_16x16x32_bf16 v[76:79], a[148:151], a[76:79], v[76:79]
  v_cvt_pk_bf16_f32 v249, v234, v235
  s_waitcnt lgkmcnt(6)
  v_mfma_f32_16x16x32_bf16 v[92:95], a[128:131], a[76:79], v[92:95]
  ds_read_b64_tr_b16 a[148:149], v21 offset:50176
  buffer_store_dwordx2 v[248:249], v6, s[44:47], s49 offen sc1
  v_mfma_f32_16x16x32_bf16 v[92:95], a[132:135], a[92:95], v[92:95]
  ds_read_b64_tr_b16 a[150:151], v21 offset:53760
  v_mul_f32 v236, v236, v252
  v_mfma_f32_16x16x32_bf16 v[88:91], a[132:135], a[88:91], v[88:91]
  v_mul_f32 v237, v237, v253
  v_mfma_f32_16x16x32_bf16 v[88:91], a[128:131], a[72:75], v[88:91]
  v_mul_f32 v238, v238, v254
  v_mfma_f32_16x16x32_bf16 v[84:87], a[128:131], a[68:71], v[84:87]
  ds_read_b64_tr_b16 a[152:153], v21 offset:28704
  v_mul_f32 v239, v239, v255
  v_mfma_f32_16x16x32_bf16 v[84:87], a[132:135], a[84:87], v[84:87]
  ds_read_b64_tr_b16 a[154:155], v21 offset:32288
  v_cvt_pk_bf16_f32 v252, v236, v237
  v_mfma_f32_16x16x32_bf16 v[80:83], a[132:135], a[80:83], v[80:83]
  v_cvt_pk_bf16_f32 v253, v238, v239
  v_mfma_f32_16x16x32_bf16 v[80:83], a[128:131], a[64:67], v[80:83]
  buffer_store_dwordx2 v[252:253], v7, s[44:47], s49 offen sc1
  s_waitcnt lgkmcnt(6)
  v_mfma_f32_16x16x32_bf16 v[32:35], a[136:139], a[96:99], v[32:35]
  ds_read_b64_tr_b16 a[128:129], v21 offset:35872
  v_mfma_f32_16x16x32_bf16 v[32:35], a[140:143], a[112:115], v[32:35]
  ds_read_b64_tr_b16 a[130:131], v21 offset:39456
  v_mfma_f32_16x16x32_bf16 v[36:39], a[140:143], a[116:119], v[36:39]
  v_mfma_f32_16x16x32_bf16 v[36:39], a[136:139], a[100:103], v[36:39]
  v_mfma_f32_16x16x32_bf16 v[40:43], a[136:139], a[104:107], v[40:43]
  ds_read_b64_tr_b16 a[132:133], v21 offset:43040
  v_mfma_f32_16x16x32_bf16 v[40:43], a[140:143], a[120:123], v[40:43]
  ds_read_b64_tr_b16 a[134:135], v21 offset:46624
  v_mfma_f32_16x16x32_bf16 v[44:47], a[140:143], a[124:127], v[44:47]
  v_mfma_f32_16x16x32_bf16 v[44:47], a[136:139], a[108:111], v[44:47]
  s_waitcnt lgkmcnt(6)
  v_mfma_f32_16x16x32_bf16 v[60:63], a[144:147], a[108:111], v[60:63]
  ds_read_b64_tr_b16 a[136:137], v21 offset:50208
  v_mfma_f32_16x16x32_bf16 v[60:63], a[148:151], a[124:127], v[60:63]
  ds_read_b64_tr_b16 a[138:139], v21 offset:53792
  v_mfma_f32_16x16x32_bf16 v[56:59], a[148:151], a[120:123], v[56:59]
  v_mfma_f32_16x16x32_bf16 v[56:59], a[144:147], a[104:107], v[56:59]
  v_mfma_f32_16x16x32_bf16 v[52:55], a[144:147], a[100:103], v[52:55]
  ds_read_b64_tr_b16 a[140:141], v21 offset:64
  v_mfma_f32_16x16x32_bf16 v[52:55], a[148:151], a[116:119], v[52:55]
  ds_read_b64_tr_b16 a[142:143], v21 offset:3648
  v_mfma_f32_16x16x32_bf16 v[48:51], a[148:151], a[112:115], v[48:51]
  v_mfma_f32_16x16x32_bf16 v[48:51], a[144:147], a[96:99], v[48:51]
  s_waitcnt lgkmcnt(6)
  v_mfma_f32_16x16x32_bf16 v[64:67], a[152:155], a[96:99], v[64:67]
  ds_read_b64_tr_b16 a[144:145], v21 offset:7232
  v_mfma_f32_16x16x32_bf16 v[64:67], a[128:131], a[112:115], v[64:67]
  ds_read_b64_tr_b16 a[146:147], v21 offset:10816
  v_mfma_f32_16x16x32_bf16 v[68:71], a[128:131], a[116:119], v[68:71]
  v_mfma_f32_16x16x32_bf16 v[68:71], a[152:155], a[100:103], v[68:71]
  v_mfma_f32_16x16x32_bf16 v[72:75], a[152:155], a[104:107], v[72:75]
  ds_read_b64_tr_b16 a[148:149], v21 offset:14400
  v_mfma_f32_16x16x32_bf16 v[72:75], a[128:131], a[120:123], v[72:75]
  ds_read_b64_tr_b16 a[150:151], v21 offset:17984
  v_mfma_f32_16x16x32_bf16 v[76:79], a[128:131], a[124:127], v[76:79]
  v_mfma_f32_16x16x32_bf16 v[76:79], a[152:155], a[108:111], v[76:79]
  s_waitcnt lgkmcnt(6)
  v_mfma_f32_16x16x32_bf16 v[92:95], a[132:135], a[108:111], v[92:95]
  ds_read_b64_tr_b16 a[152:153], v21 offset:21568
  v_mfma_f32_16x16x32_bf16 v[92:95], a[136:139], a[124:127], v[92:95]
  ds_read_b64_tr_b16 a[154:155], v21 offset:25152
  v_mfma_f32_16x16x32_bf16 v[88:91], a[136:139], a[120:123], v[88:91]
  v_mfma_f32_16x16x32_bf16 v[88:91], a[132:135], a[104:107], v[88:91]
  v_mfma_f32_16x16x32_bf16 v[84:87], a[132:135], a[100:103], v[84:87]
  ds_read_b64_tr_b16 a[128:129], v21 offset:96
  v_mfma_f32_16x16x32_bf16 v[84:87], a[136:139], a[116:119], v[84:87]
  ds_read_b64_tr_b16 a[130:131], v21 offset:3680
  v_mfma_f32_16x16x32_bf16 v[80:83], a[136:139], a[112:115], v[80:83]
  v_mfma_f32_16x16x32_bf16 v[80:83], a[132:135], a[96:99], v[80:83]
  s_waitcnt lgkmcnt(6)
  v_mfma_f32_16x16x32_bf16 v[96:99], a[140:143], a[64:67], v[96:99]
  ds_read_b64_tr_b16 a[132:133], v21 offset:7264
  v_mfma_f32_16x16x32_bf16 v[96:99], a[144:147], a[80:83], v[96:99]
  ds_read_b64_tr_b16 a[134:135], v21 offset:10848
  v_mfma_f32_16x16x32_bf16 v[100:103], a[144:147], a[84:87], v[100:103]
  v_mfma_f32_16x16x32_bf16 v[100:103], a[140:143], a[68:71], v[100:103]
  v_mfma_f32_16x16x32_bf16 v[104:107], a[140:143], a[72:75], v[104:107]
  ds_read_b64_tr_b16 a[136:137], v21 offset:14432
  v_mul_f32 v32, v32, v48
  v_mfma_f32_16x16x32_bf16 v[104:107], a[144:147], a[88:91], v[104:107]
  ds_read_b64_tr_b16 a[138:139], v21 offset:18016
  v_mul_f32 v33, v33, v49
  v_mfma_f32_16x16x32_bf16 v[108:111], a[144:147], a[92:95], v[108:111]
  v_mul_f32 v34, v34, v50
  v_mfma_f32_16x16x32_bf16 v[108:111], a[140:143], a[76:79], v[108:111]
  v_mul_f32 v35, v35, v51
  s_waitcnt lgkmcnt(6)
  v_mfma_f32_16x16x32_bf16 v[124:127], a[148:151], a[76:79], v[124:127]
  ds_read_b64_tr_b16 a[140:141], v21 offset:21600
  v_mul_f32 v64, v64, v80
  v_mfma_f32_16x16x32_bf16 v[124:127], a[152:155], a[92:95], v[124:127]
  ds_read_b64_tr_b16 a[142:143], v21 offset:25184
  v_mul_f32 v65, v65, v81
  v_mfma_f32_16x16x32_bf16 v[120:123], a[152:155], a[88:91], v[120:123]
  v_mul_f32 v66, v66, v82
  v_mfma_f32_16x16x32_bf16 v[120:123], a[148:151], a[72:75], v[120:123]
  v_mul_f32 v67, v67, v83
  v_mfma_f32_16x16x32_bf16 v[116:119], a[148:151], a[68:71], v[116:119]
  ds_read_b64_tr_b16 a[144:145], v21 offset:28736
  v_cvt_pk_bf16_f32 v48, v32, v33
  v_mfma_f32_16x16x32_bf16 v[116:119], a[152:155], a[84:87], v[116:119]
  ds_read_b64_tr_b16 a[146:147], v21 offset:32320
  v_cvt_pk_bf16_f32 v49, v34, v35
  v_mfma_f32_16x16x32_bf16 v[112:115], a[152:155], a[80:83], v[112:115]
  v_cvt_pk_bf16_f32 v50, v64, v65
  v_mfma_f32_16x16x32_bf16 v[112:115], a[148:151], a[64:67], v[112:115]
  v_cvt_pk_bf16_f32 v51, v66, v67
  s_waitcnt lgkmcnt(6)
  v_mfma_f32_16x16x32_bf16 v[128:131], a[128:131], a[64:67], v[128:131]
  ds_read_b64_tr_b16 a[148:149], v21 offset:35904
  buffer_store_dwordx4 v[48:51], v16, s[44:47], s48 offen offset:0 sc1
  v_mfma_f32_16x16x32_bf16 v[128:131], a[132:135], a[80:83], v[128:131]
  ds_read_b64_tr_b16 a[150:151], v21 offset:39488
  v_mul_f32 v36, v36, v52
  v_mfma_f32_16x16x32_bf16 v[132:135], a[132:135], a[84:87], v[132:135]
  v_mul_f32 v37, v37, v53
  v_mfma_f32_16x16x32_bf16 v[132:135], a[128:131], a[68:71], v[132:135]
  v_mul_f32 v38, v38, v54
  v_mfma_f32_16x16x32_bf16 v[136:139], a[128:131], a[72:75], v[136:139]
  ds_read_b64_tr_b16 a[152:153], v21 offset:43072
  v_mul_f32 v39, v39, v55
  v_mfma_f32_16x16x32_bf16 v[136:139], a[132:135], a[88:91], v[136:139]
  ds_read_b64_tr_b16 a[154:155], v21 offset:46656
  v_mul_f32 v68, v68, v84
  v_mfma_f32_16x16x32_bf16 v[140:143], a[132:135], a[92:95], v[140:143]
  v_mul_f32 v69, v69, v85
  v_mfma_f32_16x16x32_bf16 v[140:143], a[128:131], a[76:79], v[140:143]
  v_mul_f32 v70, v70, v86
  s_waitcnt lgkmcnt(6)
  v_mfma_f32_16x16x32_bf16 v[156:159], a[136:139], a[76:79], v[156:159]
  ds_read_b64_tr_b16 a[128:129], v21 offset:50240
  v_mul_f32 v71, v71, v87
  v_mfma_f32_16x16x32_bf16 v[156:159], a[140:143], a[92:95], v[156:159]
  ds_read_b64_tr_b16 a[130:131], v21 offset:53824
  v_cvt_pk_bf16_f32 v52, v36, v37
  v_mfma_f32_16x16x32_bf16 v[152:155], a[140:143], a[88:91], v[152:155]
  v_cvt_pk_bf16_f32 v53, v38, v39
  v_mfma_f32_16x16x32_bf16 v[152:155], a[136:139], a[72:75], v[152:155]
  v_cvt_pk_bf16_f32 v54, v68, v69
  v_mfma_f32_16x16x32_bf16 v[148:151], a[136:139], a[68:71], v[148:151]
  ds_read_b64_tr_b16 a[132:133], v21 offset:28768
  v_cvt_pk_bf16_f32 v55, v70, v71
  v_mfma_f32_16x16x32_bf16 v[148:151], a[140:143], a[84:87], v[148:151]
  ds_read_b64_tr_b16 a[134:135], v21 offset:32352
  buffer_store_dwordx4 v[52:55], v5, s[44:47], s48 offen offset:0 sc1
  v_mfma_f32_16x16x32_bf16 v[144:147], a[140:143], a[80:83], v[144:147]
  v_mul_f32 v40, v40, v56
  v_mfma_f32_16x16x32_bf16 v[144:147], a[136:139], a[64:67], v[144:147]
  v_mul_f32 v41, v41, v57
  s_waitcnt lgkmcnt(6)
  v_mfma_f32_16x16x32_bf16 v[96:99], a[144:147], a[96:99], v[96:99]
  ds_read_b64_tr_b16 a[136:137], v21 offset:35936
  v_mul_f32 v42, v42, v58
  v_mfma_f32_16x16x32_bf16 v[96:99], a[148:151], a[112:115], v[96:99]
  ds_read_b64_tr_b16 a[138:139], v21 offset:39520
  v_mul_f32 v43, v43, v59
  v_mfma_f32_16x16x32_bf16 v[100:103], a[148:151], a[116:119], v[100:103]
  v_mul_f32 v72, v72, v88
  v_mfma_f32_16x16x32_bf16 v[100:103], a[144:147], a[100:103], v[100:103]
  v_mul_f32 v73, v73, v89
  v_mfma_f32_16x16x32_bf16 v[104:107], a[144:147], a[104:107], v[104:107]
  ds_read_b64_tr_b16 a[140:141], v21 offset:43104
  v_mul_f32 v74, v74, v90
  v_mfma_f32_16x16x32_bf16 v[104:107], a[148:151], a[120:123], v[104:107]
  ds_read_b64_tr_b16 a[142:143], v21 offset:46688
  v_mul_f32 v75, v75, v91
  v_mfma_f32_16x16x32_bf16 v[108:111], a[148:151], a[124:127], v[108:111]
  v_cvt_pk_bf16_f32 v56, v40, v41
  v_mfma_f32_16x16x32_bf16 v[108:111], a[144:147], a[108:111], v[108:111]
  v_cvt_pk_bf16_f32 v57, v42, v43
  s_waitcnt lgkmcnt(6)
  v_mfma_f32_16x16x32_bf16 v[124:127], a[152:155], a[108:111], v[124:127]
  ds_read_b64_tr_b16 a[144:145], v21 offset:50272
  v_cvt_pk_bf16_f32 v58, v72, v73
  v_mfma_f32_16x16x32_bf16 v[124:127], a[128:131], a[124:127], v[124:127]
  ds_read_b64_tr_b16 a[146:147], v21 offset:53856
  v_cvt_pk_bf16_f32 v59, v74, v75
  v_mfma_f32_16x16x32_bf16 v[120:123], a[128:131], a[120:123], v[120:123]
  buffer_store_dwordx4 v[56:59], v6, s[44:47], s48 offen offset:0 sc1
  v_mfma_f32_16x16x32_bf16 v[120:123], a[152:155], a[104:107], v[120:123]
  v_mul_f32 v44, v44, v60
  v_mfma_f32_16x16x32_bf16 v[116:119], a[152:155], a[100:103], v[116:119]
  ds_read_b64_tr_b16 a[148:149], v21 offset:128
  v_mul_f32 v45, v45, v61
  v_mfma_f32_16x16x32_bf16 v[116:119], a[128:131], a[116:119], v[116:119]
  ds_read_b64_tr_b16 a[150:151], v21 offset:3712
  v_mul_f32 v46, v46, v62
  v_mfma_f32_16x16x32_bf16 v[112:115], a[128:131], a[112:115], v[112:115]
  v_mul_f32 v47, v47, v63
  v_mfma_f32_16x16x32_bf16 v[112:115], a[152:155], a[96:99], v[112:115]
  v_mul_f32 v76, v76, v92
  s_waitcnt lgkmcnt(6)
  v_mfma_f32_16x16x32_bf16 v[128:131], a[132:135], a[96:99], v[128:131]
  ds_read_b64_tr_b16 a[152:153], v21 offset:7296
  v_mul_f32 v77, v77, v93
  v_mfma_f32_16x16x32_bf16 v[128:131], a[136:139], a[112:115], v[128:131]
  ds_read_b64_tr_b16 a[154:155], v21 offset:10880
  v_mul_f32 v78, v78, v94
  v_mfma_f32_16x16x32_bf16 v[132:135], a[136:139], a[116:119], v[132:135]
  v_mul_f32 v79, v79, v95
  v_mfma_f32_16x16x32_bf16 v[132:135], a[132:135], a[100:103], v[132:135]
  v_cvt_pk_bf16_f32 v60, v44, v45
  v_mfma_f32_16x16x32_bf16 v[136:139], a[132:135], a[104:107], v[136:139]
  ds_read_b64_tr_b16 a[128:129], v21 offset:14464
  v_cvt_pk_bf16_f32 v61, v46, v47
  v_mfma_f32_16x16x32_bf16 v[136:139], a[136:139], a[120:123], v[136:139]
  ds_read_b64_tr_b16 a[130:131], v21 offset:18048
  v_cvt_pk_bf16_f32 v62, v76, v77
  v_mfma_f32_16x16x32_bf16 v[140:143], a[136:139], a[124:127], v[140:143]
  v_cvt_pk_bf16_f32 v63, v78, v79
  v_mfma_f32_16x16x32_bf16 v[140:143], a[132:135], a[108:111], v[140:143]
  buffer_store_dwordx4 v[60:63], v7, s[44:47], s48 offen offset:0 sc1
  s_waitcnt lgkmcnt(6)
  v_mfma_f32_16x16x32_bf16 v[156:159], a[140:143], a[108:111], v[156:159]
  ds_read_b64_tr_b16 a[132:133], v21 offset:21632
  v_mfma_f32_16x16x32_bf16 v[156:159], a[144:147], a[124:127], v[156:159]
  ds_read_b64_tr_b16 a[134:135], v21 offset:25216
  v_mfma_f32_16x16x32_bf16 v[152:155], a[144:147], a[120:123], v[152:155]
  v_mfma_f32_16x16x32_bf16 v[152:155], a[140:143], a[104:107], v[152:155]
  v_mfma_f32_16x16x32_bf16 v[148:151], a[140:143], a[100:103], v[148:151]
  ds_read_b64_tr_b16 a[136:137], v21 offset:160
  v_mfma_f32_16x16x32_bf16 v[148:151], a[144:147], a[116:119], v[148:151]
  ds_read_b64_tr_b16 a[138:139], v21 offset:3744
  v_mfma_f32_16x16x32_bf16 v[144:147], a[144:147], a[112:115], v[144:147]
  v_mfma_f32_16x16x32_bf16 v[144:147], a[140:143], a[96:99], v[144:147]
  s_waitcnt lgkmcnt(6)
  v_mfma_f32_16x16x32_bf16 v[160:163], a[148:151], a[64:67], v[160:163]
  ds_read_b64_tr_b16 a[140:141], v21 offset:7328
  v_mfma_f32_16x16x32_bf16 v[160:163], a[152:155], a[80:83], v[160:163]
  ds_read_b64_tr_b16 a[142:143], v21 offset:10912
  v_mfma_f32_16x16x32_bf16 v[164:167], a[152:155], a[84:87], v[164:167]
  v_mfma_f32_16x16x32_bf16 v[164:167], a[148:151], a[68:71], v[164:167]
  v_mfma_f32_16x16x32_bf16 v[168:171], a[148:151], a[72:75], v[168:171]
  ds_read_b64_tr_b16 a[144:145], v21 offset:14496
  v_mul_f32 v96, v96, v112
  v_mul_f32 v97, v97, v113
  v_mfma_f32_16x16x32_bf16 v[168:171], a[152:155], a[88:91], v[168:171]
  ds_read_b64_tr_b16 a[146:147], v21 offset:18080
  v_mul_f32 v98, v98, v114
  v_mul_f32 v99, v99, v115
  v_mfma_f32_16x16x32_bf16 v[172:175], a[152:155], a[92:95], v[172:175]
  v_mul_f32 v128, v128, v144
  v_mul_f32 v129, v129, v145
  v_mfma_f32_16x16x32_bf16 v[172:175], a[148:151], a[76:79], v[172:175]
  v_mul_f32 v130, v130, v146
  v_mul_f32 v131, v131, v147
  s_waitcnt lgkmcnt(6)
  v_mfma_f32_16x16x32_bf16 v[188:191], a[128:131], a[76:79], v[188:191]
  ds_read_b64_tr_b16 a[148:149], v21 offset:21664
  v_cvt_pk_bf16_f32 v112, v96, v97
  v_cvt_pk_bf16_f32 v113, v98, v99
  v_mfma_f32_16x16x32_bf16 v[188:191], a[132:135], a[92:95], v[188:191]
  ds_read_b64_tr_b16 a[150:151], v21 offset:25248
  v_cvt_pk_bf16_f32 v114, v128, v129
  v_cvt_pk_bf16_f32 v115, v130, v131
  v_mfma_f32_16x16x32_bf16 v[184:187], a[132:135], a[88:91], v[184:187]
  buffer_store_dwordx4 v[112:115], v16, s[44:47], s48 offen offset:1024 sc1
  v_mul_f32 v100, v100, v116
  v_mfma_f32_16x16x32_bf16 v[184:187], a[128:131], a[72:75], v[184:187]
  v_mul_f32 v101, v101, v117
  v_mul_f32 v102, v102, v118
  v_mfma_f32_16x16x32_bf16 v[180:183], a[128:131], a[68:71], v[180:183]
  ds_read_b64_tr_b16 a[152:153], v21 offset:28800
  v_mul_f32 v103, v103, v119
  v_mul_f32 v132, v132, v148
  v_mfma_f32_16x16x32_bf16 v[180:183], a[132:135], a[84:87], v[180:183]
  ds_read_b64_tr_b16 a[154:155], v21 offset:32384
  v_mul_f32 v133, v133, v149
  v_mul_f32 v134, v134, v150
  v_mfma_f32_16x16x32_bf16 v[176:179], a[132:135], a[80:83], v[176:179]
  v_mul_f32 v135, v135, v151
  v_cvt_pk_bf16_f32 v116, v100, v101
  v_mfma_f32_16x16x32_bf16 v[176:179], a[128:131], a[64:67], v[176:179]
  v_cvt_pk_bf16_f32 v117, v102, v103
  v_cvt_pk_bf16_f32 v118, v132, v133
  s_waitcnt lgkmcnt(6)
  v_mfma_f32_16x16x32_bf16 v[192:195], a[136:139], a[64:67], v[192:195]
  ds_read_b64_tr_b16 a[128:129], v21 offset:35968
  v_cvt_pk_bf16_f32 v119, v134, v135
  buffer_store_dwordx4 v[116:119], v5, s[44:47], s48 offen offset:1024 sc1
  v_mfma_f32_16x16x32_bf16 v[192:195], a[140:143], a[80:83], v[192:195]
  ds_read_b64_tr_b16 a[130:131], v21 offset:39552
  v_mul_f32 v104, v104, v120
  v_mul_f32 v105, v105, v121
  v_mfma_f32_16x16x32_bf16 v[196:199], a[140:143], a[84:87], v[196:199]
  v_mul_f32 v106, v106, v122
  v_mul_f32 v107, v107, v123
  v_mfma_f32_16x16x32_bf16 v[196:199], a[136:139], a[68:71], v[196:199]
  v_mul_f32 v136, v136, v152
  v_mul_f32 v137, v137, v153
  v_mfma_f32_16x16x32_bf16 v[200:203], a[136:139], a[72:75], v[200:203]
  ds_read_b64_tr_b16 a[132:133], v21 offset:43136
  v_mul_f32 v138, v138, v154
  v_mul_f32 v139, v139, v155
  v_mfma_f32_16x16x32_bf16 v[200:203], a[140:143], a[88:91], v[200:203]
  ds_read_b64_tr_b16 a[134:135], v21 offset:46720
  v_cvt_pk_bf16_f32 v120, v104, v105
  v_cvt_pk_bf16_f32 v121, v106, v107
  v_mfma_f32_16x16x32_bf16 v[204:207], a[140:143], a[92:95], v[204:207]
  v_cvt_pk_bf16_f32 v122, v136, v137
  v_cvt_pk_bf16_f32 v123, v138, v139
  v_mfma_f32_16x16x32_bf16 v[204:207], a[136:139], a[76:79], v[204:207]
  buffer_store_dwordx4 v[120:123], v6, s[44:47], s48 offen offset:1024 sc1
  v_mul_f32 v108, v108, v124
  s_waitcnt lgkmcnt(6)
  v_mfma_f32_16x16x32_bf16 v[220:223], a[144:147], a[76:79], v[220:223]
  ds_read_b64_tr_b16 a[136:137], v21 offset:50304
  v_mul_f32 v109, v109, v125
  v_mul_f32 v110, v110, v126
  v_mfma_f32_16x16x32_bf16 v[220:223], a[148:151], a[92:95], v[220:223]
  ds_read_b64_tr_b16 a[138:139], v21 offset:53888
  v_mul_f32 v111, v111, v127
  v_mul_f32 v140, v140, v156
  v_mfma_f32_16x16x32_bf16 v[216:219], a[148:151], a[88:91], v[216:219]
  v_mul_f32 v141, v141, v157
  v_mul_f32 v142, v142, v158
  v_mfma_f32_16x16x32_bf16 v[216:219], a[144:147], a[72:75], v[216:219]
  v_mul_f32 v143, v143, v159
  v_cvt_pk_bf16_f32 v124, v108, v109
  v_mfma_f32_16x16x32_bf16 v[212:215], a[144:147], a[68:71], v[212:215]
  ds_read_b64_tr_b16 a[140:141], v21 offset:28832
  v_cvt_pk_bf16_f32 v125, v110, v111
  v_cvt_pk_bf16_f32 v126, v140, v141
  v_mfma_f32_16x16x32_bf16 v[212:215], a[148:151], a[84:87], v[212:215]
  ds_read_b64_tr_b16 a[142:143], v21 offset:32416
  v_cvt_pk_bf16_f32 v127, v142, v143
  buffer_store_dwordx4 v[124:127], v7, s[44:47], s48 offen offset:1024 sc1
  v_mfma_f32_16x16x32_bf16 v[208:211], a[148:151], a[80:83], v[208:211]
  v_mfma_f32_16x16x32_bf16 v[208:211], a[144:147], a[64:67], v[208:211]
  s_waitcnt lgkmcnt(6)
  v_mfma_f32_16x16x32_bf16 v[160:163], a[152:155], a[96:99], v[160:163]
  ds_read_b64_tr_b16 a[144:145], v21 offset:36000
  v_mfma_f32_16x16x32_bf16 v[160:163], a[128:131], a[112:115], v[160:163]
  ds_read_b64_tr_b16 a[146:147], v21 offset:39584
  v_mfma_f32_16x16x32_bf16 v[164:167], a[128:131], a[116:119], v[164:167]
  v_mfma_f32_16x16x32_bf16 v[164:167], a[152:155], a[100:103], v[164:167]
  v_mfma_f32_16x16x32_bf16 v[168:171], a[152:155], a[104:107], v[168:171]
  ds_read_b64_tr_b16 a[148:149], v21 offset:43168
  v_mfma_f32_16x16x32_bf16 v[168:171], a[128:131], a[120:123], v[168:171]
  ds_read_b64_tr_b16 a[150:151], v21 offset:46752
  s_add_u32 m0, s53, 114688
  v_mfma_f32_16x16x32_bf16 v[172:175], a[128:131], a[124:127], v[172:175]
  buffer_load_dwordx4 v8, s[32:35], s52 offen offset:0 lds
  buffer_load_dwordx4 v9, s[32:35], s52 offen offset:1024 lds
  v_mfma_f32_16x16x32_bf16 v[172:175], a[152:155], a[108:111], v[172:175]
  s_waitcnt lgkmcnt(6)
  v_mfma_f32_16x16x32_bf16 v[188:191], a[132:135], a[108:111], v[188:191]
  ds_read_b64_tr_b16 a[152:153], v21 offset:50336
  v_mfma_f32_16x16x32_bf16 v[188:191], a[136:139], a[124:127], v[188:191]
  ds_read_b64_tr_b16 a[154:155], v21 offset:53920
  v_mfma_f32_16x16x32_bf16 v[184:187], a[136:139], a[120:123], v[184:187]
  buffer_load_dwordx4 v10, s[32:35], s52 offen offset:2048 lds
  buffer_load_dwordx4 v11, s[32:35], s52 offen offset:3072 lds
  s_add_u32 s52, s52, 196608
  v_mfma_f32_16x16x32_bf16 v[184:187], a[132:135], a[104:107], v[184:187]
  v_mfma_f32_16x16x32_bf16 v[180:183], a[132:135], a[100:103], v[180:183]
  v_mfma_f32_16x16x32_bf16 v[180:183], a[136:139], a[116:119], v[180:183]
  s_add_u32 m0, s53, 131072
  v_mfma_f32_16x16x32_bf16 v[176:179], a[136:139], a[112:115], v[176:179]
  buffer_load_dwordx4 v8, s[32:35], s52 offen offset:0 lds
  buffer_load_dwordx4 v9, s[32:35], s52 offen offset:1024 lds
  v_mfma_f32_16x16x32_bf16 v[176:179], a[132:135], a[96:99], v[176:179]
  s_waitcnt lgkmcnt(4)
  v_mfma_f32_16x16x32_bf16 v[192:195], a[140:143], a[96:99], v[192:195]
  v_mfma_f32_16x16x32_bf16 v[192:195], a[144:147], a[112:115], v[192:195]
  v_mfma_f32_16x16x32_bf16 v[196:199], a[144:147], a[116:119], v[196:199]
  buffer_load_dwordx4 v10, s[32:35], s52 offen offset:2048 lds
  buffer_load_dwordx4 v11, s[32:35], s52 offen offset:3072 lds
  s_add_u32 s52, s52, s57
  v_mfma_f32_16x16x32_bf16 v[196:199], a[140:143], a[100:103], v[196:199]
  v_mfma_f32_16x16x32_bf16 v[200:203], a[140:143], a[104:107], v[200:203]
  v_mfma_f32_16x16x32_bf16 v[200:203], a[144:147], a[120:123], v[200:203]
  s_add_u32 m0, s53, 147456
  v_mfma_f32_16x16x32_bf16 v[204:207], a[144:147], a[124:127], v[204:207]
  buffer_load_dwordx4 v8, s[32:35], s52 offen offset:0 lds
  buffer_load_dwordx4 v9, s[32:35], s52 offen offset:1024 lds
  v_mfma_f32_16x16x32_bf16 v[204:207], a[140:143], a[108:111], v[204:207]
  s_waitcnt lgkmcnt(0)
  v_mfma_f32_16x16x32_bf16 v[220:223], a[148:151], a[108:111], v[220:223]
  v_mfma_f32_16x16x32_bf16 v[220:223], a[152:155], a[124:127], v[220:223]
  v_mfma_f32_16x16x32_bf16 v[216:219], a[152:155], a[120:123], v[216:219]
  buffer_load_dwordx4 v10, s[32:35], s52 offen offset:2048 lds
  buffer_load_dwordx4 v11, s[32:35], s52 offen offset:3072 lds
  s_add_u32 s52, s52, 196608
  v_mfma_f32_16x16x32_bf16 v[216:219], a[148:151], a[104:107], v[216:219]
  v_mfma_f32_16x16x32_bf16 v[212:215], a[148:151], a[100:103], v[212:215]
  v_mfma_f32_16x16x32_bf16 v[212:215], a[152:155], a[116:119], v[212:215]
  v_mfma_f32_16x16x32_bf16 v[208:211], a[152:155], a[112:115], v[208:211]
  v_mfma_f32_16x16x32_bf16 v[208:211], a[148:151], a[96:99], v[208:211]
  s_and_b32 s54, s2, 7
  s_lshl_b32 s54, s54, 5
  s_lshr_b32 s55, s2, 3
  s_add_u32 s54, s54, s55
  s_mul_i32 s54, s54, 4224
  s_lshl_b32 s55, s13, 2
  s_add_u32 s54, s54, s55
  s_mov_b64 s[56:57], s[44:45]
  s_mov_b32 s58, 458752
  s_mov_b32 s59, 0x20000
  s_mov_b32 s65, s50
  v_mov_b32 v27, v5
  s_waitcnt vmcnt(12)
  s_mov_b64 exec, 1
  buffer_store_dword v1, v30, s[60:63], s54 offen offset:32 sc1
  s_mov_b64 exec, -1
  v_pk_mul_f32 v[160:161], v[160:161], v[176:177]
  v_pk_mul_f32 v[162:163], v[162:163], v[178:179]
  v_pk_mul_f32 v[192:193], v[192:193], v[208:209]
  v_pk_mul_f32 v[194:195], v[194:195], v[210:211]
  v_cvt_pk_bf16_f32 v176, v160, v161
  v_cvt_pk_bf16_f32 v177, v162, v163
  v_cvt_pk_bf16_f32 v178, v192, v193
  v_cvt_pk_bf16_f32 v179, v194, v195
  v_pk_mul_f32 v[164:165], v[164:165], v[180:181]
  v_pk_mul_f32 v[166:167], v[166:167], v[182:183]
  v_pk_mul_f32 v[196:197], v[196:197], v[212:213]
  v_pk_mul_f32 v[198:199], v[198:199], v[214:215]
  v_cvt_pk_bf16_f32 v180, v164, v165
  v_cvt_pk_bf16_f32 v181, v166, v167
  v_cvt_pk_bf16_f32 v182, v196, v197
  v_cvt_pk_bf16_f32 v183, v198, v199
  v_pk_mul_f32 v[168:169], v[168:169], v[184:185]
  v_pk_mul_f32 v[170:171], v[170:171], v[186:187]
  v_pk_mul_f32 v[200:201], v[200:201], v[216:217]
  v_pk_mul_f32 v[202:203], v[202:203], v[218:219]
  v_cvt_pk_bf16_f32 v184, v168, v169
  v_cvt_pk_bf16_f32 v185, v170, v171
  v_cvt_pk_bf16_f32 v186, v200, v201
  v_cvt_pk_bf16_f32 v187, v202, v203
  v_pk_mul_f32 v[172:173], v[172:173], v[188:189]
  v_pk_mul_f32 v[174:175], v[174:175], v[190:191]
  v_pk_mul_f32 v[204:205], v[204:205], v[220:221]
  v_pk_mul_f32 v[206:207], v[206:207], v[222:223]
  v_cvt_pk_bf16_f32 v188, v172, v173
  v_cvt_pk_bf16_f32 v189, v174, v175
  v_cvt_pk_bf16_f32 v190, v204, v205
  v_cvt_pk_bf16_f32 v191, v206, v207
  s_mov_b64 s[4:5], s[72:73]
  s_mov_b64 s[6:7], s[94:95]
  s_bfe_u32 s12, s2, 0x10001
  s_lshl_b32 s12, s12, 3
  s_bfe_u32 s11, s2, 0x30003
  s_add_u32 s12, s12, s11
  s_and_b32 s10, s2, 1
  s_lshl_b32 s10, s10, 2
  s_lshr_b32 s11, s2, 6
  s_add_u32 s10, s10, s11
  s_bfe_u32 s11, s2, 0x10002
  v_lshlrev_b32 v12, 4, v0
  v_add_u32 v13, 114688, v12
  s_lshl_b32 s14, s12, 2
  s_add_u32 s14, s14, s13
  s_mul_i32 s15, s14, 229376
  s_add_u32 s15, s15, 23068672
  s_mul_i32 s29, s11, 57344
  s_mul_i32 s28, s11, 3670016
  s_lshl_b32 s16, s10, 8
  s_add_u32 s28, s28, s16
  s_lshl_b32 s16, s13, 15
  s_add_u32 s28, s28, s16
  s_lshl_b32 s30, s13, 12
  s_mov_b32 s22, 7340032
  s_mov_b32 s23, 0x20000
  s_mov_b32 s26, 229376
  s_mov_b32 s27, 0x20000
  s_waitcnt lgkmcnt(0)
  s_mov_b32 s20, s4
  s_and_b32 s21, s5, 0xffff
  s_add_u32 s24, s8, s15
  s_addc_u32 s25, s9, 0
  s_and_b32 s25, s25, 0xffff
  s_lshr_b32 s41, s13, 1
  s_lshl_b32 s41, s41, 16
  s_sub_u32 s41, s28, s41
  s_mov_b32 s66, 3831891456
  s_cmp_lt_u32 s13, 2
  s_cselect_b32 s66, 3559228800, s66
  s_mov_b32 s67, 34866
  s_cselect_b32 s67, 30738, s67
  s_mov_b32 s68, 348555136
  s_cmp_lt_u32 s13, 2
  s_cselect_b32 s68, 4102440704, s68
  s_mov_b32 s69, 42091
  s_cselect_b32 s69, 37962, s69
  s_mov_b32 s70, 1158105344
  s_cmp_lt_u32 s13, 2
  s_cselect_b32 s70, 619120768, s70
  s_mov_b32 s71, 49315
  s_cselect_b32 s71, 45187, s71
  s_mov_b32 s72, 1701317248
  s_cmp_lt_u32 s13, 2
  s_cselect_b32 s72, 1430768000, s72
  s_mov_b32 s73, 56539
  s_cselect_b32 s73, 52411, s73
  s_mov_b32 s28, s52
  s_add_u32 s30, s30, 98304
  s_xor_b32 s42, s30, 0x10000
  v_lshrrev_b32 v2, 2, v0
  v_and_b32 v3, 3, v0
  v_lshlrev_b32 v3, 3, v3
  v_lshl_add_u32 v3, v2, 8, v3
  v_add_u32 v3, 98304, v3
  v_and_b32 v4, 7, v2
  s_lshl_b32 s16, s11, 2
  v_xor_b32 v4, s16, v4
  v_xor_b32 v5, 0, v4
  v_lshl_add_u32 v16, v5, 5, v3
  v_xor_b32 v5, 1, v4
  v_lshl_add_u32 v17, v5, 5, v3
  v_xor_b32 v5, 2, v4
  v_lshl_add_u32 v18, v5, 5, v3
  v_xor_b32 v5, 3, v4
  v_lshl_add_u32 v19, v5, 5, v3
  v_xor_b32 v5, 4, v4
  v_lshl_add_u32 v20, v5, 5, v3
  v_xor_b32 v5, 5, v4
  v_lshl_add_u32 v21, v5, 5, v3
  v_xor_b32 v5, 6, v4
  v_lshl_add_u32 v22, v5, 5, v3
  v_xor_b32 v5, 7, v4
  v_lshl_add_u32 v23, v5, 5, v3
  v_mov_b64 v[64:65], 0
  v_mov_b64 v[66:67], 0
  v_mov_b64 v[68:69], 0
  v_mov_b64 v[70:71], 0
  v_mov_b64 v[72:73], 0
  v_mov_b64 v[74:75], 0
  v_mov_b64 v[76:77], 0
  v_mov_b64 v[78:79], 0
  v_mov_b64 v[80:81], 0
  v_mov_b64 v[82:83], 0
  v_mov_b64 v[84:85], 0
  v_mov_b64 v[86:87], 0
  v_mov_b64 v[88:89], 0
  v_mov_b64 v[90:91], 0
  v_mov_b64 v[92:93], 0
  v_mov_b64 v[94:95], 0
  v_mov_b64 v[96:97], 0
  v_mov_b64 v[98:99], 0
  v_mov_b64 v[100:101], 0
  v_mov_b64 v[102:103], 0
  v_mov_b64 v[104:105], 0
  v_mov_b64 v[106:107], 0
  v_mov_b64 v[108:109], 0
  v_mov_b64 v[110:111], 0
  v_mov_b64 v[112:113], 0
  v_mov_b64 v[114:115], 0
  v_mov_b64 v[116:117], 0
  v_mov_b64 v[118:119], 0
  v_mov_b64 v[120:121], 0
  v_mov_b64 v[122:123], 0
  v_mov_b64 v[124:125], 0
  v_mov_b64 v[126:127], 0
  s_add_u32 s32, s8, 18874368
  s_addc_u32 s33, s9, 0
  s_and_b32 s33, s33, 0xffff
  s_mov_b32 s34, 4194304
  s_mov_b32 s35, 0x20000
  s_mov_b32 s36, s6
  s_and_b32 s37, s7, 0xffff
  s_mov_b32 s38, 4194304
  s_mov_b32 s39, 0x20000
  s_add_u32 s44, s8, 39845888
  s_addc_u32 s45, s9, 0
  s_and_b32 s45, s45, 0xffff
  s_mov_b32 s46, 4194304
  s_mov_b32 s47, 0x20000
  v_bfe_u32 v2, v0, 2, 1
  v_lshlrev_b32 v2, 21, v2
  v_and_b32 v3, 3, v0
  v_bfe_u32 v4, v0, 3, 1
  v_lshl_add_u32 v3, v4, 2, v3
  v_lshl_add_u32 v2, v3, 11, v2
  v_bfe_u32 v3, v0, 4, 1
  v_lshl_add_u32 v2, v3, 5, v2
  v_bfe_u32 v3, v0, 5, 1
  v_lshl_add_u32 v14, v3, 4, v2
  v_add_u32 v15, 16384, v14
  s_lshl_b32 s40, s14, 15
  s_lshl_b32 s15, s10, 8
  s_add_u32 s40, s40, s15
  s_lshl_b32 s15, s11, 7
  s_add_u32 s40, s40, s15
  s_lshl_b32 s48, s2, 2
  s_add_u32 s48, s48, s13
  s_lshl_b32 s48, s48, 12
  s_xor_b32 s49, s48, 65536
  s_mov_b32 s50, -2
  v_bfe_u32 v3, v0, 3, 1
  v_mul_u32_u24 v3, 8128, v3
  v_sub_u32 v28, v14, v3
  v_sub_u32 v29, v15, v3
  s_add_u32 s51, s40, 8192
  s_mov_b32 s31, 0
  s_and_b32 s54, s2, 7
  s_lshl_b32 s54, s54, 5
  s_lshr_b32 s55, s2, 3
  s_add_u32 s54, s54, s55
  s_xor_b32 s55, s54, 128
  s_mul_i32 s54, s54, 4224
  v_bfe_u32 v2, v0, 2, 2
  v_lshlrev_b32 v2, 5, v2
  v_and_or_b32 v2, v0, 3, v2
  s_lshl_b32 s16, s11, 7
  s_lshr_b32 s17, s12, 1
  s_lshl_b32 s17, s17, 2
  s_add_u32 s16, s16, s17
  v_add_u32 v2, s16, v2
  s_lshl_b32 s16, s12, 4
  v_and_b32 v3, 15, v0
  v_add_u32 v3, s16, v3
  v_cmp_gt_u32 vcc, 16, v0
  s_nop 1
  v_cndmask_b32 v2, v3, v2, vcc
  v_mov_b32 v3, s55
  v_cmp_gt_u32 vcc, 32, v0
  s_nop 1
  v_cndmask_b32 v2, v3, v2, vcc
  s_nop 0
  v_mul_u32_u24 v2, 4224, v2
  v_mov_b32 v1, 1
  v_mov_b32 v30, 0
  s_mov_b32 s64, 0
  v_add_u32 v25, 16, v2
  v_mov_b32_dpp v24, v2 quad_perm:[0,1,2,3] row_mask:0xf bank_mask:0xf
  v_mov_b32 v3, v2
  s_nop 1
  v_permlane16_swap_b32 v24, v3
  v_bfe_u32 v3, v0, 4, 1
  s_and_b32 s16, s12, 1
  s_lshl_b32 s16, s16, 1
  v_add_u32 v3, s16, v3
  v_lshl_add_u32 v24, v3, 2, v24
  s_nop 0
  v_readlane_b32 s16, v24, 0
  v_cmp_gt_u32 vcc, 32, v0
  s_nop 0
  v_mov_b32 v3, s16
  v_cndmask_b32 v2, v3, v24, vcc
  v_add_u32 v2, 16, v2
  s_cmp_eq_u32 s13, 0
  s_cselect_b32 s16, 1, 0
  v_cmp_gt_u32 vcc, s16, v0
  v_mov_b32 v31, 0x7fff0000
  s_nop 0
  v_cndmask_b32 v30, v31, v30, vcc
  s_waitcnt vmcnt(1)
  s_barrier
  ds_read_b64_tr_b16 v[32:33], v16 offset:16384
  ds_read_b64_tr_b16 v[34:35], v16 offset:20480
  ds_read_b64_tr_b16 v[36:37], v17 offset:16384
  ds_read_b64_tr_b16 v[38:39], v17 offset:20480
  ds_read_b64_tr_b16 v[40:41], v18 offset:16384
  ds_read_b64_tr_b16 v[42:43], v18 offset:20480
  ds_read_b64_tr_b16 v[44:45], v19 offset:16384
  ds_read_b64_tr_b16 v[46:47], v19 offset:20480
  ds_read_b64_tr_b16 v[48:49], v20 offset:16384
  ds_read_b64_tr_b16 v[50:51], v20 offset:20480
  ds_read_b64_tr_b16 v[52:53], v21 offset:16384
  ds_read_b64_tr_b16 v[54:55], v21 offset:20480
  s_cmp_lg_u32 s13, 0
  s_cbranch_scc1 L_g2_go
  s_sleep 4
L_g2_wait:
  s_sleep 2
  buffer_load_dword v3, v2, s[60:63], 0 offen offset:16 sc1
  s_add_u32 s64, s64, 1
  s_waitcnt vmcnt(0)
  v_cmp_ne_u32 vcc, 1, v3
  s_cmp_lt_u32 s64, 0x40000
  s_cselect_b64 s[74:75], vcc, 0
  s_cmp_lg_u64 s[74:75], 0
  s_cbranch_scc1 L_g2_wait
L_g2_go:
  s_waitcnt vmcnt(0)
  s_barrier
  buffer_load_dwordx4 a[0:3], v12, s[24:27], s29 offen offset:0 sc1
  buffer_load_dwordx4 a[4:7], v13, s[24:27], s29 offen offset:0 sc1
  buffer_load_dwordx4 a[8:11], v12, s[24:27], s29 offen offset:1024 sc1
  buffer_load_dwordx4 a[12:15], v13, s[24:27], s29 offen offset:1024 sc1
  buffer_load_dwordx4 a[16:19], v12, s[24:27], s29 offen offset:2048 sc1
  buffer_load_dwordx4 a[20:23], v13, s[24:27], s29 offen offset:2048 sc1
  buffer_load_dwordx4 a[24:27], v12, s[24:27], s29 offen offset:3072 sc1
  buffer_load_dwordx4 a[28:31], v13, s[24:27], s29 offen offset:3072 sc1
  s_add_u32 s29, s29, 4096
  buffer_load_dwordx4 a[32:35], v12, s[24:27], s29 offen offset:0 sc1
  buffer_load_dwordx4 a[36:39], v13, s[24:27], s29 offen offset:0 sc1
  buffer_load_dwordx4 a[40:43], v12, s[24:27], s29 offen offset:1024 sc1
  buffer_load_dwordx4 a[44:47], v13, s[24:27], s29 offen offset:1024 sc1
  s_add_u32 m0, s30, 0
  s_nop 0
  buffer_load_dwordx4 v8, s[20:23], s28 offen offset:0 lds
  buffer_load_dwordx4 v9, s[20:23], s28 offen offset:1024 lds
  buffer_load_dwordx4 v10, s[20:23], s28 offen offset:2048 lds
  buffer_load_dwordx4 v11, s[20:23], s28 offen offset:3072 lds
  buffer_store_dwordx4 v[176:179], v12, s[56:59], s65 offen offset:2048 sc1
  buffer_store_dwordx4 v[180:183], v27, s[56:59], s65 offen offset:2048 sc1
  buffer_store_dwordx4 v[184:187], v6, s[56:59], s65 offen offset:2048 sc1
  buffer_store_dwordx4 v[188:191], v7, s[56:59], s65 offen offset:2048 sc1
  s_lshr_b64 s[66:67], s[66:67], 7
  s_and_b32 s28, s66, 127
  s_lshl_b32 s28, s28, 16
  s_add_u32 s28, s28, s41
  s_mov_b32 s43, 0
.p2align 6
L_g2_loop:
  s_waitcnt vmcnt(18)
  s_waitcnt lgkmcnt(8)
  v_xor_b32 v22, s43, v22
  v_mfma_f32_16x16x32_bf16 v[64:67], v[32:35], a[0:3], v[64:67]
  s_add_u32 m0, s42, 16384
  ds_read_b64_tr_b16 v[56:57], v22 offset:16384
  v_mfma_f32_16x16x32_bf16 v[68:71], v[32:35], a[4:7], v[68:71]
  ds_read_b64_tr_b16 v[58:59], v22 offset:20480
  buffer_load_dwordx4 v8, s[20:23], s28 offen offset:0 lds
  v_xor_b32 v23, s43, v23
  v_mfma_f32_16x16x32_bf16 v[76:79], v[36:39], a[4:7], v[76:79]
  s_cmp_eq_u32 s31, 3
  s_cselect_b32 s62, 1081344, 0
  ds_read_b64_tr_b16 v[60:61], v23 offset:16384
  v_mfma_f32_16x16x32_bf16 v[72:75], v[36:39], a[0:3], v[72:75]
  ds_read_b64_tr_b16 v[62:63], v23 offset:20480
  buffer_load_dword v26, v25, s[60:63], 0 offen sc1
  s_waitcnt lgkmcnt(8)
  v_mfma_f32_16x16x32_bf16 v[80:83], v[40:43], a[0:3], v[80:83]
  ds_read_b64_tr_b16 v[32:33], v16 offset:24576
  v_mfma_f32_16x16x32_bf16 v[84:87], v[40:43], a[4:7], v[84:87]
  ds_read_b64_tr_b16 v[34:35], v16 offset:28672
  buffer_load_dwordx4 a[48:51], v12, s[24:27], s29 offen offset:2048 sc1
  v_mfma_f32_16x16x32_bf16 v[92:95], v[44:47], a[4:7], v[92:95]
  ds_read_b64_tr_b16 v[36:37], v17 offset:24576
  s_lshr_b64 s[68:69], s[68:69], 7
  v_mfma_f32_16x16x32_bf16 v[88:91], v[44:47], a[0:3], v[88:91]
  ds_read_b64_tr_b16 v[38:39], v17 offset:28672
  s_waitcnt lgkmcnt(8)
  v_mfma_f32_16x16x32_bf16 v[96:99], v[48:51], a[0:3], v[96:99]
  ds_read_b64_tr_b16 v[40:41], v18 offset:24576
  v_mfma_f32_16x16x32_bf16 v[100:103], v[48:51], a[4:7], v[100:103]
  ds_read_b64_tr_b16 v[42:43], v18 offset:28672
  buffer_load_dwordx4 v9, s[20:23], s28 offen offset:1024 lds
  v_mfma_f32_16x16x32_bf16 v[108:111], v[52:55], a[4:7], v[108:111]
  ds_read_b64_tr_b16 v[44:45], v19 offset:24576
  v_mfma_f32_16x16x32_bf16 v[104:107], v[52:55], a[0:3], v[104:107]
  ds_read_b64_tr_b16 v[46:47], v19 offset:28672
  s_waitcnt lgkmcnt(8)
  v_mfma_f32_16x16x32_bf16 v[112:115], v[56:59], a[0:3], v[112:115]
  ds_read_b64_tr_b16 v[48:49], v20 offset:24576
  v_mfma_f32_16x16x32_bf16 v[116:119], v[56:59], a[4:7], v[116:119]
  ds_read_b64_tr_b16 v[50:51], v20 offset:28672
  buffer_load_dwordx4 a[52:55], v13, s[24:27], s29 offen offset:2048 sc1
  v_mfma_f32_16x16x32_bf16 v[124:127], v[60:63], a[4:7], v[124:127]
  ds_read_b64_tr_b16 v[52:53], v21 offset:24576
  v_mfma_f32_16x16x32_bf16 v[120:123], v[60:63], a[0:3], v[120:123]
  ds_read_b64_tr_b16 v[54:55], v21 offset:28672
  s_waitcnt vmcnt(21)
  s_waitcnt lgkmcnt(8)
  v_mfma_f32_16x16x32_bf16 v[64:67], v[32:35], a[8:11], v[64:67]
  ds_read_b64_tr_b16 v[56:57], v22 offset:24576
  v_mfma_f32_16x16x32_bf16 v[68:71], v[32:35], a[12:15], v[68:71]
  ds_read_b64_tr_b16 v[58:59], v22 offset:28672
  buffer_load_dwordx4 v10, s[20:23], s28 offen offset:2048 lds
  v_mfma_f32_16x16x32_bf16 v[76:79], v[36:39], a[12:15], v[76:79]
  ds_read_b64_tr_b16 v[60:61], v23 offset:24576
  v_mfma_f32_16x16x32_bf16 v[72:75], v[36:39], a[8:11], v[72:75]
  ds_read_b64_tr_b16 v[62:63], v23 offset:28672
  s_waitcnt lgkmcnt(8)
  s_waitcnt vmcnt(24)
  s_barrier
  v_mfma_f32_16x16x32_bf16 v[80:83], v[40:43], a[8:11], v[80:83]
  ds_read_b64_tr_b16 v[32:33], v16 offset:32768
  v_mfma_f32_16x16x32_bf16 v[84:87], v[40:43], a[12:15], v[84:87]
  ds_read_b64_tr_b16 v[34:35], v16 offset:36864
  buffer_load_dwordx4 a[56:59], v12, s[24:27], s29 offen offset:3072 sc1
  v_mfma_f32_16x16x32_bf16 v[92:95], v[44:47], a[12:15], v[92:95]
  ds_read_b64_tr_b16 v[36:37], v17 offset:32768
  v_mfma_f32_16x16x32_bf16 v[88:91], v[44:47], a[8:11], v[88:91]
  ds_read_b64_tr_b16 v[38:39], v17 offset:36864
  s_waitcnt lgkmcnt(8)
  v_mfma_f32_16x16x32_bf16 v[96:99], v[48:51], a[8:11], v[96:99]
  ds_read_b64_tr_b16 v[40:41], v18 offset:32768
  v_mfma_f32_16x16x32_bf16 v[100:103], v[48:51], a[12:15], v[100:103]
  ds_read_b64_tr_b16 v[42:43], v18 offset:36864
  buffer_load_dwordx4 v11, s[20:23], s28 offen offset:3072 lds
  v_mfma_f32_16x16x32_bf16 v[108:111], v[52:55], a[12:15], v[108:111]
  ds_read_b64_tr_b16 v[44:45], v19 offset:32768
  s_and_b32 s28, s68, 127
  v_mfma_f32_16x16x32_bf16 v[104:107], v[52:55], a[8:11], v[104:107]
  ds_read_b64_tr_b16 v[46:47], v19 offset:36864
  s_lshl_b32 s28, s28, 16
  s_waitcnt lgkmcnt(8)
  v_mfma_f32_16x16x32_bf16 v[112:115], v[56:59], a[8:11], v[112:115]
  ds_read_b64_tr_b16 v[48:49], v20 offset:32768
  s_add_u32 s28, s28, s41
  v_mfma_f32_16x16x32_bf16 v[116:119], v[56:59], a[12:15], v[116:119]
  ds_read_b64_tr_b16 v[50:51], v20 offset:36864
  buffer_load_dwordx4 a[60:63], v13, s[24:27], s29 offen offset:3072 sc1
  s_add_u32 s29, s29, 4096
  v_mfma_f32_16x16x32_bf16 v[124:127], v[60:63], a[12:15], v[124:127]
  ds_read_b64_tr_b16 v[52:53], v21 offset:32768
  v_mfma_f32_16x16x32_bf16 v[120:123], v[60:63], a[8:11], v[120:123]
  ds_read_b64_tr_b16 v[54:55], v21 offset:36864
  s_waitcnt vmcnt(22)
  s_waitcnt lgkmcnt(8)
  v_mfma_f32_16x16x32_bf16 v[64:67], v[32:35], a[16:19], v[64:67]
  s_add_u32 m0, s42, 32768
  ds_read_b64_tr_b16 v[56:57], v22 offset:32768
  v_mfma_f32_16x16x32_bf16 v[68:71], v[32:35], a[20:23], v[68:71]
  ds_read_b64_tr_b16 v[58:59], v22 offset:36864
  buffer_load_dwordx4 v8, s[20:23], s28 offen offset:0 lds
  v_mfma_f32_16x16x32_bf16 v[76:79], v[36:39], a[20:23], v[76:79]
  ds_read_b64_tr_b16 v[60:61], v23 offset:32768
  v_mfma_f32_16x16x32_bf16 v[72:75], v[36:39], a[16:19], v[72:75]
  ds_read_b64_tr_b16 v[62:63], v23 offset:36864
  s_waitcnt lgkmcnt(8)
  v_mfma_f32_16x16x32_bf16 v[80:83], v[40:43], a[16:19], v[80:83]
  ds_read_b64_tr_b16 v[32:33], v16 offset:40960
  v_mfma_f32_16x16x32_bf16 v[84:87], v[40:43], a[20:23], v[84:87]
  ds_read_b64_tr_b16 v[34:35], v16 offset:45056
  buffer_load_dwordx4 a[0:3], v12, s[24:27], s29 offen offset:0 sc1
  v_mfma_f32_16x16x32_bf16 v[92:95], v[44:47], a[20:23], v[92:95]
  ds_read_b64_tr_b16 v[36:37], v17 offset:40960
  s_lshr_b64 s[70:71], s[70:71], 7
  v_mfma_f32_16x16x32_bf16 v[88:91], v[44:47], a[16:19], v[88:91]
  ds_read_b64_tr_b16 v[38:39], v17 offset:45056
  s_waitcnt lgkmcnt(8)
  v_mfma_f32_16x16x32_bf16 v[96:99], v[48:51], a[16:19], v[96:99]
  ds_read_b64_tr_b16 v[40:41], v18 offset:40960
  v_mfma_f32_16x16x32_bf16 v[100:103], v[48:51], a[20:23], v[100:103]
  ds_read_b64_tr_b16 v[42:43], v18 offset:45056
  buffer_load_dwordx4 v9, s[20:23], s28 offen offset:1024 lds
  v_mfma_f32_16x16x32_bf16 v[108:111], v[52:55], a[20:23], v[108:111]
  ds_read_b64_tr_b16 v[44:45], v19 offset:40960
  v_mfma_f32_16x16x32_bf16 v[104:107], v[52:55], a[16:19], v[104:107]
  ds_read_b64_tr_b16 v[46:47], v19 offset:45056
  s_waitcnt lgkmcnt(8)
  v_mfma_f32_16x16x32_bf16 v[112:115], v[56:59], a[16:19], v[112:115]
  ds_read_b64_tr_b16 v[48:49], v20 offset:40960
  v_mfma_f32_16x16x32_bf16 v[116:119], v[56:59], a[20:23], v[116:119]
  ds_read_b64_tr_b16 v[50:51], v20 offset:45056
  buffer_load_dwordx4 a[4:7], v13, s[24:27], s29 offen offset:0 sc1
  v_mfma_f32_16x16x32_bf16 v[124:127], v[60:63], a[20:23], v[124:127]
  ds_read_b64_tr_b16 v[52:53], v21 offset:40960
  v_mfma_f32_16x16x32_bf16 v[120:123], v[60:63], a[16:19], v[120:123]
  ds_read_b64_tr_b16 v[54:55], v21 offset:45056
  s_waitcnt vmcnt(22)
  s_waitcnt lgkmcnt(8)
  v_mfma_f32_16x16x32_bf16 v[64:67], v[32:35], a[24:27], v[64:67]
  ds_read_b64_tr_b16 v[56:57], v22 offset:40960
  v_mfma_f32_16x16x32_bf16 v[68:71], v[32:35], a[28:31], v[68:71]
  ds_read_b64_tr_b16 v[58:59], v22 offset:45056
  buffer_load_dwordx4 v10, s[20:23], s28 offen offset:2048 lds
  v_mfma_f32_16x16x32_bf16 v[76:79], v[36:39], a[28:31], v[76:79]
  ds_read_b64_tr_b16 v[60:61], v23 offset:40960
  v_mfma_f32_16x16x32_bf16 v[72:75], v[36:39], a[24:27], v[72:75]
  ds_read_b64_tr_b16 v[62:63], v23 offset:45056
  s_waitcnt lgkmcnt(8)
  s_waitcnt vmcnt(24)
  s_barrier
  v_mfma_f32_16x16x32_bf16 v[80:83], v[40:43], a[24:27], v[80:83]
  ds_read_b64_tr_b16 v[32:33], v16 offset:49152
  v_mfma_f32_16x16x32_bf16 v[84:87], v[40:43], a[28:31], v[84:87]
  ds_read_b64_tr_b16 v[34:35], v16 offset:53248
  buffer_load_dwordx4 a[8:11], v12, s[24:27], s29 offen offset:1024 sc1
  v_mfma_f32_16x16x32_bf16 v[92:95], v[44:47], a[28:31], v[92:95]
  ds_read_b64_tr_b16 v[36:37], v17 offset:49152
  v_mfma_f32_16x16x32_bf16 v[88:91], v[44:47], a[24:27], v[88:91]
  ds_read_b64_tr_b16 v[38:39], v17 offset:53248
  s_waitcnt lgkmcnt(8)
  v_mfma_f32_16x16x32_bf16 v[96:99], v[48:51], a[24:27], v[96:99]
  ds_read_b64_tr_b16 v[40:41], v18 offset:49152
  v_mfma_f32_16x16x32_bf16 v[100:103], v[48:51], a[28:31], v[100:103]
  ds_read_b64_tr_b16 v[42:43], v18 offset:53248
  buffer_load_dwordx4 v11, s[20:23], s28 offen offset:3072 lds
  v_mfma_f32_16x16x32_bf16 v[108:111], v[52:55], a[28:31], v[108:111]
  ds_read_b64_tr_b16 v[44:45], v19 offset:49152
  s_and_b32 s28, s70, 127
  v_mfma_f32_16x16x32_bf16 v[104:107], v[52:55], a[24:27], v[104:107]
  ds_read_b64_tr_b16 v[46:47], v19 offset:53248
  s_lshl_b32 s28, s28, 16
  s_waitcnt lgkmcnt(8)
  v_mfma_f32_16x16x32_bf16 v[112:115], v[56:59], a[24:27], v[112:115]
  ds_read_b64_tr_b16 v[48:49], v20 offset:49152
  s_add_u32 s28, s28, s41
  v_mfma_f32_16x16x32_bf16 v[116:119], v[56:59], a[28:31], v[116:119]
  ds_read_b64_tr_b16 v[50:51], v20 offset:53248
  buffer_load_dwordx4 a[12:15], v13, s[24:27], s29 offen offset:1024 sc1
  v_mfma_f32_16x16x32_bf16 v[124:127], v[60:63], a[28:31], v[124:127]
  ds_read_b64_tr_b16 v[52:53], v21 offset:49152
  v_mfma_f32_16x16x32_bf16 v[120:123], v[60:63], a[24:27], v[120:123]
  ds_read_b64_tr_b16 v[54:55], v21 offset:53248
  s_waitcnt vmcnt(22)
  s_waitcnt lgkmcnt(8)
  v_mfma_f32_16x16x32_bf16 v[64:67], v[32:35], a[32:35], v[64:67]
  s_add_u32 m0, s42, 49152
  ds_read_b64_tr_b16 v[56:57], v22 offset:49152
  v_mfma_f32_16x16x32_bf16 v[68:71], v[32:35], a[36:39], v[68:71]
  ds_read_b64_tr_b16 v[58:59], v22 offset:53248
  buffer_load_dwordx4 v8, s[20:23], s28 offen offset:0 lds
  v_mfma_f32_16x16x32_bf16 v[76:79], v[36:39], a[36:39], v[76:79]
  ds_read_b64_tr_b16 v[60:61], v23 offset:49152
  v_mfma_f32_16x16x32_bf16 v[72:75], v[36:39], a[32:35], v[72:75]
  ds_read_b64_tr_b16 v[62:63], v23 offset:53248
  s_waitcnt lgkmcnt(8)
  v_mfma_f32_16x16x32_bf16 v[80:83], v[40:43], a[32:35], v[80:83]
  ds_read_b64_tr_b16 v[32:33], v16 offset:57344
  v_mfma_f32_16x16x32_bf16 v[84:87], v[40:43], a[36:39], v[84:87]
  ds_read_b64_tr_b16 v[34:35], v16 offset:61440
  buffer_load_dwordx4 a[16:19], v12, s[24:27], s29 offen offset:2048 sc1
  v_mfma_f32_16x16x32_bf16 v[92:95], v[44:47], a[36:39], v[92:95]
  ds_read_b64_tr_b16 v[36:37], v17 offset:57344
  s_lshr_b64 s[72:73], s[72:73], 7
  v_mfma_f32_16x16x32_bf16 v[88:91], v[44:47], a[32:35], v[88:91]
  ds_read_b64_tr_b16 v[38:39], v17 offset:61440
  s_waitcnt lgkmcnt(8)
  v_mfma_f32_16x16x32_bf16 v[96:99], v[48:51], a[32:35], v[96:99]
  ds_read_b64_tr_b16 v[40:41], v18 offset:57344
  v_mfma_f32_16x16x32_bf16 v[100:103], v[48:51], a[36:39], v[100:103]
  ds_read_b64_tr_b16 v[42:43], v18 offset:61440
  buffer_load_dwordx4 v9, s[20:23], s28 offen offset:1024 lds
  v_mfma_f32_16x16x32_bf16 v[108:111], v[52:55], a[36:39], v[108:111]
  ds_read_b64_tr_b16 v[44:45], v19 offset:57344
  v_mfma_f32_16x16x32_bf16 v[104:107], v[52:55], a[32:35], v[104:107]
  ds_read_b64_tr_b16 v[46:47], v19 offset:61440
  s_waitcnt lgkmcnt(8)
  v_mfma_f32_16x16x32_bf16 v[112:115], v[56:59], a[32:35], v[112:115]
  ds_read_b64_tr_b16 v[48:49], v20 offset:57344
  v_mfma_f32_16x16x32_bf16 v[116:119], v[56:59], a[36:39], v[116:119]
  ds_read_b64_tr_b16 v[50:51], v20 offset:61440
  buffer_load_dwordx4 a[20:23], v13, s[24:27], s29 offen offset:2048 sc1
  v_mfma_f32_16x16x32_bf16 v[124:127], v[60:63], a[36:39], v[124:127]
  ds_read_b64_tr_b16 v[52:53], v21 offset:57344
  v_mfma_f32_16x16x32_bf16 v[120:123], v[60:63], a[32:35], v[120:123]
  ds_read_b64_tr_b16 v[54:55], v21 offset:61440
  s_waitcnt vmcnt(21)
  s_waitcnt lgkmcnt(8)
  v_mfma_f32_16x16x32_bf16 v[64:67], v[32:35], a[40:43], v[64:67]
  ds_read_b64_tr_b16 v[56:57], v22 offset:57344
  v_mfma_f32_16x16x32_bf16 v[68:71], v[32:35], a[44:47], v[68:71]
  ds_read_b64_tr_b16 v[58:59], v22 offset:61440
  buffer_load_dwordx4 v10, s[20:23], s28 offen offset:2048 lds
  v_mfma_f32_16x16x32_bf16 v[76:79], v[36:39], a[44:47], v[76:79]
  ds_read_b64_tr_b16 v[60:61], v23 offset:57344
  v_mfma_f32_16x16x32_bf16 v[72:75], v[36:39], a[40:43], v[72:75]
  ds_read_b64_tr_b16 v[62:63], v23 offset:61440
  s_waitcnt lgkmcnt(8)
  s_waitcnt vmcnt(23)
  s_barrier
  v_mfma_f32_16x16x32_bf16 v[80:83], v[40:43], a[40:43], v[80:83]
  ds_read_b64_tr_b16 v[32:33], v16 offset:0
  v_mfma_f32_16x16x32_bf16 v[84:87], v[40:43], a[44:47], v[84:87]
  ds_read_b64_tr_b16 v[34:35], v16 offset:4096
  buffer_load_dwordx4 a[24:27], v12, s[24:27], s29 offen offset:3072 sc1
  v_mfma_f32_16x16x32_bf16 v[92:95], v[44:47], a[44:47], v[92:95]
  ds_read_b64_tr_b16 v[36:37], v17 offset:0
  v_mfma_f32_16x16x32_bf16 v[88:91], v[44:47], a[40:43], v[88:91]
  ds_read_b64_tr_b16 v[38:39], v17 offset:4096
  s_waitcnt lgkmcnt(8)
  v_mfma_f32_16x16x32_bf16 v[96:99], v[48:51], a[40:43], v[96:99]
  ds_read_b64_tr_b16 v[40:41], v18 offset:0
  v_mfma_f32_16x16x32_bf16 v[100:103], v[48:51], a[44:47], v[100:103]
  ds_read_b64_tr_b16 v[42:43], v18 offset:4096
  buffer_load_dwordx4 v11, s[20:23], s28 offen offset:3072 lds
  v_mfma_f32_16x16x32_bf16 v[108:111], v[52:55], a[44:47], v[108:111]
  ds_read_b64_tr_b16 v[44:45], v19 offset:0
  s_and_b32 s28, s72, 127
  v_mfma_f32_16x16x32_bf16 v[104:107], v[52:55], a[40:43], v[104:107]
  ds_read_b64_tr_b16 v[46:47], v19 offset:4096
  s_lshl_b32 s28, s28, 16
  s_waitcnt lgkmcnt(8)
  v_mfma_f32_16x16x32_bf16 v[112:115], v[56:59], a[40:43], v[112:115]
  ds_read_b64_tr_b16 v[48:49], v20 offset:0
  s_add_u32 s28, s28, s41
  v_mfma_f32_16x16x32_bf16 v[116:119], v[56:59], a[44:47], v[116:119]
  ds_read_b64_tr_b16 v[50:51], v20 offset:4096
  buffer_load_dwordx4 a[28:31], v13, s[24:27], s29 offen offset:3072 sc1
  s_add_u32 s29, s29, 4096
  v_mfma_f32_16x16x32_bf16 v[124:127], v[60:63], a[44:47], v[124:127]
  ds_read_b64_tr_b16 v[52:53], v21 offset:0
  v_mfma_f32_16x16x32_bf16 v[120:123], v[60:63], a[40:43], v[120:123]
  ds_read_b64_tr_b16 v[54:55], v21 offset:4096
  s_waitcnt vmcnt(20)
  s_waitcnt lgkmcnt(8)
  v_mfma_f32_16x16x32_bf16 v[64:67], v[32:35], a[48:51], v[64:67]
  s_add_u32 m0, s42, 0
  ds_read_b64_tr_b16 v[56:57], v22 offset:0
  v_mfma_f32_16x16x32_bf16 v[68:71], v[32:35], a[52:55], v[68:71]
  ds_read_b64_tr_b16 v[58:59], v22 offset:4096
  buffer_load_dwordx4 v8, s[20:23], s28 offen offset:0 lds
  v_mfma_f32_16x16x32_bf16 v[76:79], v[36:39], a[52:55], v[76:79]
  ds_read_b64_tr_b16 v[60:61], v23 offset:0
  v_mfma_f32_16x16x32_bf16 v[72:75], v[36:39], a[48:51], v[72:75]
  ds_read_b64_tr_b16 v[62:63], v23 offset:4096
  s_waitcnt lgkmcnt(8)
  v_mfma_f32_16x16x32_bf16 v[80:83], v[40:43], a[48:51], v[80:83]
  ds_read_b64_tr_b16 v[32:33], v16 offset:8192
  v_mfma_f32_16x16x32_bf16 v[84:87], v[40:43], a[52:55], v[84:87]
  ds_read_b64_tr_b16 v[34:35], v16 offset:12288
  buffer_load_dwordx4 a[32:35], v12, s[24:27], s29 offen offset:0 sc1
  v_mfma_f32_16x16x32_bf16 v[92:95], v[44:47], a[52:55], v[92:95]
  ds_read_b64_tr_b16 v[36:37], v17 offset:8192
  s_lshr_b64 s[66:67], s[66:67], 7
  v_mfma_f32_16x16x32_bf16 v[88:91], v[44:47], a[48:51], v[88:91]
  ds_read_b64_tr_b16 v[38:39], v17 offset:12288
  s_waitcnt lgkmcnt(8)
  v_mfma_f32_16x16x32_bf16 v[96:99], v[48:51], a[48:51], v[96:99]
  ds_read_b64_tr_b16 v[40:41], v18 offset:8192
  v_mfma_f32_16x16x32_bf16 v[100:103], v[48:51], a[52:55], v[100:103]
  ds_read_b64_tr_b16 v[42:43], v18 offset:12288
  buffer_load_dwordx4 v9, s[20:23], s28 offen offset:1024 lds
  s_waitcnt vmcnt(26)
  v_mfma_f32_16x16x32_bf16 v[108:111], v[52:55], a[52:55], v[108:111]
  ds_read_b64_tr_b16 v[44:45], v19 offset:8192
  v_cmp_ne_u32 vcc, 1, v26
  v_mfma_f32_16x16x32_bf16 v[104:107], v[52:55], a[48:51], v[104:107]
  ds_read_b64_tr_b16 v[46:47], v19 offset:12288
  s_waitcnt lgkmcnt(8)
  v_mfma_f32_16x16x32_bf16 v[112:115], v[56:59], a[48:51], v[112:115]
  ds_read_b64_tr_b16 v[48:49], v20 offset:8192
  v_mfma_f32_16x16x32_bf16 v[116:119], v[56:59], a[52:55], v[116:119]
  ds_read_b64_tr_b16 v[50:51], v20 offset:12288
  buffer_load_dwordx4 a[36:39], v13, s[24:27], s29 offen offset:0 sc1
  v_mfma_f32_16x16x32_bf16 v[124:127], v[60:63], a[52:55], v[124:127]
  ds_read_b64_tr_b16 v[52:53], v21 offset:8192
  s_cmp_eq_u32 s31, 3
  s_cselect_b64 s[74:75], vcc, 0
  v_mfma_f32_16x16x32_bf16 v[120:123], v[60:63], a[48:51], v[120:123]
  ds_read_b64_tr_b16 v[54:55], v21 offset:12288
  s_waitcnt vmcnt(20)
  s_waitcnt lgkmcnt(8)
  v_mfma_f32_16x16x32_bf16 v[64:67], v[32:35], a[56:59], v[64:67]
  ds_read_b64_tr_b16 v[56:57], v22 offset:8192
  v_mfma_f32_16x16x32_bf16 v[68:71], v[32:35], a[60:63], v[68:71]
  ds_read_b64_tr_b16 v[58:59], v22 offset:12288
  buffer_load_dwordx4 v10, s[20:23], s28 offen offset:2048 lds
  v_mfma_f32_16x16x32_bf16 v[76:79], v[36:39], a[60:63], v[76:79]
  ds_read_b64_tr_b16 v[60:61], v23 offset:8192
  s_cmp_lg_u64 s[74:75], 0
  s_cbranch_scc1 L_g2_late
L_g2_back:
  v_mfma_f32_16x16x32_bf16 v[72:75], v[36:39], a[56:59], v[72:75]
  ds_read_b64_tr_b16 v[62:63], v23 offset:12288
  s_waitcnt lgkmcnt(8)
  s_waitcnt vmcnt(22)
  s_barrier
  v_xor_b32 v16, 0x10000, v16
  v_mfma_f32_16x16x32_bf16 v[80:83], v[40:43], a[56:59], v[80:83]
  ds_read_b64_tr_b16 v[32:33], v16 offset:16384
  v_mfma_f32_16x16x32_bf16 v[84:87], v[40:43], a[60:63], v[84:87]
  ds_read_b64_tr_b16 v[34:35], v16 offset:20480
  buffer_load_dwordx4 a[40:43], v12, s[24:27], s29 offen offset:1024 sc1
  v_xor_b32 v17, 0x10000, v17
  v_mfma_f32_16x16x32_bf16 v[92:95], v[44:47], a[60:63], v[92:95]
  s_cmp_eq_u32 s31, 0
  s_cselect_b32 s62, 1081344, 0
  ds_read_b64_tr_b16 v[36:37], v17 offset:16384
  v_mfma_f32_16x16x32_bf16 v[88:91], v[44:47], a[56:59], v[88:91]
  ds_read_b64_tr_b16 v[38:39], v17 offset:20480
  buffer_store_dword v1, v30, s[60:63], s54 offen offset:16 sc1
  s_waitcnt lgkmcnt(8)
  v_xor_b32 v18, 0x10000, v18
  v_mfma_f32_16x16x32_bf16 v[96:99], v[48:51], a[56:59], v[96:99]
  ds_read_b64_tr_b16 v[40:41], v18 offset:16384
  v_mfma_f32_16x16x32_bf16 v[100:103], v[48:51], a[60:63], v[100:103]
  ds_read_b64_tr_b16 v[42:43], v18 offset:20480
  buffer_load_dwordx4 v11, s[20:23], s28 offen offset:3072 lds
  v_xor_b32 v19, 0x10000, v19
  v_mfma_f32_16x16x32_bf16 v[108:111], v[52:55], a[60:63], v[108:111]
  ds_read_b64_tr_b16 v[44:45], v19 offset:16384
  s_and_b32 s28, s66, 127
  s_xor_b32 s30, s30, 0x10000
  s_xor_b32 s42, s42, 0x10000
  v_mfma_f32_16x16x32_bf16 v[104:107], v[52:55], a[56:59], v[104:107]
  ds_read_b64_tr_b16 v[46:47], v19 offset:20480
  s_lshl_b32 s28, s28, 16
  s_mov_b32 s43, 0x10000
  s_waitcnt lgkmcnt(8)
  v_xor_b32 v20, 0x10000, v20
  v_mfma_f32_16x16x32_bf16 v[112:115], v[56:59], a[56:59], v[112:115]
  ds_read_b64_tr_b16 v[48:49], v20 offset:16384
  s_add_u32 s28, s28, s41
  v_mfma_f32_16x16x32_bf16 v[116:119], v[56:59], a[60:63], v[116:119]
  ds_read_b64_tr_b16 v[50:51], v20 offset:20480
  buffer_load_dwordx4 a[44:47], v13, s[24:27], s29 offen offset:1024 sc1
  v_xor_b32 v21, 0x10000, v21
  v_mfma_f32_16x16x32_bf16 v[124:127], v[60:63], a[60:63], v[124:127]
  ds_read_b64_tr_b16 v[52:53], v21 offset:16384
  s_add_u32 s31, s31, 1
  v_mfma_f32_16x16x32_bf16 v[120:123], v[60:63], a[56:59], v[120:123]
  ds_read_b64_tr_b16 v[54:55], v21 offset:20480
  s_cmp_lt_u32 s31, 6
  s_cbranch_scc1 L_g2_loop
  s_waitcnt vmcnt(21)
  s_waitcnt lgkmcnt(8)
  v_xor_b32 v22, s43, v22
  v_mfma_f32_16x16x32_bf16 v[64:67], v[32:35], a[0:3], v[64:67]
  ds_read_b64_tr_b16 v[56:57], v22 offset:16384
  v_mfma_f32_16x16x32_bf16 v[68:71], v[32:35], a[4:7], v[68:71]
  ds_read_b64_tr_b16 v[58:59], v22 offset:20480
  buffer_load_dwordx4 a[48:51], v12, s[24:27], s29 offen offset:2048 sc1
  v_xor_b32 v23, s43, v23
  v_mfma_f32_16x16x32_bf16 v[76:79], v[36:39], a[4:7], v[76:79]
  ds_read_b64_tr_b16 v[60:61], v23 offset:16384
  v_mfma_f32_16x16x32_bf16 v[72:75], v[36:39], a[0:3], v[72:75]
  ds_read_b64_tr_b16 v[62:63], v23 offset:20480
  buffer_load_dwordx4 a[52:55], v13, s[24:27], s29 offen offset:2048 sc1
  s_waitcnt lgkmcnt(8)
  v_mfma_f32_16x16x32_bf16 v[80:83], v[40:43], a[0:3], v[80:83]
  ds_read_b64_tr_b16 v[32:33], v20 offset:24576
  v_mfma_f32_16x16x32_bf16 v[84:87], v[40:43], a[4:7], v[84:87]
  ds_read_b64_tr_b16 v[34:35], v20 offset:28672
  buffer_load_dwordx4 a[56:59], v12, s[24:27], s29 offen offset:3072 sc1
  v_mfma_f32_16x16x32_bf16 v[92:95], v[44:47], a[4:7], v[92:95]
  ds_read_b64_tr_b16 v[36:37], v21 offset:24576
  v_mfma_f32_16x16x32_bf16 v[88:91], v[44:47], a[0:3], v[88:91]
  ds_read_b64_tr_b16 v[38:39], v21 offset:28672
  buffer_load_dwordx4 a[60:63], v13, s[24:27], s29 offen offset:3072 sc1
  s_add_u32 s29, s29, 4096
  s_waitcnt lgkmcnt(8)
  v_mfma_f32_16x16x32_bf16 v[96:99], v[48:51], a[0:3], v[96:99]
  ds_read_b64_tr_b16 v[40:41], v22 offset:24576
  v_mfma_f32_16x16x32_bf16 v[100:103], v[48:51], a[4:7], v[100:103]
  ds_read_b64_tr_b16 v[42:43], v22 offset:28672
  buffer_load_dwordx4 v[160:163], v14, s[32:35], s40 offen offset:0 sc1
  v_mfma_f32_16x16x32_bf16 v[108:111], v[52:55], a[4:7], v[108:111]
  ds_read_b64_tr_b16 v[44:45], v23 offset:24576
  v_mfma_f32_16x16x32_bf16 v[104:107], v[52:55], a[0:3], v[104:107]
  ds_read_b64_tr_b16 v[46:47], v23 offset:28672
  buffer_load_dwordx4 v[164:167], v14, s[32:35], s40 offen offset:64 sc1
  s_waitcnt lgkmcnt(8)
  s_waitcnt vmcnt(24)
  s_barrier
  v_mfma_f32_16x16x32_bf16 v[112:115], v[56:59], a[0:3], v[112:115]
  ds_read_b64_tr_b16 v[48:49], v20 offset:32768
  v_mfma_f32_16x16x32_bf16 v[116:119], v[56:59], a[4:7], v[116:119]
  ds_read_b64_tr_b16 v[50:51], v20 offset:36864
  buffer_load_dwordx4 v[168:171], v15, s[32:35], s40 offen offset:0 sc1
  v_mfma_f32_16x16x32_bf16 v[124:127], v[60:63], a[4:7], v[124:127]
  ds_read_b64_tr_b16 v[52:53], v21 offset:32768
  v_mfma_f32_16x16x32_bf16 v[120:123], v[60:63], a[0:3], v[120:123]
  ds_read_b64_tr_b16 v[54:55], v21 offset:36864
  buffer_load_dwordx4 v[172:175], v15, s[32:35], s40 offen offset:64 sc1
  s_waitcnt vmcnt(25)
  s_waitcnt lgkmcnt(8)
  v_mfma_f32_16x16x32_bf16 v[96:99], v[32:35], a[8:11], v[96:99]
  ds_read_b64_tr_b16 v[56:57], v22 offset:32768
  v_mfma_f32_16x16x32_bf16 v[100:103], v[32:35], a[12:15], v[100:103]
  ds_read_b64_tr_b16 v[58:59], v22 offset:36864
  v_mfma_f32_16x16x32_bf16 v[108:111], v[36:39], a[12:15], v[108:111]
  ds_read_b64_tr_b16 v[60:61], v23 offset:32768
  v_mfma_f32_16x16x32_bf16 v[104:107], v[36:39], a[8:11], v[104:107]
  ds_read_b64_tr_b16 v[62:63], v23 offset:36864
  s_waitcnt lgkmcnt(8)
  v_mfma_f32_16x16x32_bf16 v[112:115], v[40:43], a[8:11], v[112:115]
  ds_read_b64_tr_b16 v[32:33], v20 offset:40960
  v_mfma_f32_16x16x32_bf16 v[116:119], v[40:43], a[12:15], v[116:119]
  ds_read_b64_tr_b16 v[34:35], v20 offset:45056
  v_mfma_f32_16x16x32_bf16 v[124:127], v[44:47], a[12:15], v[124:127]
  ds_read_b64_tr_b16 v[36:37], v21 offset:40960
  v_mfma_f32_16x16x32_bf16 v[120:123], v[44:47], a[8:11], v[120:123]
  ds_read_b64_tr_b16 v[38:39], v21 offset:45056
  s_waitcnt vmcnt(21)
  s_waitcnt lgkmcnt(8)
  v_mfma_f32_16x16x32_bf16 v[96:99], v[48:51], a[16:19], v[96:99]
  ds_read_b64_tr_b16 v[40:41], v22 offset:40960
  v_mfma_f32_16x16x32_bf16 v[100:103], v[48:51], a[20:23], v[100:103]
  ds_read_b64_tr_b16 v[42:43], v22 offset:45056
  v_mfma_f32_16x16x32_bf16 v[108:111], v[52:55], a[20:23], v[108:111]
  ds_read_b64_tr_b16 v[44:45], v23 offset:40960
  v_mfma_f32_16x16x32_bf16 v[104:107], v[52:55], a[16:19], v[104:107]
  ds_read_b64_tr_b16 v[46:47], v23 offset:45056
  s_waitcnt lgkmcnt(8)
  s_waitcnt vmcnt(18)
  s_barrier
  v_mfma_f32_16x16x32_bf16 v[112:115], v[56:59], a[16:19], v[112:115]
  ds_read_b64_tr_b16 v[48:49], v20 offset:49152
  v_mfma_f32_16x16x32_bf16 v[116:119], v[56:59], a[20:23], v[116:119]
  ds_read_b64_tr_b16 v[50:51], v20 offset:53248
  v_mfma_f32_16x16x32_bf16 v[124:127], v[60:63], a[20:23], v[124:127]
  ds_read_b64_tr_b16 v[52:53], v21 offset:49152
  v_mfma_f32_16x16x32_bf16 v[120:123], v[60:63], a[16:19], v[120:123]
  ds_read_b64_tr_b16 v[54:55], v21 offset:53248
  s_waitcnt vmcnt(17)
  s_waitcnt lgkmcnt(8)
  v_mfma_f32_16x16x32_bf16 v[96:99], v[32:35], a[24:27], v[96:99]
  ds_read_b64_tr_b16 v[56:57], v22 offset:49152
  v_mfma_f32_16x16x32_bf16 v[100:103], v[32:35], a[28:31], v[100:103]
  ds_read_b64_tr_b16 v[58:59], v22 offset:53248
  v_mfma_f32_16x16x32_bf16 v[108:111], v[36:39], a[28:31], v[108:111]
  ds_read_b64_tr_b16 v[60:61], v23 offset:49152
  v_mfma_f32_16x16x32_bf16 v[104:107], v[36:39], a[24:27], v[104:107]
  ds_read_b64_tr_b16 v[62:63], v23 offset:53248
  s_waitcnt lgkmcnt(8)
  v_mfma_f32_16x16x32_bf16 v[112:115], v[40:43], a[24:27], v[112:115]
  ds_read_b64_tr_b16 v[32:33], v20 offset:57344
  v_mfma_f32_16x16x32_bf16 v[116:119], v[40:43], a[28:31], v[116:119]
  ds_read_b64_tr_b16 v[34:35], v20 offset:61440
  v_mfma_f32_16x16x32_bf16 v[124:127], v[44:47], a[28:31], v[124:127]
  ds_read_b64_tr_b16 v[36:37], v21 offset:57344
  v_mfma_f32_16x16x32_bf16 v[120:123], v[44:47], a[24:27], v[120:123]
  ds_read_b64_tr_b16 v[38:39], v21 offset:61440
  s_waitcnt vmcnt(13)
  s_waitcnt lgkmcnt(8)
  v_mfma_f32_16x16x32_bf16 v[96:99], v[48:51], a[32:35], v[96:99]
  ds_read_b64_tr_b16 v[40:41], v22 offset:57344
  v_mfma_f32_16x16x32_bf16 v[100:103], v[48:51], a[36:39], v[100:103]
  ds_read_b64_tr_b16 v[42:43], v22 offset:61440
  v_mfma_f32_16x16x32_bf16 v[108:111], v[52:55], a[36:39], v[108:111]
  ds_read_b64_tr_b16 v[44:45], v23 offset:57344
  v_mfma_f32_16x16x32_bf16 v[104:107], v[52:55], a[32:35], v[104:107]
  ds_read_b64_tr_b16 v[46:47], v23 offset:61440
  s_waitcnt lgkmcnt(8)
  s_waitcnt vmcnt(9)
  s_barrier
  v_mfma_f32_16x16x32_bf16 v[112:115], v[56:59], a[32:35], v[112:115]
  ds_read_b64_tr_b16 v[48:49], v20 offset:0
  v_mfma_f32_16x16x32_bf16 v[116:119], v[56:59], a[36:39], v[116:119]
  ds_read_b64_tr_b16 v[50:51], v20 offset:4096
  v_mfma_f32_16x16x32_bf16 v[124:127], v[60:63], a[36:39], v[124:127]
  ds_read_b64_tr_b16 v[52:53], v21 offset:0
  v_mfma_f32_16x16x32_bf16 v[120:123], v[60:63], a[32:35], v[120:123]
  ds_read_b64_tr_b16 v[54:55], v21 offset:4096
  s_waitcnt vmcnt(8)
  s_waitcnt lgkmcnt(8)
  v_mfma_f32_16x16x32_bf16 v[96:99], v[32:35], a[40:43], v[96:99]
  ds_read_b64_tr_b16 v[56:57], v22 offset:0
  v_mfma_f32_16x16x32_bf16 v[100:103], v[32:35], a[44:47], v[100:103]
  ds_read_b64_tr_b16 v[58:59], v22 offset:4096
  v_mfma_f32_16x16x32_bf16 v[108:111], v[36:39], a[44:47], v[108:111]
  ds_read_b64_tr_b16 v[60:61], v23 offset:0
  v_mfma_f32_16x16x32_bf16 v[104:107], v[36:39], a[40:43], v[104:107]
  ds_read_b64_tr_b16 v[62:63], v23 offset:4096
  s_waitcnt lgkmcnt(8)
  v_mfma_f32_16x16x32_bf16 v[112:115], v[40:43], a[40:43], v[112:115]
  ds_read_b64_tr_b16 v[32:33], v20 offset:8192
  v_mfma_f32_16x16x32_bf16 v[116:119], v[40:43], a[44:47], v[116:119]
  ds_read_b64_tr_b16 v[34:35], v20 offset:12288
  v_mfma_f32_16x16x32_bf16 v[124:127], v[44:47], a[44:47], v[124:127]
  ds_read_b64_tr_b16 v[36:37], v21 offset:8192
  v_mfma_f32_16x16x32_bf16 v[120:123], v[44:47], a[40:43], v[120:123]
  ds_read_b64_tr_b16 v[38:39], v21 offset:12288
  s_waitcnt vmcnt(6)
  s_waitcnt lgkmcnt(8)
  v_mfma_f32_16x16x32_bf16 v[96:99], v[48:51], a[48:51], v[96:99]
  ds_read_b64_tr_b16 v[40:41], v22 offset:8192
  v_mfma_f32_16x16x32_bf16 v[100:103], v[48:51], a[52:55], v[100:103]
  ds_read_b64_tr_b16 v[42:43], v22 offset:12288
  v_mfma_f32_16x16x32_bf16 v[108:111], v[52:55], a[52:55], v[108:111]
  ds_read_b64_tr_b16 v[44:45], v23 offset:8192
  v_mfma_f32_16x16x32_bf16 v[104:107], v[52:55], a[48:51], v[104:107]
  ds_read_b64_tr_b16 v[46:47], v23 offset:12288
  s_waitcnt lgkmcnt(8)
  v_mfma_f32_16x16x32_bf16 v[112:115], v[56:59], a[48:51], v[112:115]
  ds_read_b64_tr_b16 v[48:49], v16 offset:24576
  v_mfma_f32_16x16x32_bf16 v[116:119], v[56:59], a[52:55], v[116:119]
  ds_read_b64_tr_b16 v[50:51], v16 offset:28672
  v_mfma_f32_16x16x32_bf16 v[124:127], v[60:63], a[52:55], v[124:127]
  ds_read_b64_tr_b16 v[52:53], v17 offset:24576
  v_mfma_f32_16x16x32_bf16 v[120:123], v[60:63], a[48:51], v[120:123]
  ds_read_b64_tr_b16 v[54:55], v17 offset:28672
  s_waitcnt vmcnt(4)
  s_waitcnt lgkmcnt(8)
  v_mfma_f32_16x16x32_bf16 v[96:99], v[32:35], a[56:59], v[96:99]
  ds_read_b64_tr_b16 v[56:57], v18 offset:24576
  v_mfma_f32_16x16x32_bf16 v[100:103], v[32:35], a[60:63], v[100:103]
  ds_read_b64_tr_b16 v[58:59], v18 offset:28672
  v_mfma_f32_16x16x32_bf16 v[108:111], v[36:39], a[60:63], v[108:111]
  ds_read_b64_tr_b16 v[60:61], v19 offset:24576
  v_mfma_f32_16x16x32_bf16 v[104:107], v[36:39], a[56:59], v[104:107]
  ds_read_b64_tr_b16 v[62:63], v19 offset:28672
  s_waitcnt lgkmcnt(8)
  v_mfma_f32_16x16x32_bf16 v[112:115], v[40:43], a[56:59], v[112:115]
  ds_read_b64_tr_b16 v[32:33], v16 offset:32768
  v_mfma_f32_16x16x32_bf16 v[116:119], v[40:43], a[60:63], v[116:119]
  ds_read_b64_tr_b16 v[34:35], v16 offset:36864
  v_mfma_f32_16x16x32_bf16 v[124:127], v[44:47], a[60:63], v[124:127]
  ds_read_b64_tr_b16 v[36:37], v17 offset:32768
  v_mfma_f32_16x16x32_bf16 v[120:123], v[44:47], a[56:59], v[120:123]
  ds_read_b64_tr_b16 v[38:39], v17 offset:36864
  s_waitcnt lgkmcnt(8)
  v_mfma_f32_16x16x32_bf16 v[64:67], v[48:51], a[8:11], v[64:67]
  ds_read_b64_tr_b16 v[40:41], v18 offset:32768
  v_mfma_f32_16x16x32_bf16 v[68:71], v[48:51], a[12:15], v[68:71]
  ds_read_b64_tr_b16 v[42:43], v18 offset:36864
  v_mfma_f32_16x16x32_bf16 v[76:79], v[52:55], a[12:15], v[76:79]
  ds_read_b64_tr_b16 v[44:45], v19 offset:32768
  v_mfma_f32_16x16x32_bf16 v[72:75], v[52:55], a[8:11], v[72:75]
  ds_read_b64_tr_b16 v[46:47], v19 offset:36864
  s_waitcnt lgkmcnt(8)
  v_mfma_f32_16x16x32_bf16 v[80:83], v[56:59], a[8:11], v[80:83]
  ds_read_b64_tr_b16 v[48:49], v16 offset:40960
  v_cvt_pk_bf16_f32 v96, v96, v97
  v_mfma_f32_16x16x32_bf16 v[84:87], v[56:59], a[12:15], v[84:87]
  ds_read_b64_tr_b16 v[50:51], v16 offset:45056
  v_cvt_pk_bf16_f32 v97, v98, v99
  v_cvt_pk_bf16_f32 v98, v104, v105
  v_mfma_f32_16x16x32_bf16 v[92:95], v[60:63], a[12:15], v[92:95]
  ds_read_b64_tr_b16 v[52:53], v17 offset:40960
  v_cvt_pk_bf16_f32 v99, v106, v107
  v_mfma_f32_16x16x32_bf16 v[88:91], v[60:63], a[8:11], v[88:91]
  ds_read_b64_tr_b16 v[54:55], v17 offset:45056
  v_min_u32 v96, s50, v96
  v_min_u32 v98, s50, v98
  s_waitcnt lgkmcnt(8)
  v_mfma_f32_16x16x32_bf16 v[64:67], v[32:35], a[16:19], v[64:67]
  ds_read_b64_tr_b16 v[56:57], v18 offset:40960
  v_min_u32 v97, s50, v97
  v_mfma_f32_16x16x32_bf16 v[68:71], v[32:35], a[20:23], v[68:71]
  ds_read_b64_tr_b16 v[58:59], v18 offset:45056
  v_min_u32 v99, s50, v99
  s_nop 0
  v_mfma_f32_16x16x32_bf16 v[76:79], v[36:39], a[20:23], v[76:79]
  ds_read_b64_tr_b16 v[60:61], v19 offset:40960
  v_permlane16_swap_b32 v96, v98
  v_mfma_f32_16x16x32_bf16 v[72:75], v[36:39], a[16:19], v[72:75]
  ds_read_b64_tr_b16 v[62:63], v19 offset:45056
  v_permlane16_swap_b32 v97, v99
  buffer_store_dwordx4 v[96:99], v12, s[44:47], s48 offen offset:0 sc1
  s_waitcnt lgkmcnt(8)
  v_mfma_f32_16x16x32_bf16 v[80:83], v[40:43], a[16:19], v[80:83]
  ds_read_b64_tr_b16 v[32:33], v16 offset:49152
  v_cvt_pk_bf16_f32 v100, v100, v101
  v_mfma_f32_16x16x32_bf16 v[84:87], v[40:43], a[20:23], v[84:87]
  ds_read_b64_tr_b16 v[34:35], v16 offset:53248
  v_cvt_pk_bf16_f32 v101, v102, v103
  v_cvt_pk_bf16_f32 v102, v108, v109
  v_mfma_f32_16x16x32_bf16 v[92:95], v[44:47], a[20:23], v[92:95]
  ds_read_b64_tr_b16 v[36:37], v17 offset:49152
  v_cvt_pk_bf16_f32 v103, v110, v111
  v_mfma_f32_16x16x32_bf16 v[88:91], v[44:47], a[16:19], v[88:91]
  ds_read_b64_tr_b16 v[38:39], v17 offset:53248
  v_min_u32 v100, s50, v100
  v_min_u32 v102, s50, v102
  s_waitcnt lgkmcnt(8)
  v_mfma_f32_16x16x32_bf16 v[64:67], v[48:51], a[24:27], v[64:67]
  ds_read_b64_tr_b16 v[40:41], v18 offset:49152
  v_min_u32 v101, s50, v101
  v_mfma_f32_16x16x32_bf16 v[68:71], v[48:51], a[28:31], v[68:71]
  ds_read_b64_tr_b16 v[42:43], v18 offset:53248
  v_min_u32 v103, s50, v103
  s_nop 0
  v_mfma_f32_16x16x32_bf16 v[76:79], v[52:55], a[28:31], v[76:79]
  ds_read_b64_tr_b16 v[44:45], v19 offset:49152
  v_permlane16_swap_b32 v100, v102
  v_mfma_f32_16x16x32_bf16 v[72:75], v[52:55], a[24:27], v[72:75]
  ds_read_b64_tr_b16 v[46:47], v19 offset:53248
  v_permlane16_swap_b32 v101, v103
  buffer_store_dwordx4 v[100:103], v12, s[44:47], s48 offen offset:1024 sc1
  s_waitcnt lgkmcnt(8)
  v_mfma_f32_16x16x32_bf16 v[80:83], v[56:59], a[24:27], v[80:83]
  ds_read_b64_tr_b16 v[48:49], v16 offset:57344
  v_cvt_pk_bf16_f32 v112, v112, v113
  v_mfma_f32_16x16x32_bf16 v[84:87], v[56:59], a[28:31], v[84:87]
  ds_read_b64_tr_b16 v[50:51], v16 offset:61440
  v_cvt_pk_bf16_f32 v113, v114, v115
  v_cvt_pk_bf16_f32 v114, v120, v121
  v_mfma_f32_16x16x32_bf16 v[92:95], v[60:63], a[28:31], v[92:95]
  ds_read_b64_tr_b16 v[52:53], v17 offset:57344
  v_cvt_pk_bf16_f32 v115, v122, v123
  v_mfma_f32_16x16x32_bf16 v[88:91], v[60:63], a[24:27], v[88:91]
  ds_read_b64_tr_b16 v[54:55], v17 offset:61440
  v_min_u32 v112, s50, v112
  v_min_u32 v114, s50, v114
  s_waitcnt lgkmcnt(8)
  v_mfma_f32_16x16x32_bf16 v[64:67], v[32:35], a[32:35], v[64:67]
  ds_read_b64_tr_b16 v[56:57], v18 offset:57344
  v_min_u32 v113, s50, v113
  v_mfma_f32_16x16x32_bf16 v[68:71], v[32:35], a[36:39], v[68:71]
  ds_read_b64_tr_b16 v[58:59], v18 offset:61440
  v_min_u32 v115, s50, v115
  s_nop 0
  v_mfma_f32_16x16x32_bf16 v[76:79], v[36:39], a[36:39], v[76:79]
  ds_read_b64_tr_b16 v[60:61], v19 offset:57344
  v_permlane16_swap_b32 v112, v114
  v_mfma_f32_16x16x32_bf16 v[72:75], v[36:39], a[32:35], v[72:75]
  ds_read_b64_tr_b16 v[62:63], v19 offset:61440
  v_permlane16_swap_b32 v113, v115
  buffer_store_dwordx4 v[112:115], v12, s[44:47], s48 offen offset:2048 sc1
  s_waitcnt lgkmcnt(8)
  v_mfma_f32_16x16x32_bf16 v[80:83], v[40:43], a[32:35], v[80:83]
  ds_read_b64_tr_b16 v[32:33], v16 offset:0
  v_cvt_pk_bf16_f32 v116, v116, v117
  v_mfma_f32_16x16x32_bf16 v[84:87], v[40:43], a[36:39], v[84:87]
  ds_read_b64_tr_b16 v[34:35], v16 offset:4096
  v_cvt_pk_bf16_f32 v117, v118, v119
  v_cvt_pk_bf16_f32 v118, v124, v125
  v_mfma_f32_16x16x32_bf16 v[92:95], v[44:47], a[36:39], v[92:95]
  ds_read_b64_tr_b16 v[36:37], v17 offset:0
  v_cvt_pk_bf16_f32 v119, v126, v127
  v_mfma_f32_16x16x32_bf16 v[88:91], v[44:47], a[32:35], v[88:91]
  ds_read_b64_tr_b16 v[38:39], v17 offset:4096
  v_min_u32 v116, s50, v116
  v_min_u32 v118, s50, v118
  s_waitcnt lgkmcnt(8)
  v_mfma_f32_16x16x32_bf16 v[64:67], v[48:51], a[40:43], v[64:67]
  ds_read_b64_tr_b16 v[40:41], v18 offset:0
  v_min_u32 v117, s50, v117
  v_mfma_f32_16x16x32_bf16 v[68:71], v[48:51], a[44:47], v[68:71]
  ds_read_b64_tr_b16 v[42:43], v18 offset:4096
  v_min_u32 v119, s50, v119
  s_nop 0
  v_mfma_f32_16x16x32_bf16 v[76:79], v[52:55], a[44:47], v[76:79]
  ds_read_b64_tr_b16 v[44:45], v19 offset:0
  v_permlane16_swap_b32 v116, v118
  v_mfma_f32_16x16x32_bf16 v[72:75], v[52:55], a[40:43], v[72:75]
  ds_read_b64_tr_b16 v[46:47], v19 offset:4096
  v_permlane16_swap_b32 v117, v119
  buffer_store_dwordx4 v[116:119], v12, s[44:47], s48 offen offset:3072 sc1
  s_waitcnt lgkmcnt(8)
  v_mfma_f32_16x16x32_bf16 v[80:83], v[56:59], a[40:43], v[80:83]
  ds_read_b64_tr_b16 v[48:49], v16 offset:8192
  v_mfma_f32_16x16x32_bf16 v[84:87], v[56:59], a[44:47], v[84:87]
  ds_read_b64_tr_b16 v[50:51], v16 offset:12288
  v_mfma_f32_16x16x32_bf16 v[92:95], v[60:63], a[44:47], v[92:95]
  ds_read_b64_tr_b16 v[52:53], v17 offset:8192
  v_mfma_f32_16x16x32_bf16 v[88:91], v[60:63], a[40:43], v[88:91]
  ds_read_b64_tr_b16 v[54:55], v17 offset:12288
  s_waitcnt lgkmcnt(8)
  v_mfma_f32_16x16x32_bf16 v[64:67], v[32:35], a[48:51], v[64:67]
  ds_read_b64_tr_b16 v[56:57], v18 offset:8192
  v_mfma_f32_16x16x32_bf16 v[68:71], v[32:35], a[52:55], v[68:71]
  ds_read_b64_tr_b16 v[58:59], v18 offset:12288
  v_mfma_f32_16x16x32_bf16 v[76:79], v[36:39], a[52:55], v[76:79]
  ds_read_b64_tr_b16 v[60:61], v19 offset:8192
  v_mfma_f32_16x16x32_bf16 v[72:75], v[36:39], a[48:51], v[72:75]
  ds_read_b64_tr_b16 v[62:63], v19 offset:12288
  s_waitcnt lgkmcnt(8)
  v_mfma_f32_16x16x32_bf16 v[80:83], v[40:43], a[48:51], v[80:83]
  v_mfma_f32_16x16x32_bf16 v[84:87], v[40:43], a[52:55], v[84:87]
  v_mfma_f32_16x16x32_bf16 v[92:95], v[44:47], a[52:55], v[92:95]
  v_mfma_f32_16x16x32_bf16 v[88:91], v[44:47], a[48:51], v[88:91]
  s_waitcnt lgkmcnt(4)
  v_mfma_f32_16x16x32_bf16 v[64:67], v[48:51], a[56:59], v[64:67]
  v_mfma_f32_16x16x32_bf16 v[68:71], v[48:51], a[60:63], v[68:71]
  v_mfma_f32_16x16x32_bf16 v[76:79], v[52:55], a[60:63], v[76:79]
  v_mfma_f32_16x16x32_bf16 v[72:75], v[52:55], a[56:59], v[72:75]
  s_waitcnt lgkmcnt(0)
  v_mfma_f32_16x16x32_bf16 v[80:83], v[56:59], a[56:59], v[80:83]
  v_mfma_f32_16x16x32_bf16 v[84:87], v[56:59], a[60:63], v[84:87]
  v_mfma_f32_16x16x32_bf16 v[92:95], v[60:63], a[60:63], v[92:95]
  v_mfma_f32_16x16x32_bf16 v[88:91], v[60:63], a[56:59], v[88:91]
  s_mov_b32 s17, 0
L_g2_poll:
  buffer_load_dwordx4 v[128:131], v12, s[44:47], s49 offen offset:0 sc1
  buffer_load_dwordx4 v[132:135], v12, s[44:47], s49 offen offset:1024 sc1
  buffer_load_dwordx4 v[136:139], v12, s[44:47], s49 offen offset:2048 sc1
  buffer_load_dwordx4 v[140:143], v12, s[44:47], s49 offen offset:3072 sc1
  s_cmp_lg_u32 s17, 0
  s_cbranch_scc1 L_g2_check
  s_waitcnt vmcnt(8)
  s_nop 4
  v_permlane16_swap_b32 v64, v72
  v_permlane16_swap_b32 v65, v73
  v_permlane16_swap_b32 v66, v74
  v_permlane16_swap_b32 v67, v75
  v_lshlrev_b32 v2, 16, v160
  v_and_b32 v3, 0xffff0000, v160
  v_pk_add_f32 v[64:65], v[64:65], v[2:3]
  v_lshlrev_b32 v4, 16, v161
  v_and_b32 v5, 0xffff0000, v161
  v_pk_add_f32 v[66:67], v[66:67], v[4:5]
  v_lshlrev_b32 v2, 16, v162
  v_and_b32 v3, 0xffff0000, v162
  v_pk_add_f32 v[72:73], v[72:73], v[2:3]
  v_lshlrev_b32 v4, 16, v163
  v_and_b32 v5, 0xffff0000, v163
  v_pk_add_f32 v[74:75], v[74:75], v[4:5]
  v_permlane16_swap_b32 v80, v88
  v_permlane16_swap_b32 v81, v89
  v_permlane16_swap_b32 v82, v90
  v_permlane16_swap_b32 v83, v91
  v_lshlrev_b32 v2, 16, v164
  v_and_b32 v3, 0xffff0000, v164
  v_pk_add_f32 v[80:81], v[80:81], v[2:3]
  v_lshlrev_b32 v4, 16, v165
  v_and_b32 v5, 0xffff0000, v165
  v_pk_add_f32 v[82:83], v[82:83], v[4:5]
  v_lshlrev_b32 v2, 16, v166
  v_and_b32 v3, 0xffff0000, v166
  v_pk_add_f32 v[88:89], v[88:89], v[2:3]
  v_lshlrev_b32 v4, 16, v167
  v_and_b32 v5, 0xffff0000, v167
  v_pk_add_f32 v[90:91], v[90:91], v[4:5]
  v_permlane16_swap_b32 v68, v76
  v_permlane16_swap_b32 v69, v77
  v_permlane16_swap_b32 v70, v78
  v_permlane16_swap_b32 v71, v79
  v_lshlrev_b32 v2, 16, v168
  v_and_b32 v3, 0xffff0000, v168
  v_pk_add_f32 v[68:69], v[68:69], v[2:3]
  v_lshlrev_b32 v4, 16, v169
  v_and_b32 v5, 0xffff0000, v169
  v_pk_add_f32 v[70:71], v[70:71], v[4:5]
  v_lshlrev_b32 v2, 16, v170
  v_and_b32 v3, 0xffff0000, v170
  v_pk_add_f32 v[76:77], v[76:77], v[2:3]
  v_lshlrev_b32 v4, 16, v171
  v_and_b32 v5, 0xffff0000, v171
  v_pk_add_f32 v[78:79], v[78:79], v[4:5]
  v_permlane16_swap_b32 v84, v92
  v_permlane16_swap_b32 v85, v93
  v_permlane16_swap_b32 v86, v94
  v_permlane16_swap_b32 v87, v95
  v_lshlrev_b32 v2, 16, v172
  v_and_b32 v3, 0xffff0000, v172
  v_pk_add_f32 v[84:85], v[84:85], v[2:3]
  v_lshlrev_b32 v4, 16, v173
  v_and_b32 v5, 0xffff0000, v173
  v_pk_add_f32 v[86:87], v[86:87], v[4:5]
  v_lshlrev_b32 v2, 16, v174
  v_and_b32 v3, 0xffff0000, v174
  v_pk_add_f32 v[92:93], v[92:93], v[2:3]
  v_lshlrev_b32 v4, 16, v175
  v_and_b32 v5, 0xffff0000, v175
  v_pk_add_f32 v[94:95], v[94:95], v[4:5]
L_g2_check:
  s_add_u32 s17, s17, 1
  s_waitcnt vmcnt(3)
  v_max3_u32 v2, v128, v129, v130
  v_max_u32 v2, v2, v131
  s_waitcnt vmcnt(2)
  v_max3_u32 v2, v2, v132, v133
  v_max3_u32 v2, v2, v134, v135
  s_waitcnt vmcnt(1)
  v_max3_u32 v2, v2, v136, v137
  v_max3_u32 v2, v2, v138, v139
  s_waitcnt vmcnt(0)
  v_max3_u32 v2, v2, v140, v141
  v_max3_u32 v2, v2, v142, v143
  v_cmp_eq_u32 vcc, -1, v2
  s_cmp_lt_u32 s17, 0x40000
  s_cselect_b64 s[18:19], vcc, 0
  s_cmp_lg_u64 s[18:19], 0
  s_cbranch_scc1 L_g2_poll
  v_lshlrev_b32 v2, 16, v128
  v_and_b32 v3, 0xffff0000, v128
  v_pk_add_f32 v[64:65], v[64:65], v[2:3]
  v_cvt_pk_bf16_f32 v160, v64, v65
  v_lshlrev_b32 v4, 16, v129
  v_and_b32 v5, 0xffff0000, v129
  v_pk_add_f32 v[66:67], v[66:67], v[4:5]
  v_cvt_pk_bf16_f32 v161, v66, v67
  v_lshlrev_b32 v2, 16, v130
  v_and_b32 v3, 0xffff0000, v130
  v_pk_add_f32 v[72:73], v[72:73], v[2:3]
  v_cvt_pk_bf16_f32 v162, v72, v73
  v_lshlrev_b32 v4, 16, v131
  v_and_b32 v5, 0xffff0000, v131
  v_pk_add_f32 v[74:75], v[74:75], v[4:5]
  v_cvt_pk_bf16_f32 v163, v74, v75
  v_lshlrev_b32 v2, 16, v136
  v_and_b32 v3, 0xffff0000, v136
  v_pk_add_f32 v[80:81], v[80:81], v[2:3]
  v_cvt_pk_bf16_f32 v164, v80, v81
  v_lshlrev_b32 v4, 16, v137
  v_and_b32 v5, 0xffff0000, v137
  v_pk_add_f32 v[82:83], v[82:83], v[4:5]
  v_cvt_pk_bf16_f32 v165, v82, v83
  v_lshlrev_b32 v2, 16, v138
  v_and_b32 v3, 0xffff0000, v138
  v_pk_add_f32 v[88:89], v[88:89], v[2:3]
  v_cvt_pk_bf16_f32 v166, v88, v89
  v_lshlrev_b32 v4, 16, v139
  v_and_b32 v5, 0xffff0000, v139
  v_pk_add_f32 v[90:91], v[90:91], v[4:5]
  v_cvt_pk_bf16_f32 v167, v90, v91
  v_mov_b32_dpp v128, v164 row_ror:8 row_mask:0xf bank_mask:0xf
  v_mov_b32_dpp v129, v165 row_ror:8 row_mask:0xf bank_mask:0xf
  v_mov_b32_dpp v130, v166 row_ror:8 row_mask:0xf bank_mask:0xf
  v_mov_b32_dpp v131, v167 row_ror:8 row_mask:0xf bank_mask:0xf
  v_mov_b32_dpp v164, v160 row_ror:8 row_mask:0xf bank_mask:0x3
  v_mov_b32_dpp v165, v161 row_ror:8 row_mask:0xf bank_mask:0x3
  v_mov_b32_dpp v166, v162 row_ror:8 row_mask:0xf bank_mask:0x3
  v_mov_b32_dpp v167, v163 row_ror:8 row_mask:0xf bank_mask:0x3
  v_mov_b32_dpp v160, v128 quad_perm:[0,1,2,3] row_mask:0xf bank_mask:0xc
  v_mov_b32_dpp v161, v129 quad_perm:[0,1,2,3] row_mask:0xf bank_mask:0xc
  v_mov_b32_dpp v162, v130 quad_perm:[0,1,2,3] row_mask:0xf bank_mask:0xc
  v_mov_b32_dpp v163, v131 quad_perm:[0,1,2,3] row_mask:0xf bank_mask:0xc
  buffer_store_dwordx4 v[160:163], v28, s[36:39], s40 offen
  buffer_store_dwordx4 v[164:167], v28, s[36:39], s51 offen
  v_lshlrev_b32 v2, 16, v132
  v_and_b32 v3, 0xffff0000, v132
  v_pk_add_f32 v[68:69], v[68:69], v[2:3]
  v_cvt_pk_bf16_f32 v168, v68, v69
  v_lshlrev_b32 v4, 16, v133
  v_and_b32 v5, 0xffff0000, v133
  v_pk_add_f32 v[70:71], v[70:71], v[4:5]
  v_cvt_pk_bf16_f32 v169, v70, v71
  v_lshlrev_b32 v2, 16, v134
  v_and_b32 v3, 0xffff0000, v134
  v_pk_add_f32 v[76:77], v[76:77], v[2:3]
  v_cvt_pk_bf16_f32 v170, v76, v77
  v_lshlrev_b32 v4, 16, v135
  v_and_b32 v5, 0xffff0000, v135
  v_pk_add_f32 v[78:79], v[78:79], v[4:5]
  v_cvt_pk_bf16_f32 v171, v78, v79
  v_lshlrev_b32 v2, 16, v140
  v_and_b32 v3, 0xffff0000, v140
  v_pk_add_f32 v[84:85], v[84:85], v[2:3]
  v_cvt_pk_bf16_f32 v172, v84, v85
  v_lshlrev_b32 v4, 16, v141
  v_and_b32 v5, 0xffff0000, v141
  v_pk_add_f32 v[86:87], v[86:87], v[4:5]
  v_cvt_pk_bf16_f32 v173, v86, v87
  v_lshlrev_b32 v2, 16, v142
  v_and_b32 v3, 0xffff0000, v142
  v_pk_add_f32 v[92:93], v[92:93], v[2:3]
  v_cvt_pk_bf16_f32 v174, v92, v93
  v_lshlrev_b32 v4, 16, v143
  v_and_b32 v5, 0xffff0000, v143
  v_pk_add_f32 v[94:95], v[94:95], v[4:5]
  v_cvt_pk_bf16_f32 v175, v94, v95
  v_mov_b32_dpp v128, v172 row_ror:8 row_mask:0xf bank_mask:0xf
  v_mov_b32_dpp v129, v173 row_ror:8 row_mask:0xf bank_mask:0xf
  v_mov_b32_dpp v130, v174 row_ror:8 row_mask:0xf bank_mask:0xf
  v_mov_b32_dpp v131, v175 row_ror:8 row_mask:0xf bank_mask:0xf
  v_mov_b32_dpp v172, v168 row_ror:8 row_mask:0xf bank_mask:0x3
  v_mov_b32_dpp v173, v169 row_ror:8 row_mask:0xf bank_mask:0x3
  v_mov_b32_dpp v174, v170 row_ror:8 row_mask:0xf bank_mask:0x3
  v_mov_b32_dpp v175, v171 row_ror:8 row_mask:0xf bank_mask:0x3
  v_mov_b32_dpp v168, v128 quad_perm:[0,1,2,3] row_mask:0xf bank_mask:0xc
  v_mov_b32_dpp v169, v129 quad_perm:[0,1,2,3] row_mask:0xf bank_mask:0xc
  v_mov_b32_dpp v170, v130 quad_perm:[0,1,2,3] row_mask:0xf bank_mask:0xc
  v_mov_b32_dpp v171, v131 quad_perm:[0,1,2,3] row_mask:0xf bank_mask:0xc
  buffer_store_dwordx4 v[168:171], v29, s[36:39], s40 offen
  buffer_store_dwordx4 v[172:175], v29, s[36:39], s51 offen
  s_endpgm
L_g2_late:
  s_mov_b32 s62, 1081344
  s_sleep 2
  buffer_load_dword v26, v25, s[60:63], 0 offen sc1
  s_add_u32 s64, s64, 1
  s_waitcnt vmcnt(0)
  v_cmp_ne_u32 vcc, 1, v26
  s_cmp_lt_u32 s64, 0x80000
  s_cselect_b64 s[74:75], vcc, 0
  s_cmp_lg_u64 s[74:75], 0
  s_cbranch_scc1 L_g2_late
  s_branch L_g2_back
  s_endpgm
L_f2_packed:
  s_mul_i32 s14, s13, 8704
  s_add_u32 s14, s14, 106496
  v_and_b32 v3, 31, v0
  v_lshlrev_b32 v3, 2, v3
  v_lshrrev_b32 v7, 5, v0
  v_lshl_add_u32 v3, v7, 9, v3
  s_lshl_b32 s15, s13, 2
  s_sub_u32 s15, 640, s15
  s_add_u32 s15, s15, s14
  v_sub_u32 v160, s15, v3
  v_add_u32 v3, s14, v3
  v_add_u32 v7, 128, v3
  v_min_u32 v162, 1, v0
  v_lshl_add_u32 v162, v162, 2, s14
  v_add_u32 v8, 3072, v160
  v_add_u32 v12, 7424, v160
  v_add_u32 v9, 2048, v160
  v_add_u32 v13, 6400, v160
  v_add_u32 v10, 1024, v160
  v_add_u32 v14, 5376, v160
  v_add_u32 v11, 0, v160
  v_add_u32 v15, 4352, v160
  ds_write2st64_b32 v3, v216, v232 offset0:0 offset1:17
  ds_write2st64_b32 v7, v217, v233 offset0:0 offset1:17
  ds_write2st64_b32 v3, v218, v234 offset0:1 offset1:18
  ds_write2st64_b32 v7, v219, v235 offset0:1 offset1:18
  ds_write2st64_b32 v3, v220, v236 offset0:4 offset1:21
  ds_write2st64_b32 v7, v221, v237 offset0:4 offset1:21
  ds_write2st64_b32 v3, v222, v238 offset0:5 offset1:22
  ds_write2st64_b32 v7, v223, v239 offset0:5 offset1:22
  ds_write2st64_b32 v3, v224, v240 offset0:8 offset1:25
  ds_write2st64_b32 v7, v225, v241 offset0:8 offset1:25
  ds_write2st64_b32 v3, v226, v242 offset0:9 offset1:26
  ds_write2st64_b32 v7, v227, v243 offset0:9 offset1:26
  ds_write2st64_b32 v3, v228, v244 offset0:12 offset1:29
  ds_write2st64_b32 v7, v229, v245 offset0:12 offset1:29
  ds_write2st64_b32 v3, v230, v246 offset0:13 offset1:30
  ds_write2st64_b32 v7, v231, v247 offset0:13 offset1:30
  ds_write2st64_b32 v162, v216, v232 offset0:16 offset1:33
  ds_read2_b32 v[72:73], v8 offset0:96 offset1:64
  ds_read2_b32 v[88:89], v12 offset0:96 offset1:64
  ds_read2_b32 v[74:75], v8 offset0:32 offset1:0
  ds_read2_b32 v[90:91], v12 offset0:32 offset1:0
  ds_read2_b32 v[76:77], v9 offset0:96 offset1:64
  ds_read2_b32 v[92:93], v13 offset0:96 offset1:64
  ds_read2_b32 v[78:79], v9 offset0:32 offset1:0
  ds_read2_b32 v[94:95], v13 offset0:32 offset1:0
  ds_read2_b32 v[80:81], v10 offset0:96 offset1:64
  ds_read2_b32 v[96:97], v14 offset0:96 offset1:64
  ds_read2_b32 v[82:83], v10 offset0:32 offset1:0
  ds_read2_b32 v[98:99], v14 offset0:32 offset1:0
  ds_read2_b32 v[84:85], v11 offset0:96 offset1:64
  ds_read2_b32 v[100:101], v15 offset0:96 offset1:64
  ds_read2_b32 v[86:87], v11 offset0:32 offset1:0
  ds_read2_b32 v[102:103], v15 offset0:32 offset1:0
  s_waitcnt vmcnt(2)
  v_accvgpr_read_b32 v152, a0
  v_lshlrev_b32 v136, 16, v152
  v_and_b32 v152, 0xffff0000, v152
  v_accvgpr_read_b32 v153, a1
  v_lshlrev_b32 v137, 16, v153
  v_and_b32 v153, 0xffff0000, v153
  v_accvgpr_read_b32 v154, a2
  v_lshlrev_b32 v138, 16, v154
  v_and_b32 v154, 0xffff0000, v154
  v_accvgpr_read_b32 v155, a3
  v_lshlrev_b32 v139, 16, v155
  v_and_b32 v155, 0xffff0000, v155
  v_accvgpr_read_b32 v156, a4
  v_lshlrev_b32 v140, 16, v156
  v_and_b32 v156, 0xffff0000, v156
  v_accvgpr_read_b32 v157, a5
  v_lshlrev_b32 v141, 16, v157
  v_and_b32 v157, 0xffff0000, v157
  v_accvgpr_read_b32 v158, a6
  v_lshlrev_b32 v142, 16, v158
  v_and_b32 v158, 0xffff0000, v158
  v_accvgpr_read_b32 v159, a7
  v_lshlrev_b32 v143, 16, v159
  v_and_b32 v159, 0xffff0000, v159
  v_accvgpr_read_b32 v30, a8
  v_lshlrev_b32 v144, 16, v30
  v_and_b32 v30, 0xffff0000, v30
  v_accvgpr_read_b32 v31, a9
  v_lshlrev_b32 v145, 16, v31
  v_and_b32 v31, 0xffff0000, v31
  v_accvgpr_read_b32 v32, a10
  v_lshlrev_b32 v146, 16, v32
  v_and_b32 v32, 0xffff0000, v32
  v_accvgpr_read_b32 v33, a11
  v_lshlrev_b32 v147, 16, v33
  v_and_b32 v33, 0xffff0000, v33
  v_accvgpr_read_b32 v34, a12
  v_lshlrev_b32 v148, 16, v34
  v_and_b32 v34, 0xffff0000, v34
  v_accvgpr_read_b32 v35, a13
  v_lshlrev_b32 v149, 16, v35
  v_and_b32 v35, 0xffff0000, v35
  v_accvgpr_read_b32 v36, a14
  v_lshlrev_b32 v150, 16, v36
  v_and_b32 v36, 0xffff0000, v36
  v_accvgpr_read_b32 v37, a15
  v_lshlrev_b32 v151, 16, v37
  v_and_b32 v37, 0xffff0000, v37
  s_waitcnt lgkmcnt(0)
  v_pk_mul_f32 v[160:161], v[216:217], v[40:41]
  v_pk_mul_f32 v[162:163], v[232:233], v[40:41]
  v_pk_fma_f32 v[160:161], v[232:233], v[56:57], v[160:161] neg_lo:[1,0,0] neg_hi:[1,0,0]
  v_pk_fma_f32 v[162:163], v[216:217], v[56:57], v[162:163]
  v_pk_fma_f32 v[160:161], v[72:73], v[136:137], v[160:161]
  v_pk_fma_f32 v[162:163], v[72:73], v[152:153], v[162:163]
  v_pk_fma_f32 v[160:161], v[88:89], v[152:153], v[160:161]
  v_pk_fma_f32 v[162:163], v[88:89], v[136:137], v[162:163] neg_lo:[1,0,0] neg_hi:[1,0,0]
  v_cvt_pk_bf16_f32 v8, v160, v161
  v_cvt_pk_bf16_f32 v16, v162, v163
  v_pk_mul_f32 v[164:165], v[218:219], v[42:43]
  v_pk_mul_f32 v[166:167], v[234:235], v[42:43]
  v_pk_fma_f32 v[164:165], v[234:235], v[58:59], v[164:165] neg_lo:[1,0,0] neg_hi:[1,0,0]
  v_pk_fma_f32 v[166:167], v[218:219], v[58:59], v[166:167]
  v_pk_fma_f32 v[164:165], v[74:75], v[138:139], v[164:165]
  v_pk_fma_f32 v[166:167], v[74:75], v[154:155], v[166:167]
  v_pk_fma_f32 v[164:165], v[90:91], v[154:155], v[164:165]
  v_pk_fma_f32 v[166:167], v[90:91], v[138:139], v[166:167] neg_lo:[1,0,0] neg_hi:[1,0,0]
  v_cvt_pk_bf16_f32 v9, v164, v165
  v_cvt_pk_bf16_f32 v17, v166, v167
  v_pk_mul_f32 v[160:161], v[220:221], v[44:45]
  v_pk_mul_f32 v[162:163], v[236:237], v[44:45]
  v_pk_fma_f32 v[160:161], v[236:237], v[60:61], v[160:161] neg_lo:[1,0,0] neg_hi:[1,0,0]
  v_pk_fma_f32 v[162:163], v[220:221], v[60:61], v[162:163]
  v_pk_fma_f32 v[160:161], v[76:77], v[140:141], v[160:161]
  v_pk_fma_f32 v[162:163], v[76:77], v[156:157], v[162:163]
  v_pk_fma_f32 v[160:161], v[92:93], v[156:157], v[160:161]
  v_pk_fma_f32 v[162:163], v[92:93], v[140:141], v[162:163] neg_lo:[1,0,0] neg_hi:[1,0,0]
  v_cvt_pk_bf16_f32 v10, v160, v161
  v_cvt_pk_bf16_f32 v18, v162, v163
  v_pk_mul_f32 v[164:165], v[222:223], v[46:47]
  v_pk_mul_f32 v[166:167], v[238:239], v[46:47]
  v_pk_fma_f32 v[164:165], v[238:239], v[62:63], v[164:165] neg_lo:[1,0,0] neg_hi:[1,0,0]
  v_pk_fma_f32 v[166:167], v[222:223], v[62:63], v[166:167]
  v_pk_fma_f32 v[164:165], v[78:79], v[142:143], v[164:165]
  v_pk_fma_f32 v[166:167], v[78:79], v[158:159], v[166:167]
  v_pk_fma_f32 v[164:165], v[94:95], v[158:159], v[164:165]
  v_pk_fma_f32 v[166:167], v[94:95], v[142:143], v[166:167] neg_lo:[1,0,0] neg_hi:[1,0,0]
  v_cvt_pk_bf16_f32 v11, v164, v165
  v_cvt_pk_bf16_f32 v19, v166, v167
  v_pk_mul_f32 v[160:161], v[224:225], v[48:49]
  v_pk_mul_f32 v[162:163], v[240:241], v[48:49]
  v_pk_fma_f32 v[160:161], v[240:241], v[64:65], v[160:161] neg_lo:[1,0,0] neg_hi:[1,0,0]
  v_pk_fma_f32 v[162:163], v[224:225], v[64:65], v[162:163]
  v_pk_fma_f32 v[160:161], v[80:81], v[144:145], v[160:161]
  v_pk_fma_f32 v[162:163], v[80:81], v[30:31], v[162:163]
  v_pk_fma_f32 v[160:161], v[96:97], v[30:31], v[160:161]
  v_pk_fma_f32 v[162:163], v[96:97], v[144:145], v[162:163] neg_lo:[1,0,0] neg_hi:[1,0,0]
  v_cvt_pk_bf16_f32 v12, v160, v161
  v_cvt_pk_bf16_f32 v20, v162, v163
  v_pk_mul_f32 v[164:165], v[226:227], v[50:51]
  v_pk_mul_f32 v[166:167], v[242:243], v[50:51]
  v_pk_fma_f32 v[164:165], v[242:243], v[66:67], v[164:165] neg_lo:[1,0,0] neg_hi:[1,0,0]
  v_pk_fma_f32 v[166:167], v[226:227], v[66:67], v[166:167]
  v_pk_fma_f32 v[164:165], v[82:83], v[146:147], v[164:165]
  v_pk_fma_f32 v[166:167], v[82:83], v[32:33], v[166:167]
  v_pk_fma_f32 v[164:165], v[98:99], v[32:33], v[164:165]
  v_pk_fma_f32 v[166:167], v[98:99], v[146:147], v[166:167] neg_lo:[1,0,0] neg_hi:[1,0,0]
  v_cvt_pk_bf16_f32 v13, v164, v165
  v_cvt_pk_bf16_f32 v21, v166, v167
  v_pk_mul_f32 v[160:161], v[228:229], v[52:53]
  v_pk_mul_f32 v[162:163], v[244:245], v[52:53]
  v_pk_fma_f32 v[160:161], v[244:245], v[68:69], v[160:161] neg_lo:[1,0,0] neg_hi:[1,0,0]
  v_pk_fma_f32 v[162:163], v[228:229], v[68:69], v[162:163]
  v_pk_fma_f32 v[160:161], v[84:85], v[148:149], v[160:161]
  v_pk_fma_f32 v[162:163], v[84:85], v[34:35], v[162:163]
  v_pk_fma_f32 v[160:161], v[100:101], v[34:35], v[160:161]
  v_pk_fma_f32 v[162:163], v[100:101], v[148:149], v[162:163] neg_lo:[1,0,0] neg_hi:[1,0,0]
  v_cvt_pk_bf16_f32 v14, v160, v161
  v_cvt_pk_bf16_f32 v22, v162, v163
  v_pk_mul_f32 v[164:165], v[230:231], v[54:55]
  v_pk_mul_f32 v[166:167], v[246:247], v[54:55]
  v_pk_fma_f32 v[164:165], v[246:247], v[70:71], v[164:165] neg_lo:[1,0,0] neg_hi:[1,0,0]
  v_pk_fma_f32 v[166:167], v[230:231], v[70:71], v[166:167]
  v_pk_fma_f32 v[164:165], v[86:87], v[150:151], v[164:165]
  v_pk_fma_f32 v[166:167], v[86:87], v[36:37], v[166:167]
  v_pk_fma_f32 v[164:165], v[102:103], v[36:37], v[164:165]
  v_pk_fma_f32 v[166:167], v[102:103], v[150:151], v[166:167] neg_lo:[1,0,0] neg_hi:[1,0,0]
  v_cvt_pk_bf16_f32 v15, v164, v165
  v_cvt_pk_bf16_f32 v23, v166, v167
  s_nop 1
  s_branch L_f2_join
L_f2_end:
  s_endpgm
.section .rodata,"a"
.p2align 6
.amdhsa_kernel fft1_kernel
  .amdhsa_next_free_vgpr 232
  .amdhsa_next_free_sgpr 96
  .amdhsa_accum_offset 232
  .amdhsa_group_segment_fixed_size 0
  .amdhsa_kernarg_size 80
  .amdhsa_user_sgpr_count 2
  .amdhsa_user_sgpr_kernarg_segment_ptr 1
  .amdhsa_system_sgpr_workgroup_id_x 1
  .amdhsa_float_denorm_mode_32 3
.end_amdhsa_kernel
.p2align 6
.amdhsa_kernel main_kernel
  .amdhsa_next_free_vgpr 512
  .amdhsa_next_free_sgpr 96
  .amdhsa_accum_offset 256
  .amdhsa_group_segment_fixed_size 0
  .amdhsa_kernarg_size 80
  .amdhsa_user_sgpr_count 2
  .amdhsa_user_sgpr_kernarg_segment_ptr 1
  .amdhsa_system_sgpr_workgroup_id_x 1
  .amdhsa_float_denorm_mode_32 3
.end_amdhsa_kernel
```
